```python
import torch

def _softmax(x, axis=-1):
    return torch.softmax(x, dim=axis)
def _gelu(x):
    return torch.nn.functional.gelu(x, approximate="tanh")
def _silu(x):
    return torch.nn.functional.silu(x)
def _sigmoid(x):
    return torch.sigmoid(x)
def _layernorm(x, axis=-1, eps=1e-5):
    m = x.mean(dim=axis, keepdim=True)
    v = x.var(dim=axis, keepdim=True, unbiased=False)
    return (x - m) / torch.sqrt(v + eps)
def _scatter_add(tgt, idx, src, axis=0):
    return tgt.clone().index_add_(axis, idx, src)
def _segment_sum(src, seg, n):
    out = torch.zeros((n,) + src.shape[1:], dtype=src.dtype)
    return out.index_add_(0, seg, src)
def _pad(x, pw):
    flat = tuple(v for pair in reversed(pw) for v in pair)
    return torch.nn.functional.pad(x, flat)

kernel_name = 'concat_heads__mha_block_cached__gqa_block_cached__near_ridge'

def setup_inputs():

    _w = (lambda a: (lambda t: t.to(torch.bfloat16) if t.is_floating_point() else t)(torch.as_tensor(a)))
    def _A_setup():
        B, Sq, D = 16, 192, 448
        H, Sk, Dh = 16, 512, 256
        return {
            "x": _w((lambda *s: torch.randn(*s, dtype=torch.bfloat16) * 0.8)(B, Sq, D)),
            "k_cache": _w((lambda *s: torch.randn(*s, dtype=torch.bfloat16) * 0.8)(B, H, Sk, Dh)),
            "v_cache": _w((lambda *s: torch.randn(*s, dtype=torch.bfloat16) * 0.05)(B, H, Sk, Dh)),
            "wq": _w((lambda *s: torch.randn(*s, dtype=torch.bfloat16) * 0.8)(D, H * Dh) * (D ** -0.5)),
            "wo": _w((lambda *s: torch.randn(*s, dtype=torch.bfloat16) * 0.05)(H * Dh, D) * ((H * Dh) ** -0.5)),
        }
    _A_in = _A_setup()

    def _B_setup():
        B, Sq, D = 16, 192, 448
        Hq, Hkv, Sk, Dh = 16, 16, 512, 256
        assert Hq % Hkv == 0, (Hq, Hkv)
        return {
            "x": _w((lambda *s: torch.randn(*s, dtype=torch.bfloat16) * 0.8)(B, Sq, D)),
            "k_cache": _w((lambda *s: torch.randn(*s, dtype=torch.bfloat16) * 0.8)(B, Hkv, Sk, Dh)),
            "v_cache": _w((lambda *s: torch.randn(*s, dtype=torch.bfloat16) * 0.05)(B, Hkv, Sk, Dh)),
            "wq": _w((lambda *s: torch.randn(*s, dtype=torch.bfloat16) * 0.8)(D, Hq * Dh) * (D ** -0.5)),
            "wo": _w((lambda *s: torch.randn(*s, dtype=torch.bfloat16) * 0.05)(Hq * Dh, D) * ((Hq * Dh) ** -0.5)),
        }
    _B_in = _B_setup()

    return {
        "A_x": _A_in["x"],
        "A_k_cache": _A_in["k_cache"],
        "A_v_cache": _A_in["v_cache"],
        "A_wq": _A_in["wq"],
        "A_wo": _A_in["wo"],
        "B_x": _B_in["x"],
        "B_k_cache": _B_in["k_cache"],
        "B_v_cache": _B_in["v_cache"],
        "B_wq": _B_in["wq"],
        "B_wo": _B_in["wo"],
    }

def reference(A_x, A_k_cache, A_v_cache, A_wq, A_wo, B_x, B_k_cache, B_v_cache, B_wq, B_wo):
    def _A_ref(x, k_cache, v_cache, wq, wo):
        B, Sq, D = x.shape
        H, Dh = 16, 256
        q = (lambda x, *d: x.permute(*d))((x @ wq).reshape(B, Sq, H, Dh), 0, 2, 1, 3)
        scores = torch.einsum("bhqd,bhkd->bhqk", q, k_cache) * (Dh ** -0.5)
        p = _softmax(scores, axis=-1)
        o = torch.einsum("bhqk,bhkd->bhqd", p, v_cache)
        return (lambda x, *d: x.permute(*d))(o, 0, 2, 1, 3).reshape(B, Sq, H * Dh) @ wo

    def _B_ref(x, k_cache, v_cache, wq, wo):
        B, Sq, D = x.shape
        Hq, Dh = 16, 256
        Hkv = k_cache.shape[1]
        rep = Hq // Hkv
        q = (lambda x, *d: x.permute(*d))((x @ wq).reshape(B, Sq, Hq, Dh), 0, 2, 1, 3)
        k = (lambda x, n, axis: torch.repeat_interleave(x, n, dim=axis))(k_cache, rep, axis=1)
        v = (lambda x, n, axis: torch.repeat_interleave(x, n, dim=axis))(v_cache, rep, axis=1)
        scores = torch.einsum("bhqd,bhkd->bhqk", q, k) * (Dh ** -0.5)
        p = _softmax(scores, axis=-1)
        o = torch.einsum("bhqk,bhkd->bhqd", p, v)
        return (lambda x, *d: x.permute(*d))(o, 0, 2, 1, 3).reshape(B, Sq, Hq * Dh) @ wo

    a = _A_ref(A_x, A_k_cache, A_v_cache, A_wq, A_wo)
    b = _B_ref(B_x, B_k_cache, B_v_cache, B_wq, B_wo)
    return torch.concatenate([a, b], axis=-1)
```

```asm
; @launch kernel=attn_kernel grid=(256,1,1) block=(256,1,1) lds=163840
; @launch kernel=reduce_kernel grid=(224,1,1) block=(256,1,1) lds=0
.amdgcn_target "amdgcn-amd-amdhsa--gfx950"
.text
.globl attn_kernel
.p2align 8
.type attn_kernel,@function
attn_kernel:
  s_cmp_ge_u32 s2, 256
  s_cbranch_scc1 L_k1_end
  s_load_dwordx16 s[68:83], s[0:1], 0
  s_load_dwordx4 s[84:87], s[0:1], 64
  s_load_dwordx2 s[88:89], s[0:1], 96
  s_and_b32 s90, s2, 7
  s_lshr_b32 s91, s2, 3
  s_lshr_b32 s92, s90, 2
  s_lshr_b32 s93, s90, 1
  s_and_b32 s93, s93, 1
  s_lshl_b32 s93, s93, 3
  s_lshr_b32 s94, s91, 2
  s_add_u32 s93, s93, s94
  s_and_b32 s95, s90, 1
  s_lshl_b32 s95, s95, 3
  s_and_b32 s96, s91, 3
  s_lshl_b32 s97, s96, 1
  s_add_u32 s95, s95, s97
  s_lshl_b32 s61, s96, 1
  s_add_u32 s61, s61, s94
  s_cmp_ge_u32 s61, 7
  s_cselect_b32 s97, 7, 0
  s_sub_u32 s61, s61, s97
  s_cmp_ge_u32 s61, 7
  s_cselect_b32 s97, 7, 0
  s_sub_u32 s61, s61, s97
  v_lshrrev_b32 v1, 6, v0
  v_and_b32 v56, 63, v0
  v_readfirstlane_b32 s24, v1
  v_and_b32 v57, 15, v56
  v_lshrrev_b32 v58, 4, v56
  v_bfe_u32 v62, v56, 4, 1
  v_bfe_u32 v63, v56, 2, 2
  v_bfe_u32 v59, v56, 1, 1
  v_xor_b32 v59, v59, v62
  v_lshlrev_b32 v59, 5, v59
  v_lshrrev_b32 v60, 5, v56
  v_lshl_add_u32 v59, v60, 6, v59
  v_and_b32 v60, 1, v56
  v_lshl_add_u32 v61, v60, 4, v59
  s_and_b32 s38, s24, 1
  s_lshl_b32 s38, s38, 4
  s_lshr_b32 s39, s24, 1
  s_lshl_b32 s39, s39, 2
  s_add_u32 s38, s38, s39
  v_lshl_add_u32 v59, v62, 3, v63
  v_add_u32 v59, s38, v59
  v_lshl_add_u32 v11, v59, 13, v61
  s_mul_i32 s38, s24, 48
  v_add_u32 v59, s38, v57
  s_movk_i32 s39, 896
  v_mul_lo_u32 v59, v59, s39
  v_lshl_add_u32 v12, v58, 4, v59
  v_add_u32 v19, 14336, v12
  v_add_u32 v20, 28672, v12
  s_lshl_b32 s38, s24, 12
  s_add_u32 s46, s38, 0
  s_add_u32 s50, s38, 0
  s_add_u32 s62, s38, 0
  s_add_u32 s47, s38, 768
  s_add_u32 s51, s38, 896
  s_add_u32 s63, s38, 1024
  s_add_u32 s48, s38, 2048
  s_add_u32 s52, s38, 1792
  s_add_u32 s64, s38, 2048
  s_add_u32 s49, s38, 2816
  s_add_u32 s53, s38, 2688
  s_add_u32 s65, s38, 3072
  s_mov_b32 s25, 0
  s_mov_b32 s26, 0xffffc000
  s_mov_b32 s27, 0xffffc000
  s_mov_b32 s29, 98304
  s_mov_b32 s30, 147456
  s_mov_b32 s31, 49152
  s_mov_b32 s32, 65536
  s_mov_b32 s33, 147456
  s_mov_b32 s34, 49152
  s_lshl_b32 s35, s61, 1
  s_add_u32 s35, s35, 13
  s_cmp_ge_u32 s35, 14
  s_cselect_b32 s38, 14, 0
  s_sub_u32 s35, s35, s38
  s_lshl_b32 s35, s35, 18
  s_add_u32 s40, s61, 6
  s_cmp_ge_u32 s40, 7
  s_cselect_b32 s38, 7, 0
  s_sub_u32 s40, s40, s38
  s_lshl_b32 s40, s40, 7
  s_mov_b32 s60, 0
  s_mov_b32 s36, 0
  s_waitcnt lgkmcnt(0)
  s_cmp_eq_u32 s92, 0
  s_cselect_b32 s68, s68, s78
  s_cselect_b32 s69, s69, s79
  s_cselect_b32 s70, s70, s80
  s_cselect_b32 s71, s71, s81
  s_cselect_b32 s72, s72, s82
  s_cselect_b32 s73, s73, s83
  s_cselect_b32 s74, s74, s84
  s_cselect_b32 s75, s75, s85
  s_cselect_b32 s76, s76, s86
  s_cselect_b32 s77, s77, s87
  s_lshl_b32 s97, s95, 9
  s_add_u32 s12, s74, s97
  s_addc_u32 s13, s75, 0
  s_and_b32 s13, s13, 0xffff
  s_sub_u32 s14, 3670016, s97
  s_mov_b32 s15, 0x20000
  s_mul_i32 s97, s93, 172032
  s_add_u32 s16, s68, s97
  s_addc_u32 s17, s69, 0
  s_and_b32 s17, s17, 0xffff
  s_mov_b32 s18, 172032
  s_mov_b32 s19, 0x20000
  s_add_u32 s35, s35, 262144
  s_cmp_eq_u32 s35, 3670016
  s_cselect_b32 s35, 0, s35
  s_add_u32 s31, s31, 16384
  s_and_b32 s31, s31, 65535
  s_add_u32 s28, s35, s36
  s_add_u32 m0, s31, s50
  s_nop 0
  buffer_load_dwordx4 v11, s[12:15], s28 offen offset:0 lds
  s_add_u32 m0, s31, s51
  s_nop 0
  buffer_load_dwordx4 v11, s[12:15], s28 offen offset:128 lds
  s_add_u32 m0, s31, s52
  s_nop 0
  buffer_load_dwordx4 v11, s[12:15], s28 offen offset:256 lds
  s_add_u32 m0, s31, s53
  s_nop 0
  buffer_load_dwordx4 v11, s[12:15], s28 offen offset:384 lds
  s_add_u32 s40, s40, 128
  s_cmp_eq_u32 s40, 896
  s_cselect_b32 s40, 0, s40
  buffer_load_dwordx4 a[192:195], v12, s[16:19], s40 offen offset:0
  buffer_load_dwordx4 a[204:207], v12, s[16:19], s40 offen offset:64
  buffer_load_dwordx4 a[196:199], v19, s[16:19], s40 offen offset:0
  buffer_load_dwordx4 a[208:211], v19, s[16:19], s40 offen offset:64
  buffer_load_dwordx4 a[200:203], v20, s[16:19], s40 offen offset:0
  buffer_load_dwordx4 a[212:215], v20, s[16:19], s40 offen offset:64
  s_add_u32 s35, s35, 262144
  s_cmp_eq_u32 s35, 3670016
  s_cselect_b32 s35, 0, s35
  s_add_u32 s31, s31, 16384
  s_and_b32 s31, s31, 65535
  s_add_u32 s28, s35, s36
  s_add_u32 m0, s31, s50
  s_nop 0
  buffer_load_dwordx4 v11, s[12:15], s28 offen offset:0 lds
  s_add_u32 m0, s31, s51
  s_nop 0
  buffer_load_dwordx4 v11, s[12:15], s28 offen offset:128 lds
  s_add_u32 m0, s31, s52
  s_nop 0
  buffer_load_dwordx4 v11, s[12:15], s28 offen offset:256 lds
  s_add_u32 m0, s31, s53
  s_nop 0
  buffer_load_dwordx4 v11, s[12:15], s28 offen offset:384 lds
  s_mul_i32 s97, s95, 229376
  s_add_u32 s56, s76, s97
  s_addc_u32 s57, s77, 0
  s_and_b32 s57, s57, 0xffff
  s_mov_b32 s58, 458752
  s_mov_b32 s59, 0x20000
  s_lshl_b32 s97, s92, 4
  s_add_u32 s97, s97, s93
  s_lshl_b32 s97, s97, 3
  s_lshr_b32 s90, s95, 1
  s_add_u32 s97, s97, s90
  s_mul_i32 s97, s97, 172032
  s_add_u32 s20, s88, s97
  s_addc_u32 s21, s89, 0
  s_and_b32 s21, s21, 0xffff
  s_mov_b32 s22, 172032
  s_mov_b32 s23, 0x20000
  s_add_u32 s35, s35, 262144
  s_cmp_eq_u32 s35, 3670016
  s_cselect_b32 s35, 0, s35
  s_add_u32 s31, s31, 16384
  s_and_b32 s31, s31, 65535
  s_add_u32 s28, s35, s36
  s_add_u32 m0, s31, s50
  s_nop 0
  buffer_load_dwordx4 v11, s[12:15], s28 offen offset:0 lds
  s_add_u32 m0, s31, s51
  s_nop 0
  buffer_load_dwordx4 v11, s[12:15], s28 offen offset:128 lds
  s_add_u32 m0, s31, s52
  s_nop 0
  buffer_load_dwordx4 v11, s[12:15], s28 offen offset:256 lds
  s_add_u32 m0, s31, s53
  s_nop 0
  buffer_load_dwordx4 v11, s[12:15], s28 offen offset:384 lds
  s_add_u32 s35, s35, 262144
  s_cmp_eq_u32 s35, 3670016
  s_cselect_b32 s35, 0, s35
  s_add_u32 s31, s31, 16384
  s_and_b32 s31, s31, 65535
  s_add_u32 s28, s35, s36
  s_add_u32 m0, s31, s50
  s_nop 0
  buffer_load_dwordx4 v11, s[12:15], s28 offen offset:0 lds
  s_add_u32 m0, s31, s51
  s_nop 0
  buffer_load_dwordx4 v11, s[12:15], s28 offen offset:128 lds
  s_add_u32 m0, s31, s52
  s_nop 0
  buffer_load_dwordx4 v11, s[12:15], s28 offen offset:256 lds
  s_add_u32 m0, s31, s53
  s_nop 0
  buffer_load_dwordx4 v11, s[12:15], s28 offen offset:384 lds
  s_lshl_b32 s97, s93, 4
  s_add_u32 s97, s97, s95
  s_lshl_b32 s97, s97, 18
  s_add_u32 s4, s70, s97
  s_addc_u32 s5, s71, 0
  s_and_b32 s5, s5, 0xffff
  s_mov_b32 s6, 524288
  s_mov_b32 s7, 0x20000
  s_add_u32 s8, s72, s97
  s_addc_u32 s9, s73, 0
  s_and_b32 s9, s9, 0xffff
  s_mov_b32 s10, 524288
  s_mov_b32 s11, 0x20000
  v_lshl_add_u32 v59, v62, 2, v63
  v_lshl_add_u32 v59, v59, 9, v61
  s_lshl_b32 s38, s24, 12
  v_add_u32 v10, s38, v59
  s_and_b32 s38, s24, 1
  s_lshl_b32 s38, s38, 1
  s_add_u32 s38, s38, 0
  s_sub_u32 s39, 4, s38
  s_and_b32 s39, s39, 3
  v_and_b32 v59, 3, v56
  v_xor_b32 v59, s39, v59
  v_lshlrev_b32 v59, 4, v59
  v_lshl_add_u32 v59, v58, 6, v59
  s_lshl_b32 s38, s38, 2
  s_lshr_b32 s39, s24, 1
  s_lshl_b32 s39, s39, 4
  s_add_u32 s38, s38, s39
  v_add_u32 v60, s38, v63
  v_lshl_add_u32 v8, v60, 9, v59
  s_and_b32 s38, s24, 1
  s_lshl_b32 s38, s38, 1
  s_add_u32 s38, s38, 1
  s_sub_u32 s39, 4, s38
  s_and_b32 s39, s39, 3
  v_and_b32 v59, 3, v56
  v_xor_b32 v59, s39, v59
  v_lshlrev_b32 v59, 4, v59
  v_lshl_add_u32 v59, v58, 6, v59
  s_lshl_b32 s38, s38, 2
  s_lshr_b32 s39, s24, 1
  s_lshl_b32 s39, s39, 4
  s_add_u32 s38, s38, s39
  v_add_u32 v60, s38, v63
  v_lshl_add_u32 v9, v60, 9, v59
  v_lshrrev_b32 v59, 2, v57
  v_sub_u32 v60, 4, v59
  v_and_b32 v60, 3, v60
  v_xor_b32 v60, v60, v58
  v_lshlrev_b32 v60, 4, v60
  v_lshl_add_u32 v60, v59, 11, v60
  v_and_b32 v59, 3, v57
  v_lshl_add_u32 v2, v59, 6, v60
  v_lshrrev_b32 v59, 1, v58
  v_lshlrev_b32 v59, 12, v59
  v_lshl_add_u32 v59, v62, 8, v59
  v_lshl_add_u32 v59, v63, 6, v59
  v_and_b32 v60, 3, v56
  v_lshl_add_u32 v59, v60, 3, v59
  v_lshl_add_u32 v3, v62, 5, v59
  v_xor_b32 v60, 1, v62
  v_lshl_add_u32 v4, v60, 5, v59
  v_add_u32 v5, 65536, v2
  v_lshrrev_b32 v59, 4, v56
  v_sub_u32 v59, 4, v59
  v_and_b32 v59, 3, v59
  v_and_b32 v60, 3, v56
  v_xor_b32 v59, v59, v60
  v_lshlrev_b32 v59, 4, v59
  v_lshrrev_b32 v60, 2, v56
  s_mul_i32 s38, s24, 48
  v_add_u32 v60, s38, v60
  s_movk_i32 s97, 896
  v_mul_lo_u32 v60, v60, s97
  v_add_u32 v21, v59, v60
  v_lshrrev_b32 v59, 2, v57
  v_sub_u32 v59, 4, v59
  v_and_b32 v59, 3, v59
  v_xor_b32 v59, v59, v58
  v_lshlrev_b32 v59, 4, v59
  v_lshl_add_u32 v59, v57, 6, v59
  v_add_u32 v23, 64, v59
  s_mul_i32 s38, s24, 43008
  v_lshlrev_b32 v59, 4, v56
  v_add_u32 v13, s38, v59
  s_lshr_b32 s38, s24, 1
  s_lshl_b32 s38, s38, 4
  s_and_b32 s39, s24, 1
  s_lshl_b32 s39, s39, 3
  s_add_u32 s38, s38, s39
  v_lshl_add_u32 v59, v62, 2, v63
  v_add_u32 v59, s38, v59
  s_movk_i32 s39, 896
  v_mul_lo_u32 v59, v59, s39
  v_add_u32 v22, v59, v61
  s_mov_b32 s42, 0x3db8aa3b
  s_mov_b32 s43, 0x41317218
  s_mov_b32 s44, 0x41800000
  s_lshl_b32 s41, s61, 7
  s_mov_b32 s92, s16
  s_mov_b32 s93, s17
  s_mov_b32 s94, 0
  s_mov_b32 s95, 0x20000
  s_mov_b32 s45, 0
  s_waitcnt vmcnt(13)
  s_barrier
L_k1_unit:
  s_andn2_b32 s38, s45, s60
  s_cmp_eq_u32 s38, 1
  s_cselect_b32 s39, 0, 32768
  s_add_u32 s39, s39, 114688
  s_lshl_b32 s38, s24, 12
  s_add_u32 s39, s39, s38
  v_add_u32 v14, s39, v23
  s_add_u32 s34, s34, 16384
  s_and_b32 s34, s34, 65535
  v_add_u32 v6, s34, v3
  v_add_u32 v7, s34, v4
  ds_read_b64_tr_b16 v[40:41], v6 offset:0
  ds_read_b64_tr_b16 v[42:43], v6 offset:8192
  ds_read_b64_tr_b16 v[44:45], v7 offset:0
  ds_read_b64_tr_b16 v[46:47], v7 offset:8192
  ds_read_b64_tr_b16 v[48:49], v6 offset:512
  ds_read_b64_tr_b16 v[50:51], v6 offset:8704
  s_waitcnt lgkmcnt(4)
  v_mfma_f32_16x16x32_bf16 v[64:67], v[40:43], a[192:195], 0
  s_add_u32 s40, s40, 128
  ds_read_b64_tr_b16 v[52:53], v7 offset:512
  v_accvgpr_read_b32 v24, a48
  v_mfma_f32_16x16x32_bf16 v[68:71], v[40:43], a[196:199], 0
  s_cmp_eq_u32 s40, 896
  s_cselect_b32 s40, 0, s40
  ds_read_b64_tr_b16 v[54:55], v7 offset:8704
  v_mfma_f32_16x16x32_bf16 v[72:75], v[40:43], a[200:203], 0
  s_waitcnt lgkmcnt(4)
  v_accvgpr_read_b32 v25, a49
  v_accvgpr_read_b32 v26, a50
  v_mfma_f32_16x16x32_bf16 v[160:163], v[44:47], a[192:195], 0
  s_add_u32 s54, s40, 14336
  ds_read_b64_tr_b16 v[40:41], v6 offset:1024
  v_accvgpr_read_b32 v27, a51
  v_mfma_f32_16x16x32_bf16 v[164:167], v[44:47], a[196:199], 0
  s_add_u32 s55, s40, 28672
  ds_read_b64_tr_b16 v[42:43], v6 offset:9216
  v_accvgpr_read_b32 v28, a60
  v_mfma_f32_16x16x32_bf16 v[168:171], v[44:47], a[200:203], 0
  s_waitcnt lgkmcnt(4)
  v_accvgpr_read_b32 v29, a61
  v_accvgpr_read_b32 v30, a62
  v_mfma_f32_16x16x32_bf16 v[76:79], v[48:51], a[192:195], 0
  ds_read_b64_tr_b16 v[44:45], v7 offset:1024
  v_accvgpr_read_b32 v31, a63
  v_mfma_f32_16x16x32_bf16 v[80:83], v[48:51], a[196:199], 0
  ds_read_b64_tr_b16 v[46:47], v7 offset:9216
  v_mul_f32 v24, v24, v56
  v_mfma_f32_16x16x32_bf16 v[84:87], v[48:51], a[200:203], 0
  s_waitcnt lgkmcnt(4)
  v_mul_f32 v25, v25, v56
  v_mul_f32 v26, v26, v56
  v_mfma_f32_16x16x32_bf16 v[172:175], v[52:55], a[192:195], 0
  ds_read_b64_tr_b16 v[48:49], v6 offset:1536
  v_mul_f32 v27, v27, v56
  v_mfma_f32_16x16x32_bf16 v[176:179], v[52:55], a[196:199], 0
  ds_read_b64_tr_b16 v[50:51], v6 offset:9728
  v_mul_f32 v28, v28, v56
  v_mfma_f32_16x16x32_bf16 v[180:183], v[52:55], a[200:203], 0
  s_waitcnt lgkmcnt(4)
  v_mul_f32 v29, v29, v56
  v_mul_f32 v30, v30, v56
  v_mfma_f32_16x16x32_bf16 v[88:91], v[40:43], a[192:195], 0
  ds_read_b64_tr_b16 v[52:53], v7 offset:1536
  v_mul_f32 v31, v31, v56
  v_mfma_f32_16x16x32_bf16 v[92:95], v[40:43], a[196:199], 0
  s_add_u32 m0, s39, 64
  ds_read_b64_tr_b16 v[54:55], v7 offset:9728
  v_cvt_pk_bf16_f32 v24, v24, v25
  v_mfma_f32_16x16x32_bf16 v[96:99], v[40:43], a[200:203], 0
  s_waitcnt lgkmcnt(4)
  buffer_load_dwordx4 v21, s[16:19], s40 offen offset:0 lds
  v_mfma_f32_16x16x32_bf16 v[184:187], v[44:47], a[192:195], 0
  ds_read_b64_tr_b16 v[40:41], v6 offset:2048
  v_cvt_pk_bf16_f32 v25, v26, v27
  v_mfma_f32_16x16x32_bf16 v[188:191], v[44:47], a[196:199], 0
  s_add_u32 m0, s39, 1088
  ds_read_b64_tr_b16 v[42:43], v6 offset:10240
  v_cvt_pk_bf16_f32 v26, v28, v29
  v_mfma_f32_16x16x32_bf16 v[192:195], v[44:47], a[200:203], 0
  s_waitcnt lgkmcnt(4)
  buffer_load_dwordx4 v21, s[16:19], s54 offen offset:0 lds
  v_mfma_f32_16x16x32_bf16 v[100:103], v[48:51], a[192:195], 0
  ds_read_b64_tr_b16 v[44:45], v7 offset:2048
  v_cvt_pk_bf16_f32 v27, v30, v31
  v_mfma_f32_16x16x32_bf16 v[104:107], v[48:51], a[196:199], 0
  s_add_u32 m0, s39, 2112
  ds_read_b64_tr_b16 v[46:47], v7 offset:10240
  v_accvgpr_write_b32 a48, v24
  v_mfma_f32_16x16x32_bf16 v[108:111], v[48:51], a[200:203], 0
  s_waitcnt lgkmcnt(4)
  buffer_load_dwordx4 v21, s[16:19], s55 offen offset:0 lds
  v_mfma_f32_16x16x32_bf16 v[196:199], v[52:55], a[192:195], 0
  ds_read_b64_tr_b16 v[48:49], v6 offset:2560
  v_accvgpr_write_b32 a49, v25
  v_mfma_f32_16x16x32_bf16 v[200:203], v[52:55], a[196:199], 0
  ds_read_b64_tr_b16 v[50:51], v6 offset:10752
  v_accvgpr_write_b32 a50, v26
  v_mfma_f32_16x16x32_bf16 v[204:207], v[52:55], a[200:203], 0
  s_waitcnt lgkmcnt(4)
  v_accvgpr_write_b32 a51, v27
  v_accvgpr_read_b32 v32, a52
  v_mfma_f32_16x16x32_bf16 v[112:115], v[40:43], a[192:195], 0
  s_waitcnt vmcnt(11)
  ds_read_b64_tr_b16 v[52:53], v7 offset:2560
  v_accvgpr_read_b32 v33, a53
  v_mfma_f32_16x16x32_bf16 v[116:119], v[40:43], a[196:199], 0
  s_barrier
  ds_read_b64_tr_b16 v[54:55], v7 offset:10752
  v_accvgpr_read_b32 v34, a54
  v_mfma_f32_16x16x32_bf16 v[120:123], v[40:43], a[200:203], 0
  s_waitcnt lgkmcnt(4)
  v_accvgpr_read_b32 v35, a55
  v_accvgpr_read_b32 v36, a64
  v_mfma_f32_16x16x32_bf16 v[208:211], v[44:47], a[192:195], 0
  ds_read_b64_tr_b16 v[40:41], v6 offset:3072
  v_accvgpr_read_b32 v37, a65
  v_mfma_f32_16x16x32_bf16 v[212:215], v[44:47], a[196:199], 0
  ds_read_b64_tr_b16 v[42:43], v6 offset:11264
  v_accvgpr_read_b32 v38, a66
  v_mfma_f32_16x16x32_bf16 v[216:219], v[44:47], a[200:203], 0
  s_waitcnt lgkmcnt(4)
  v_accvgpr_read_b32 v39, a67
  v_mul_f32 v32, v32, v58
  v_mfma_f32_16x16x32_bf16 v[124:127], v[48:51], a[192:195], 0
  s_add_u32 s34, s34, 16384
  ds_read_b64_tr_b16 v[44:45], v7 offset:3072
  v_mul_f32 v33, v33, v58
  v_mfma_f32_16x16x32_bf16 v[128:131], v[48:51], a[196:199], 0
  ds_read_b64_tr_b16 v[46:47], v7 offset:11264
  v_mul_f32 v34, v34, v58
  v_mfma_f32_16x16x32_bf16 v[132:135], v[48:51], a[200:203], 0
  s_waitcnt lgkmcnt(4)
  v_mul_f32 v35, v35, v58
  v_mul_f32 v36, v36, v58
  v_mfma_f32_16x16x32_bf16 v[220:223], v[52:55], a[192:195], 0
  s_and_b32 s34, s34, 65535
  ds_read_b64_tr_b16 v[48:49], v6 offset:3584
  v_mul_f32 v37, v37, v58
  v_mfma_f32_16x16x32_bf16 v[224:227], v[52:55], a[196:199], 0
  ds_read_b64_tr_b16 v[50:51], v6 offset:11776
  v_mul_f32 v38, v38, v58
  v_mfma_f32_16x16x32_bf16 v[228:231], v[52:55], a[200:203], 0
  s_waitcnt lgkmcnt(4)
  v_mul_f32 v39, v39, v58
  v_cvt_pk_bf16_f32 v32, v32, v33
  v_mfma_f32_16x16x32_bf16 v[136:139], v[40:43], a[192:195], 0
  ds_read_b64_tr_b16 v[52:53], v7 offset:3584
  v_add_u32 v6, s34, v3
  v_mfma_f32_16x16x32_bf16 v[140:143], v[40:43], a[196:199], 0
  ds_read_b64_tr_b16 v[54:55], v7 offset:11776
  v_add_u32 v7, s34, v4
  v_mfma_f32_16x16x32_bf16 v[144:147], v[40:43], a[200:203], 0
  s_waitcnt lgkmcnt(4)
  v_cvt_pk_bf16_f32 v33, v34, v35
  v_cvt_pk_bf16_f32 v34, v36, v37
  v_mfma_f32_16x16x32_bf16 v[232:235], v[44:47], a[192:195], 0
  ds_read_b64_tr_b16 v[40:41], v6 offset:0
  v_cvt_pk_bf16_f32 v35, v38, v39
  v_mfma_f32_16x16x32_bf16 v[236:239], v[44:47], a[196:199], 0
  ds_read_b64_tr_b16 v[42:43], v6 offset:8192
  v_accvgpr_write_b32 a52, v32
  v_mfma_f32_16x16x32_bf16 v[240:243], v[44:47], a[200:203], 0
  s_waitcnt lgkmcnt(4)
  v_accvgpr_write_b32 a53, v33
  v_accvgpr_write_b32 a54, v34
  v_mfma_f32_16x16x32_bf16 v[148:151], v[48:51], a[192:195], 0
  ds_read_b64_tr_b16 v[44:45], v7 offset:0
  v_accvgpr_write_b32 a55, v35
  v_mfma_f32_16x16x32_bf16 v[152:155], v[48:51], a[196:199], 0
  ds_read_b64_tr_b16 v[46:47], v7 offset:8192
  v_accvgpr_read_b32 v24, a56
  v_mfma_f32_16x16x32_bf16 v[156:159], v[48:51], a[200:203], 0
  s_waitcnt lgkmcnt(4)
  v_accvgpr_read_b32 v25, a57
  v_accvgpr_read_b32 v26, a58
  v_mfma_f32_16x16x32_bf16 v[244:247], v[52:55], a[192:195], 0
  ds_read_b64_tr_b16 v[48:49], v6 offset:512
  v_accvgpr_read_b32 v27, a59
  v_mfma_f32_16x16x32_bf16 v[248:251], v[52:55], a[196:199], 0
  ds_read_b64_tr_b16 v[50:51], v6 offset:8704
  v_accvgpr_read_b32 v28, a68
  v_mfma_f32_16x16x32_bf16 v[252:255], v[52:55], a[200:203], 0
  s_waitcnt lgkmcnt(4)
  v_accvgpr_read_b32 v29, a69
  v_accvgpr_read_b32 v30, a70
  v_mfma_f32_16x16x32_bf16 v[64:67], v[40:43], a[204:207], v[64:67]
  s_add_u32 s35, s35, 262144
  ds_read_b64_tr_b16 v[52:53], v7 offset:512
  v_accvgpr_read_b32 v31, a71
  v_mfma_f32_16x16x32_bf16 v[68:71], v[40:43], a[208:211], v[68:71]
  s_waitcnt vmcnt(0)
  ds_read_b64_tr_b16 v[54:55], v7 offset:8704
  v_mul_f32 v24, v24, v60
  v_mfma_f32_16x16x32_bf16 v[72:75], v[40:43], a[212:215], v[72:75]
  s_waitcnt lgkmcnt(4)
  ds_read_b128 a[216:219], v14 offset:0
  v_mul_f32 v25, v25, v60
  v_mfma_f32_16x16x32_bf16 v[160:163], v[44:47], a[204:207], v[160:163]
  s_cmp_eq_u32 s35, 3670016
  s_cselect_b32 s35, 0, s35
  ds_read_b64_tr_b16 v[40:41], v6 offset:1024
  v_mfma_f32_16x16x32_bf16 v[164:167], v[44:47], a[208:211], v[164:167]
  s_add_u32 s31, s31, 16384
  s_and_b32 s31, s31, 65535
  ds_read_b64_tr_b16 v[42:43], v6 offset:9216
  v_mfma_f32_16x16x32_bf16 v[168:171], v[44:47], a[212:215], v[168:171]
  s_waitcnt lgkmcnt(5)
  ds_read_b128 a[220:223], v14 offset:1024
  v_mul_f32 v26, v26, v60
  v_mfma_f32_16x16x32_bf16 v[76:79], v[48:51], a[204:207], v[76:79]
  s_add_u32 s28, s35, s36
  ds_read_b64_tr_b16 v[44:45], v7 offset:1024
  v_mul_f32 v27, v27, v60
  v_mfma_f32_16x16x32_bf16 v[80:83], v[48:51], a[208:211], v[80:83]
  ds_read_b64_tr_b16 v[46:47], v7 offset:9216
  v_mul_f32 v28, v28, v60
  v_mfma_f32_16x16x32_bf16 v[84:87], v[48:51], a[212:215], v[84:87]
  s_waitcnt lgkmcnt(6)
  ds_read_b128 a[224:227], v14 offset:2048
  v_mul_f32 v29, v29, v60
  v_mfma_f32_16x16x32_bf16 v[172:175], v[52:55], a[204:207], v[172:175]
  ds_read_b64_tr_b16 v[48:49], v6 offset:1536
  v_mul_f32 v30, v30, v60
  v_mfma_f32_16x16x32_bf16 v[176:179], v[52:55], a[208:211], v[176:179]
  ds_read_b64_tr_b16 v[50:51], v6 offset:9728
  v_mul_f32 v31, v31, v60
  v_mfma_f32_16x16x32_bf16 v[180:183], v[52:55], a[212:215], v[180:183]
  s_waitcnt lgkmcnt(6)
  v_cvt_pk_bf16_f32 v24, v24, v25
  v_cvt_pk_bf16_f32 v25, v26, v27
  v_mfma_f32_16x16x32_bf16 v[88:91], v[40:43], a[204:207], v[88:91]
  s_waitcnt lgkmcnt(2)
  ds_read_b64_tr_b16 v[52:53], v7 offset:1536
  v_cvt_pk_bf16_f32 v26, v28, v29
  v_mfma_f32_16x16x32_bf16 v[92:95], v[40:43], a[208:211], v[92:95]
  s_add_u32 m0, s39, 0
  ds_read_b64_tr_b16 v[54:55], v7 offset:9728
  v_cvt_pk_bf16_f32 v27, v30, v31
  v_mfma_f32_16x16x32_bf16 v[96:99], v[40:43], a[212:215], v[96:99]
  s_waitcnt lgkmcnt(5)
  buffer_load_dwordx4 v21, s[16:19], s40 offen offset:64 lds
  v_mfma_f32_16x16x32_bf16 v[184:187], v[44:47], a[204:207], v[184:187]
  ds_read_b64_tr_b16 v[40:41], v6 offset:2048
  v_accvgpr_write_b32 a56, v24
  v_mfma_f32_16x16x32_bf16 v[188:191], v[44:47], a[208:211], v[188:191]
  s_add_u32 m0, s39, 1024
  ds_read_b64_tr_b16 v[42:43], v6 offset:10240
  v_accvgpr_write_b32 a57, v25
  v_mfma_f32_16x16x32_bf16 v[192:195], v[44:47], a[212:215], v[192:195]
  s_waitcnt lgkmcnt(4)
  buffer_load_dwordx4 v21, s[16:19], s54 offen offset:64 lds
  v_mfma_f32_16x16x32_bf16 v[100:103], v[48:51], a[204:207], v[100:103]
  ds_read_b64_tr_b16 v[44:45], v7 offset:2048
  v_accvgpr_write_b32 a58, v26
  v_mfma_f32_16x16x32_bf16 v[104:107], v[48:51], a[208:211], v[104:107]
  s_add_u32 m0, s39, 2048
  ds_read_b64_tr_b16 v[46:47], v7 offset:10240
  v_accvgpr_write_b32 a59, v27
  v_mfma_f32_16x16x32_bf16 v[108:111], v[48:51], a[212:215], v[108:111]
  s_waitcnt lgkmcnt(4)
  buffer_load_dwordx4 v21, s[16:19], s55 offen offset:64 lds
  v_mfma_f32_16x16x32_bf16 v[196:199], v[52:55], a[204:207], v[196:199]
  ds_read_b64_tr_b16 v[48:49], v6 offset:2560
  v_accvgpr_read_b32 v32, a72
  v_mfma_f32_16x16x32_bf16 v[200:203], v[52:55], a[208:211], v[200:203]
  ds_read_b64_tr_b16 v[50:51], v6 offset:10752
  v_accvgpr_read_b32 v33, a73
  v_mfma_f32_16x16x32_bf16 v[204:207], v[52:55], a[212:215], v[204:207]
  s_waitcnt lgkmcnt(4)
  v_accvgpr_read_b32 v34, a74
  v_accvgpr_read_b32 v35, a75
  v_mfma_f32_16x16x32_bf16 v[112:115], v[40:43], a[204:207], v[112:115]
  s_waitcnt vmcnt(10)
  ds_read_b64_tr_b16 v[52:53], v7 offset:2560
  v_accvgpr_read_b32 v36, a84
  v_mfma_f32_16x16x32_bf16 v[116:119], v[40:43], a[208:211], v[116:119]
  s_barrier
  ds_read_b64_tr_b16 v[54:55], v7 offset:10752
  v_accvgpr_read_b32 v37, a85
  v_mfma_f32_16x16x32_bf16 v[120:123], v[40:43], a[212:215], v[120:123]
  s_waitcnt lgkmcnt(4)
  v_accvgpr_read_b32 v38, a86
  v_accvgpr_read_b32 v39, a87
  v_mfma_f32_16x16x32_bf16 v[208:211], v[44:47], a[204:207], v[208:211]
  ds_read_b64_tr_b16 v[40:41], v6 offset:3072
  v_mul_f32 v32, v32, v56
  v_mfma_f32_16x16x32_bf16 v[212:215], v[44:47], a[208:211], v[212:215]
  s_add_u32 m0, s31, s50
  ds_read_b64_tr_b16 v[42:43], v6 offset:11264
  v_mul_f32 v33, v33, v56
  v_mfma_f32_16x16x32_bf16 v[216:219], v[44:47], a[212:215], v[216:219]
  s_waitcnt lgkmcnt(4)
  buffer_load_dwordx4 v11, s[12:15], s28 offen offset:0 lds
  v_mfma_f32_16x16x32_bf16 v[124:127], v[48:51], a[204:207], v[124:127]
  s_add_u32 s34, s34, 16384
  ds_read_b64_tr_b16 v[44:45], v7 offset:3072
  v_mul_f32 v34, v34, v56
  v_mfma_f32_16x16x32_bf16 v[128:131], v[48:51], a[208:211], v[128:131]
  ds_read_b64_tr_b16 v[46:47], v7 offset:11264
  v_mul_f32 v35, v35, v56
  v_mfma_f32_16x16x32_bf16 v[132:135], v[48:51], a[212:215], v[132:135]
  s_waitcnt lgkmcnt(4)
  v_mul_f32 v36, v36, v56
  v_mul_f32 v37, v37, v56
  v_mfma_f32_16x16x32_bf16 v[220:223], v[52:55], a[204:207], v[220:223]
  s_and_b32 s34, s34, 65535
  ds_read_b64_tr_b16 v[48:49], v6 offset:3584
  v_mul_f32 v38, v38, v56
  v_mfma_f32_16x16x32_bf16 v[224:227], v[52:55], a[208:211], v[224:227]
  s_add_u32 m0, s31, s51
  ds_read_b64_tr_b16 v[50:51], v6 offset:11776
  v_mul_f32 v39, v39, v56
  v_mfma_f32_16x16x32_bf16 v[228:231], v[52:55], a[212:215], v[228:231]
  s_waitcnt lgkmcnt(4)
  buffer_load_dwordx4 v11, s[12:15], s28 offen offset:128 lds
  v_mfma_f32_16x16x32_bf16 v[136:139], v[40:43], a[204:207], v[136:139]
  ds_read_b64_tr_b16 v[52:53], v7 offset:3584
  v_add_u32 v6, s34, v3
  v_mfma_f32_16x16x32_bf16 v[140:143], v[40:43], a[208:211], v[140:143]
  ds_read_b64_tr_b16 v[54:55], v7 offset:11776
  v_add_u32 v7, s34, v4
  v_mfma_f32_16x16x32_bf16 v[144:147], v[40:43], a[212:215], v[144:147]
  s_waitcnt lgkmcnt(4)
  v_cvt_pk_bf16_f32 v32, v32, v33
  v_cvt_pk_bf16_f32 v33, v34, v35
  v_mfma_f32_16x16x32_bf16 v[232:235], v[44:47], a[204:207], v[232:235]
  ds_read_b64_tr_b16 v[40:41], v6 offset:0
  v_cvt_pk_bf16_f32 v34, v36, v37
  v_mfma_f32_16x16x32_bf16 v[236:239], v[44:47], a[208:211], v[236:239]
  s_add_u32 m0, s31, s52
  ds_read_b64_tr_b16 v[42:43], v6 offset:8192
  v_cvt_pk_bf16_f32 v35, v38, v39
  v_mfma_f32_16x16x32_bf16 v[240:243], v[44:47], a[212:215], v[240:243]
  s_waitcnt lgkmcnt(4)
  buffer_load_dwordx4 v11, s[12:15], s28 offen offset:256 lds
  v_mfma_f32_16x16x32_bf16 v[148:151], v[48:51], a[204:207], v[148:151]
  ds_read_b64_tr_b16 v[44:45], v7 offset:0
  v_accvgpr_write_b32 a72, v32
  v_mfma_f32_16x16x32_bf16 v[152:155], v[48:51], a[208:211], v[152:155]
  ds_read_b64_tr_b16 v[46:47], v7 offset:8192
  v_accvgpr_write_b32 a73, v33
  v_mfma_f32_16x16x32_bf16 v[156:159], v[48:51], a[212:215], v[156:159]
  s_waitcnt lgkmcnt(4)
  v_accvgpr_write_b32 a74, v34
  v_accvgpr_write_b32 a75, v35
  v_mfma_f32_16x16x32_bf16 v[244:247], v[52:55], a[204:207], v[244:247]
  ds_read_b64_tr_b16 v[48:49], v6 offset:512
  v_accvgpr_read_b32 v24, a76
  v_mfma_f32_16x16x32_bf16 v[248:251], v[52:55], a[208:211], v[248:251]
  s_add_u32 m0, s31, s53
  ds_read_b64_tr_b16 v[50:51], v6 offset:8704
  v_accvgpr_read_b32 v25, a77
  v_mfma_f32_16x16x32_bf16 v[252:255], v[52:55], a[212:215], v[252:255]
  s_waitcnt lgkmcnt(4)
  buffer_load_dwordx4 v11, s[12:15], s28 offen offset:384 lds
  v_mfma_f32_16x16x32_bf16 v[64:67], v[40:43], a[216:219], v[64:67]
  s_add_u32 s40, s40, 128
  ds_read_b64_tr_b16 v[52:53], v7 offset:512
  v_accvgpr_read_b32 v26, a78
  v_mfma_f32_16x16x32_bf16 v[68:71], v[40:43], a[220:223], v[68:71]
  s_waitcnt vmcnt(4)
  ds_read_b64_tr_b16 v[54:55], v7 offset:8704
  v_accvgpr_read_b32 v27, a79
  v_mfma_f32_16x16x32_bf16 v[72:75], v[40:43], a[224:227], v[72:75]
  s_waitcnt lgkmcnt(4)
  ds_read_b128 a[228:231], v14 offset:0
  v_accvgpr_read_b32 v28, a88
  v_mfma_f32_16x16x32_bf16 v[160:163], v[44:47], a[216:219], v[160:163]
  s_cmp_eq_u32 s40, 896
  s_cselect_b32 s40, 0, s40
  ds_read_b64_tr_b16 v[40:41], v6 offset:1024
  v_mfma_f32_16x16x32_bf16 v[164:167], v[44:47], a[220:223], v[164:167]
  s_add_u32 s54, s40, 14336
  ds_read_b64_tr_b16 v[42:43], v6 offset:9216
  v_accvgpr_read_b32 v29, a89
  v_mfma_f32_16x16x32_bf16 v[168:171], v[44:47], a[224:227], v[168:171]
  s_waitcnt lgkmcnt(5)
  ds_read_b128 a[232:235], v14 offset:1024
  v_accvgpr_read_b32 v30, a90
  v_mfma_f32_16x16x32_bf16 v[76:79], v[48:51], a[216:219], v[76:79]
  s_add_u32 s55, s40, 28672
  ds_read_b64_tr_b16 v[44:45], v7 offset:1024
  v_accvgpr_read_b32 v31, a91
  v_mfma_f32_16x16x32_bf16 v[80:83], v[48:51], a[220:223], v[80:83]
  s_add_u32 s35, s35, 262144
  ds_read_b64_tr_b16 v[46:47], v7 offset:9216
  v_mul_f32 v24, v24, v58
  v_mfma_f32_16x16x32_bf16 v[84:87], v[48:51], a[224:227], v[84:87]
  s_waitcnt lgkmcnt(6)
  ds_read_b128 a[236:239], v14 offset:2048
  v_mul_f32 v25, v25, v58
  v_mfma_f32_16x16x32_bf16 v[172:175], v[52:55], a[216:219], v[172:175]
  s_cmp_eq_u32 s35, 3670016
  s_cselect_b32 s35, 0, s35
  ds_read_b64_tr_b16 v[48:49], v6 offset:1536
  v_mfma_f32_16x16x32_bf16 v[176:179], v[52:55], a[220:223], v[176:179]
  s_add_u32 s31, s31, 16384
  s_and_b32 s31, s31, 65535
  ds_read_b64_tr_b16 v[50:51], v6 offset:9728
  v_mfma_f32_16x16x32_bf16 v[180:183], v[52:55], a[224:227], v[180:183]
  s_waitcnt lgkmcnt(6)
  v_mul_f32 v26, v26, v58
  v_mul_f32 v27, v27, v58
  v_mfma_f32_16x16x32_bf16 v[88:91], v[40:43], a[216:219], v[88:91]
  s_waitcnt lgkmcnt(2)
  ds_read_b64_tr_b16 v[52:53], v7 offset:1536
  v_mul_f32 v28, v28, v58
  v_mfma_f32_16x16x32_bf16 v[92:95], v[40:43], a[220:223], v[92:95]
  s_add_u32 m0, s39, 64
  ds_read_b64_tr_b16 v[54:55], v7 offset:9728
  v_mul_f32 v29, v29, v58
  v_mfma_f32_16x16x32_bf16 v[96:99], v[40:43], a[224:227], v[96:99]
  s_waitcnt lgkmcnt(5)
  buffer_load_dwordx4 v21, s[16:19], s40 offen offset:0 lds
  v_mfma_f32_16x16x32_bf16 v[184:187], v[44:47], a[216:219], v[184:187]
  s_add_u32 s28, s35, s36
  ds_read_b64_tr_b16 v[40:41], v6 offset:2048
  v_mul_f32 v30, v30, v58
  v_mfma_f32_16x16x32_bf16 v[188:191], v[44:47], a[220:223], v[188:191]
  s_add_u32 m0, s39, 1088
  ds_read_b64_tr_b16 v[42:43], v6 offset:10240
  v_mul_f32 v31, v31, v58
  v_mfma_f32_16x16x32_bf16 v[192:195], v[44:47], a[224:227], v[192:195]
  s_waitcnt lgkmcnt(4)
  buffer_load_dwordx4 v21, s[16:19], s54 offen offset:0 lds
  v_mfma_f32_16x16x32_bf16 v[100:103], v[48:51], a[216:219], v[100:103]
  ds_read_b64_tr_b16 v[44:45], v7 offset:2048
  v_cvt_pk_bf16_f32 v24, v24, v25
  v_mfma_f32_16x16x32_bf16 v[104:107], v[48:51], a[220:223], v[104:107]
  s_add_u32 m0, s39, 2112
  ds_read_b64_tr_b16 v[46:47], v7 offset:10240
  v_cvt_pk_bf16_f32 v25, v26, v27
  v_mfma_f32_16x16x32_bf16 v[108:111], v[48:51], a[224:227], v[108:111]
  s_waitcnt lgkmcnt(4)
  buffer_load_dwordx4 v21, s[16:19], s55 offen offset:0 lds
  v_mfma_f32_16x16x32_bf16 v[196:199], v[52:55], a[216:219], v[196:199]
  ds_read_b64_tr_b16 v[48:49], v6 offset:2560
  v_cvt_pk_bf16_f32 v26, v28, v29
  v_mfma_f32_16x16x32_bf16 v[200:203], v[52:55], a[220:223], v[200:203]
  ds_read_b64_tr_b16 v[50:51], v6 offset:10752
  v_cvt_pk_bf16_f32 v27, v30, v31
  v_mfma_f32_16x16x32_bf16 v[204:207], v[52:55], a[224:227], v[204:207]
  s_waitcnt lgkmcnt(4)
  v_accvgpr_write_b32 a76, v24
  v_accvgpr_write_b32 a77, v25
  v_mfma_f32_16x16x32_bf16 v[112:115], v[40:43], a[216:219], v[112:115]
  s_waitcnt vmcnt(13)
  ds_read_b64_tr_b16 v[52:53], v7 offset:2560
  v_accvgpr_write_b32 a78, v26
  v_mfma_f32_16x16x32_bf16 v[116:119], v[40:43], a[220:223], v[116:119]
  s_barrier
  ds_read_b64_tr_b16 v[54:55], v7 offset:10752
  v_accvgpr_write_b32 a79, v27
  v_mfma_f32_16x16x32_bf16 v[120:123], v[40:43], a[224:227], v[120:123]
  s_waitcnt lgkmcnt(4)
  v_accvgpr_read_b32 v32, a80
  v_accvgpr_read_b32 v33, a81
  v_mfma_f32_16x16x32_bf16 v[208:211], v[44:47], a[216:219], v[208:211]
  ds_read_b64_tr_b16 v[40:41], v6 offset:3072
  v_accvgpr_read_b32 v34, a82
  v_mfma_f32_16x16x32_bf16 v[212:215], v[44:47], a[220:223], v[212:215]
  s_add_u32 m0, s31, s50
  ds_read_b64_tr_b16 v[42:43], v6 offset:11264
  v_accvgpr_read_b32 v35, a83
  v_mfma_f32_16x16x32_bf16 v[216:219], v[44:47], a[224:227], v[216:219]
  s_waitcnt lgkmcnt(4)
  buffer_load_dwordx4 v11, s[12:15], s28 offen offset:0 lds
  v_mfma_f32_16x16x32_bf16 v[124:127], v[48:51], a[216:219], v[124:127]
  s_add_u32 s34, s34, 16384
  ds_read_b64_tr_b16 v[44:45], v7 offset:3072
  v_accvgpr_read_b32 v36, a92
  v_mfma_f32_16x16x32_bf16 v[128:131], v[48:51], a[220:223], v[128:131]
  ds_read_b64_tr_b16 v[46:47], v7 offset:11264
  v_accvgpr_read_b32 v37, a93
  v_mfma_f32_16x16x32_bf16 v[132:135], v[48:51], a[224:227], v[132:135]
  s_waitcnt lgkmcnt(4)
  v_accvgpr_read_b32 v38, a94
  v_accvgpr_read_b32 v39, a95
  v_mfma_f32_16x16x32_bf16 v[220:223], v[52:55], a[216:219], v[220:223]
  s_and_b32 s34, s34, 65535
  ds_read_b64_tr_b16 v[48:49], v6 offset:3584
  v_mul_f32 v32, v32, v60
  v_mfma_f32_16x16x32_bf16 v[224:227], v[52:55], a[220:223], v[224:227]
  s_add_u32 m0, s31, s51
  ds_read_b64_tr_b16 v[50:51], v6 offset:11776
  v_mul_f32 v33, v33, v60
  v_mfma_f32_16x16x32_bf16 v[228:231], v[52:55], a[224:227], v[228:231]
  s_waitcnt lgkmcnt(4)
  buffer_load_dwordx4 v11, s[12:15], s28 offen offset:128 lds
  v_mfma_f32_16x16x32_bf16 v[136:139], v[40:43], a[216:219], v[136:139]
  ds_read_b64_tr_b16 v[52:53], v7 offset:3584
  v_add_u32 v6, s34, v3
  v_mfma_f32_16x16x32_bf16 v[140:143], v[40:43], a[220:223], v[140:143]
  ds_read_b64_tr_b16 v[54:55], v7 offset:11776
  v_add_u32 v7, s34, v4
  v_mfma_f32_16x16x32_bf16 v[144:147], v[40:43], a[224:227], v[144:147]
  s_waitcnt lgkmcnt(4)
  v_mul_f32 v34, v34, v60
  v_mul_f32 v35, v35, v60
  v_mfma_f32_16x16x32_bf16 v[232:235], v[44:47], a[216:219], v[232:235]
  ds_read_b64_tr_b16 v[40:41], v6 offset:0
  v_mul_f32 v36, v36, v60
  v_mfma_f32_16x16x32_bf16 v[236:239], v[44:47], a[220:223], v[236:239]
  s_add_u32 m0, s31, s52
  ds_read_b64_tr_b16 v[42:43], v6 offset:8192
  v_mul_f32 v37, v37, v60
  v_mfma_f32_16x16x32_bf16 v[240:243], v[44:47], a[224:227], v[240:243]
  s_waitcnt lgkmcnt(4)
  buffer_load_dwordx4 v11, s[12:15], s28 offen offset:256 lds
  v_mfma_f32_16x16x32_bf16 v[148:151], v[48:51], a[216:219], v[148:151]
  ds_read_b64_tr_b16 v[44:45], v7 offset:0
  v_mul_f32 v38, v38, v60
  v_mfma_f32_16x16x32_bf16 v[152:155], v[48:51], a[220:223], v[152:155]
  ds_read_b64_tr_b16 v[46:47], v7 offset:8192
  v_mul_f32 v39, v39, v60
  v_mfma_f32_16x16x32_bf16 v[156:159], v[48:51], a[224:227], v[156:159]
  s_waitcnt lgkmcnt(4)
  v_cvt_pk_bf16_f32 v32, v32, v33
  v_cvt_pk_bf16_f32 v33, v34, v35
  v_mfma_f32_16x16x32_bf16 v[244:247], v[52:55], a[216:219], v[244:247]
  ds_read_b64_tr_b16 v[48:49], v6 offset:512
  v_cvt_pk_bf16_f32 v34, v36, v37
  v_mfma_f32_16x16x32_bf16 v[248:251], v[52:55], a[220:223], v[248:251]
  s_add_u32 m0, s31, s53
  ds_read_b64_tr_b16 v[50:51], v6 offset:8704
  v_cvt_pk_bf16_f32 v35, v38, v39
  v_mfma_f32_16x16x32_bf16 v[252:255], v[52:55], a[224:227], v[252:255]
  s_waitcnt lgkmcnt(4)
  buffer_load_dwordx4 v11, s[12:15], s28 offen offset:384 lds
  v_mfma_f32_16x16x32_bf16 v[64:67], v[40:43], a[228:231], v[64:67]
  s_add_u32 s35, s35, 262144
  ds_read_b64_tr_b16 v[52:53], v7 offset:512
  v_accvgpr_write_b32 a80, v32
  v_mfma_f32_16x16x32_bf16 v[68:71], v[40:43], a[232:235], v[68:71]
  s_waitcnt vmcnt(4)
  ds_read_b64_tr_b16 v[54:55], v7 offset:8704
  v_accvgpr_write_b32 a81, v33
  v_mfma_f32_16x16x32_bf16 v[72:75], v[40:43], a[236:239], v[72:75]
  s_waitcnt lgkmcnt(4)
  ds_read_b128 a[216:219], v14 offset:0
  v_accvgpr_write_b32 a82, v34
  v_mfma_f32_16x16x32_bf16 v[160:163], v[44:47], a[228:231], v[160:163]
  s_cmp_eq_u32 s35, 3670016
  s_cselect_b32 s35, 0, s35
  ds_read_b64_tr_b16 v[40:41], v6 offset:1024
  v_mfma_f32_16x16x32_bf16 v[164:167], v[44:47], a[232:235], v[164:167]
  s_add_u32 s31, s31, 16384
  s_and_b32 s31, s31, 65535
  ds_read_b64_tr_b16 v[42:43], v6 offset:9216
  v_mfma_f32_16x16x32_bf16 v[168:171], v[44:47], a[236:239], v[168:171]
  s_waitcnt lgkmcnt(5)
  ds_read_b128 a[220:223], v14 offset:1024
  v_accvgpr_write_b32 a83, v35
  v_mfma_f32_16x16x32_bf16 v[76:79], v[48:51], a[228:231], v[76:79]
  s_add_u32 s28, s35, s36
  ds_read_b64_tr_b16 v[44:45], v7 offset:1024
  v_accvgpr_read_b32 v24, a96
  v_mfma_f32_16x16x32_bf16 v[80:83], v[48:51], a[232:235], v[80:83]
  ds_read_b64_tr_b16 v[46:47], v7 offset:9216
  v_accvgpr_read_b32 v25, a97
  v_mfma_f32_16x16x32_bf16 v[84:87], v[48:51], a[236:239], v[84:87]
  s_waitcnt lgkmcnt(6)
  ds_read_b128 a[224:227], v14 offset:2048
  v_accvgpr_read_b32 v26, a98
  v_mfma_f32_16x16x32_bf16 v[172:175], v[52:55], a[228:231], v[172:175]
  ds_read_b64_tr_b16 v[48:49], v6 offset:1536
  v_accvgpr_read_b32 v27, a99
  v_mfma_f32_16x16x32_bf16 v[176:179], v[52:55], a[232:235], v[176:179]
  ds_read_b64_tr_b16 v[50:51], v6 offset:9728
  v_accvgpr_read_b32 v28, a108
  v_mfma_f32_16x16x32_bf16 v[180:183], v[52:55], a[236:239], v[180:183]
  s_waitcnt lgkmcnt(6)
  v_accvgpr_read_b32 v29, a109
  v_accvgpr_read_b32 v30, a110
  v_mfma_f32_16x16x32_bf16 v[88:91], v[40:43], a[228:231], v[88:91]
  s_waitcnt lgkmcnt(2)
  ds_read_b64_tr_b16 v[52:53], v7 offset:1536
  v_accvgpr_read_b32 v31, a111
  v_mfma_f32_16x16x32_bf16 v[92:95], v[40:43], a[232:235], v[92:95]
  s_add_u32 m0, s39, 0
  ds_read_b64_tr_b16 v[54:55], v7 offset:9728
  v_mul_f32 v24, v24, v56
  v_mfma_f32_16x16x32_bf16 v[96:99], v[40:43], a[236:239], v[96:99]
  s_waitcnt lgkmcnt(5)
  buffer_load_dwordx4 v21, s[16:19], s40 offen offset:64 lds
  v_mfma_f32_16x16x32_bf16 v[184:187], v[44:47], a[228:231], v[184:187]
  ds_read_b64_tr_b16 v[40:41], v6 offset:2048
  v_mul_f32 v25, v25, v56
  v_mfma_f32_16x16x32_bf16 v[188:191], v[44:47], a[232:235], v[188:191]
  s_add_u32 m0, s39, 1024
  ds_read_b64_tr_b16 v[42:43], v6 offset:10240
  v_mul_f32 v26, v26, v56
  v_mfma_f32_16x16x32_bf16 v[192:195], v[44:47], a[236:239], v[192:195]
  s_waitcnt lgkmcnt(4)
  buffer_load_dwordx4 v21, s[16:19], s54 offen offset:64 lds
  v_mfma_f32_16x16x32_bf16 v[100:103], v[48:51], a[228:231], v[100:103]
  ds_read_b64_tr_b16 v[44:45], v7 offset:2048
  v_mul_f32 v27, v27, v56
  v_mfma_f32_16x16x32_bf16 v[104:107], v[48:51], a[232:235], v[104:107]
  s_add_u32 m0, s39, 2048
  ds_read_b64_tr_b16 v[46:47], v7 offset:10240
  v_mul_f32 v28, v28, v56
  v_mfma_f32_16x16x32_bf16 v[108:111], v[48:51], a[236:239], v[108:111]
  s_waitcnt lgkmcnt(4)
  buffer_load_dwordx4 v21, s[16:19], s55 offen offset:64 lds
  v_mfma_f32_16x16x32_bf16 v[196:199], v[52:55], a[228:231], v[196:199]
  ds_read_b64_tr_b16 v[48:49], v6 offset:2560
  v_mul_f32 v29, v29, v56
  v_mfma_f32_16x16x32_bf16 v[200:203], v[52:55], a[232:235], v[200:203]
  ds_read_b64_tr_b16 v[50:51], v6 offset:10752
  v_mul_f32 v30, v30, v56
  v_mfma_f32_16x16x32_bf16 v[204:207], v[52:55], a[236:239], v[204:207]
  s_waitcnt lgkmcnt(4)
  v_mul_f32 v31, v31, v56
  v_cvt_pk_bf16_f32 v24, v24, v25
  v_mfma_f32_16x16x32_bf16 v[112:115], v[40:43], a[228:231], v[112:115]
  s_waitcnt vmcnt(10)
  ds_read_b64_tr_b16 v[52:53], v7 offset:2560
  v_cvt_pk_bf16_f32 v25, v26, v27
  v_mfma_f32_16x16x32_bf16 v[116:119], v[40:43], a[232:235], v[116:119]
  s_barrier
  ds_read_b64_tr_b16 v[54:55], v7 offset:10752
  v_cvt_pk_bf16_f32 v26, v28, v29
  v_mfma_f32_16x16x32_bf16 v[120:123], v[40:43], a[236:239], v[120:123]
  s_waitcnt lgkmcnt(4)
  v_cvt_pk_bf16_f32 v27, v30, v31
  v_accvgpr_write_b32 a240, v24
  v_mfma_f32_16x16x32_bf16 v[208:211], v[44:47], a[228:231], v[208:211]
  ds_read_b64_tr_b16 v[40:41], v6 offset:3072
  v_accvgpr_write_b32 a241, v25
  v_mfma_f32_16x16x32_bf16 v[212:215], v[44:47], a[232:235], v[212:215]
  s_add_u32 m0, s31, s50
  ds_read_b64_tr_b16 v[42:43], v6 offset:11264
  v_accvgpr_write_b32 a242, v26
  v_mfma_f32_16x16x32_bf16 v[216:219], v[44:47], a[236:239], v[216:219]
  s_waitcnt lgkmcnt(4)
  buffer_load_dwordx4 v11, s[12:15], s28 offen offset:0 lds
  v_mfma_f32_16x16x32_bf16 v[124:127], v[48:51], a[228:231], v[124:127]
  s_add_u32 s34, s34, 16384
  ds_read_b64_tr_b16 v[44:45], v7 offset:3072
  v_accvgpr_write_b32 a243, v27
  v_mfma_f32_16x16x32_bf16 v[128:131], v[48:51], a[232:235], v[128:131]
  ds_read_b64_tr_b16 v[46:47], v7 offset:11264
  v_accvgpr_read_b32 v32, a100
  v_mfma_f32_16x16x32_bf16 v[132:135], v[48:51], a[236:239], v[132:135]
  s_waitcnt lgkmcnt(4)
  v_accvgpr_read_b32 v33, a101
  v_accvgpr_read_b32 v34, a102
  v_mfma_f32_16x16x32_bf16 v[220:223], v[52:55], a[228:231], v[220:223]
  s_and_b32 s34, s34, 65535
  ds_read_b64_tr_b16 v[48:49], v6 offset:3584
  v_accvgpr_read_b32 v35, a103
  v_mfma_f32_16x16x32_bf16 v[224:227], v[52:55], a[232:235], v[224:227]
  s_add_u32 m0, s31, s51
  ds_read_b64_tr_b16 v[50:51], v6 offset:11776
  v_accvgpr_read_b32 v36, a112
  v_mfma_f32_16x16x32_bf16 v[228:231], v[52:55], a[236:239], v[228:231]
  s_waitcnt lgkmcnt(4)
  buffer_load_dwordx4 v11, s[12:15], s28 offen offset:128 lds
  v_mfma_f32_16x16x32_bf16 v[136:139], v[40:43], a[228:231], v[136:139]
  ds_read_b64_tr_b16 v[52:53], v7 offset:3584
  v_add_u32 v6, s34, v3
  v_mfma_f32_16x16x32_bf16 v[140:143], v[40:43], a[232:235], v[140:143]
  ds_read_b64_tr_b16 v[54:55], v7 offset:11776
  v_add_u32 v7, s34, v4
  v_mfma_f32_16x16x32_bf16 v[144:147], v[40:43], a[236:239], v[144:147]
  s_waitcnt lgkmcnt(4)
  v_accvgpr_read_b32 v37, a113
  v_accvgpr_read_b32 v38, a114
  v_mfma_f32_16x16x32_bf16 v[232:235], v[44:47], a[228:231], v[232:235]
  ds_read_b64_tr_b16 v[40:41], v6 offset:0
  v_accvgpr_read_b32 v39, a115
  v_mfma_f32_16x16x32_bf16 v[236:239], v[44:47], a[232:235], v[236:239]
  s_add_u32 m0, s31, s52
  ds_read_b64_tr_b16 v[42:43], v6 offset:8192
  v_mul_f32 v32, v32, v58
  v_mfma_f32_16x16x32_bf16 v[240:243], v[44:47], a[236:239], v[240:243]
  s_waitcnt lgkmcnt(4)
  buffer_load_dwordx4 v11, s[12:15], s28 offen offset:256 lds
  v_mfma_f32_16x16x32_bf16 v[148:151], v[48:51], a[228:231], v[148:151]
  ds_read_b64_tr_b16 v[44:45], v7 offset:0
  v_mul_f32 v33, v33, v58
  v_mfma_f32_16x16x32_bf16 v[152:155], v[48:51], a[232:235], v[152:155]
  ds_read_b64_tr_b16 v[46:47], v7 offset:8192
  v_mul_f32 v34, v34, v58
  v_mfma_f32_16x16x32_bf16 v[156:159], v[48:51], a[236:239], v[156:159]
  s_waitcnt lgkmcnt(4)
  v_mul_f32 v35, v35, v58
  v_mul_f32 v36, v36, v58
  v_mfma_f32_16x16x32_bf16 v[244:247], v[52:55], a[228:231], v[244:247]
  ds_read_b64_tr_b16 v[48:49], v6 offset:512
  v_mul_f32 v37, v37, v58
  v_mfma_f32_16x16x32_bf16 v[248:251], v[52:55], a[232:235], v[248:251]
  s_add_u32 m0, s31, s53
  ds_read_b64_tr_b16 v[50:51], v6 offset:8704
  v_mul_f32 v38, v38, v58
  v_mfma_f32_16x16x32_bf16 v[252:255], v[52:55], a[236:239], v[252:255]
  s_waitcnt lgkmcnt(4)
  buffer_load_dwordx4 v11, s[12:15], s28 offen offset:384 lds
  v_mfma_f32_16x16x32_bf16 v[64:67], v[40:43], a[216:219], v[64:67]
  s_add_u32 s40, s40, 128
  ds_read_b64_tr_b16 v[52:53], v7 offset:512
  v_mul_f32 v39, v39, v58
  v_mfma_f32_16x16x32_bf16 v[68:71], v[40:43], a[220:223], v[68:71]
  s_waitcnt vmcnt(4)
  ds_read_b64_tr_b16 v[54:55], v7 offset:8704
  v_cvt_pk_bf16_f32 v32, v32, v33
  v_mfma_f32_16x16x32_bf16 v[72:75], v[40:43], a[224:227], v[72:75]
  s_waitcnt lgkmcnt(4)
  ds_read_b128 a[228:231], v14 offset:0
  v_cvt_pk_bf16_f32 v33, v34, v35
  v_mfma_f32_16x16x32_bf16 v[160:163], v[44:47], a[216:219], v[160:163]
  s_cmp_eq_u32 s40, 896
  s_cselect_b32 s40, 0, s40
  ds_read_b64_tr_b16 v[40:41], v6 offset:1024
  v_mfma_f32_16x16x32_bf16 v[164:167], v[44:47], a[220:223], v[164:167]
  s_add_u32 s54, s40, 14336
  ds_read_b64_tr_b16 v[42:43], v6 offset:9216
  v_cvt_pk_bf16_f32 v34, v36, v37
  v_mfma_f32_16x16x32_bf16 v[168:171], v[44:47], a[224:227], v[168:171]
  s_waitcnt lgkmcnt(5)
  ds_read_b128 a[232:235], v14 offset:1024
  v_cvt_pk_bf16_f32 v35, v38, v39
  v_mfma_f32_16x16x32_bf16 v[76:79], v[48:51], a[216:219], v[76:79]
  s_add_u32 s55, s40, 28672
  ds_read_b64_tr_b16 v[44:45], v7 offset:1024
  v_accvgpr_write_b32 a244, v32
  v_mfma_f32_16x16x32_bf16 v[80:83], v[48:51], a[220:223], v[80:83]
  s_add_u32 s35, s35, 262144
  ds_read_b64_tr_b16 v[46:47], v7 offset:9216
  v_accvgpr_write_b32 a245, v33
  v_mfma_f32_16x16x32_bf16 v[84:87], v[48:51], a[224:227], v[84:87]
  s_waitcnt lgkmcnt(6)
  ds_read_b128 a[236:239], v14 offset:2048
  v_accvgpr_write_b32 a246, v34
  v_mfma_f32_16x16x32_bf16 v[172:175], v[52:55], a[216:219], v[172:175]
  s_cmp_eq_u32 s35, 3670016
  s_cselect_b32 s35, 0, s35
  ds_read_b64_tr_b16 v[48:49], v6 offset:1536
  v_mfma_f32_16x16x32_bf16 v[176:179], v[52:55], a[220:223], v[176:179]
  s_add_u32 s31, s31, 16384
  s_and_b32 s31, s31, 65535
  ds_read_b64_tr_b16 v[50:51], v6 offset:9728
  v_mfma_f32_16x16x32_bf16 v[180:183], v[52:55], a[224:227], v[180:183]
  s_waitcnt lgkmcnt(6)
  v_accvgpr_write_b32 a247, v35
  v_accvgpr_read_b32 v24, a104
  v_mfma_f32_16x16x32_bf16 v[88:91], v[40:43], a[216:219], v[88:91]
  s_waitcnt lgkmcnt(2)
  ds_read_b64_tr_b16 v[52:53], v7 offset:1536
  v_accvgpr_read_b32 v25, a105
  v_mfma_f32_16x16x32_bf16 v[92:95], v[40:43], a[220:223], v[92:95]
  s_add_u32 m0, s39, 64
  ds_read_b64_tr_b16 v[54:55], v7 offset:9728
  v_accvgpr_read_b32 v26, a106
  v_mfma_f32_16x16x32_bf16 v[96:99], v[40:43], a[224:227], v[96:99]
  s_waitcnt lgkmcnt(5)
  buffer_load_dwordx4 v21, s[16:19], s40 offen offset:0 lds
  v_mfma_f32_16x16x32_bf16 v[184:187], v[44:47], a[216:219], v[184:187]
  s_add_u32 s28, s35, s36
  ds_read_b64_tr_b16 v[40:41], v6 offset:2048
  v_accvgpr_read_b32 v27, a107
  v_mfma_f32_16x16x32_bf16 v[188:191], v[44:47], a[220:223], v[188:191]
  s_add_u32 m0, s39, 1088
  ds_read_b64_tr_b16 v[42:43], v6 offset:10240
  v_accvgpr_read_b32 v28, a116
  v_mfma_f32_16x16x32_bf16 v[192:195], v[44:47], a[224:227], v[192:195]
  s_waitcnt lgkmcnt(4)
  buffer_load_dwordx4 v21, s[16:19], s54 offen offset:0 lds
  v_mfma_f32_16x16x32_bf16 v[100:103], v[48:51], a[216:219], v[100:103]
  ds_read_b64_tr_b16 v[44:45], v7 offset:2048
  v_accvgpr_read_b32 v29, a117
  v_mfma_f32_16x16x32_bf16 v[104:107], v[48:51], a[220:223], v[104:107]
  s_add_u32 m0, s39, 2112
  ds_read_b64_tr_b16 v[46:47], v7 offset:10240
  v_accvgpr_read_b32 v30, a118
  v_mfma_f32_16x16x32_bf16 v[108:111], v[48:51], a[224:227], v[108:111]
  s_waitcnt lgkmcnt(4)
  buffer_load_dwordx4 v21, s[16:19], s55 offen offset:0 lds
  v_mfma_f32_16x16x32_bf16 v[196:199], v[52:55], a[216:219], v[196:199]
  ds_read_b64_tr_b16 v[48:49], v6 offset:2560
  v_accvgpr_read_b32 v31, a119
  v_mfma_f32_16x16x32_bf16 v[200:203], v[52:55], a[220:223], v[200:203]
  ds_read_b64_tr_b16 v[50:51], v6 offset:10752
  v_mul_f32 v24, v24, v60
  v_mfma_f32_16x16x32_bf16 v[204:207], v[52:55], a[224:227], v[204:207]
  s_waitcnt lgkmcnt(4)
  v_mul_f32 v25, v25, v60
  v_mul_f32 v26, v26, v60
  v_mfma_f32_16x16x32_bf16 v[112:115], v[40:43], a[216:219], v[112:115]
  s_waitcnt vmcnt(10)
  ds_read_b64_tr_b16 v[52:53], v7 offset:2560
  v_mul_f32 v27, v27, v60
  v_mfma_f32_16x16x32_bf16 v[116:119], v[40:43], a[220:223], v[116:119]
  s_barrier
  ds_read_b64_tr_b16 v[54:55], v7 offset:10752
  v_mul_f32 v28, v28, v60
  v_mfma_f32_16x16x32_bf16 v[120:123], v[40:43], a[224:227], v[120:123]
  s_waitcnt lgkmcnt(4)
  v_mul_f32 v29, v29, v60
  v_mul_f32 v30, v30, v60
  v_mfma_f32_16x16x32_bf16 v[208:211], v[44:47], a[216:219], v[208:211]
  ds_read_b64_tr_b16 v[40:41], v6 offset:3072
  v_mul_f32 v31, v31, v60
  v_mfma_f32_16x16x32_bf16 v[212:215], v[44:47], a[220:223], v[212:215]
  s_add_u32 m0, s31, s50
  ds_read_b64_tr_b16 v[42:43], v6 offset:11264
  v_cvt_pk_bf16_f32 v24, v24, v25
  v_mfma_f32_16x16x32_bf16 v[216:219], v[44:47], a[224:227], v[216:219]
  s_waitcnt lgkmcnt(4)
  buffer_load_dwordx4 v11, s[12:15], s28 offen offset:0 lds
  v_mfma_f32_16x16x32_bf16 v[124:127], v[48:51], a[216:219], v[124:127]
  s_add_u32 s34, s34, 16384
  ds_read_b64_tr_b16 v[44:45], v7 offset:3072
  v_cvt_pk_bf16_f32 v25, v26, v27
  v_mfma_f32_16x16x32_bf16 v[128:131], v[48:51], a[220:223], v[128:131]
  ds_read_b64_tr_b16 v[46:47], v7 offset:11264
  v_cvt_pk_bf16_f32 v26, v28, v29
  v_mfma_f32_16x16x32_bf16 v[132:135], v[48:51], a[224:227], v[132:135]
  s_waitcnt lgkmcnt(4)
  v_cvt_pk_bf16_f32 v27, v30, v31
  v_accvgpr_write_b32 a248, v24
  v_mfma_f32_16x16x32_bf16 v[220:223], v[52:55], a[216:219], v[220:223]
  s_and_b32 s34, s34, 65535
  ds_read_b64_tr_b16 v[48:49], v6 offset:3584
  v_accvgpr_write_b32 a249, v25
  v_mfma_f32_16x16x32_bf16 v[224:227], v[52:55], a[220:223], v[224:227]
  s_add_u32 m0, s31, s51
  ds_read_b64_tr_b16 v[50:51], v6 offset:11776
  v_accvgpr_write_b32 a250, v26
  v_mfma_f32_16x16x32_bf16 v[228:231], v[52:55], a[224:227], v[228:231]
  s_waitcnt lgkmcnt(4)
  buffer_load_dwordx4 v11, s[12:15], s28 offen offset:128 lds
  v_mfma_f32_16x16x32_bf16 v[136:139], v[40:43], a[216:219], v[136:139]
  ds_read_b64_tr_b16 v[52:53], v7 offset:3584
  v_add_u32 v6, s34, v3
  v_mfma_f32_16x16x32_bf16 v[140:143], v[40:43], a[220:223], v[140:143]
  ds_read_b64_tr_b16 v[54:55], v7 offset:11776
  v_add_u32 v7, s34, v4
  v_mfma_f32_16x16x32_bf16 v[144:147], v[40:43], a[224:227], v[144:147]
  s_waitcnt lgkmcnt(4)
  v_accvgpr_write_b32 a251, v27
  v_accvgpr_read_b32 v32, a120
  v_mfma_f32_16x16x32_bf16 v[232:235], v[44:47], a[216:219], v[232:235]
  ds_read_b64_tr_b16 v[40:41], v6 offset:0
  v_accvgpr_read_b32 v33, a121
  v_mfma_f32_16x16x32_bf16 v[236:239], v[44:47], a[220:223], v[236:239]
  s_add_u32 m0, s31, s52
  ds_read_b64_tr_b16 v[42:43], v6 offset:8192
  v_accvgpr_read_b32 v34, a122
  v_mfma_f32_16x16x32_bf16 v[240:243], v[44:47], a[224:227], v[240:243]
  s_waitcnt lgkmcnt(4)
  buffer_load_dwordx4 v11, s[12:15], s28 offen offset:256 lds
  v_mfma_f32_16x16x32_bf16 v[148:151], v[48:51], a[216:219], v[148:151]
  ds_read_b64_tr_b16 v[44:45], v7 offset:0
  v_accvgpr_read_b32 v35, a123
  v_mfma_f32_16x16x32_bf16 v[152:155], v[48:51], a[220:223], v[152:155]
  ds_read_b64_tr_b16 v[46:47], v7 offset:8192
  v_accvgpr_read_b32 v36, a132
  v_mfma_f32_16x16x32_bf16 v[156:159], v[48:51], a[224:227], v[156:159]
  s_waitcnt lgkmcnt(4)
  v_accvgpr_read_b32 v37, a133
  v_accvgpr_read_b32 v38, a134
  v_mfma_f32_16x16x32_bf16 v[244:247], v[52:55], a[216:219], v[244:247]
  ds_read_b64_tr_b16 v[48:49], v6 offset:512
  v_accvgpr_read_b32 v39, a135
  v_mfma_f32_16x16x32_bf16 v[248:251], v[52:55], a[220:223], v[248:251]
  s_add_u32 m0, s31, s53
  ds_read_b64_tr_b16 v[50:51], v6 offset:8704
  v_mul_f32 v32, v32, v56
  v_mfma_f32_16x16x32_bf16 v[252:255], v[52:55], a[224:227], v[252:255]
  s_waitcnt lgkmcnt(4)
  buffer_load_dwordx4 v11, s[12:15], s28 offen offset:384 lds
  v_mfma_f32_16x16x32_bf16 v[64:67], v[40:43], a[228:231], v[64:67]
  s_add_u32 s35, s35, 262144
  ds_read_b64_tr_b16 v[52:53], v7 offset:512
  v_mul_f32 v33, v33, v56
  v_mfma_f32_16x16x32_bf16 v[68:71], v[40:43], a[232:235], v[68:71]
  s_waitcnt vmcnt(4)
  ds_read_b64_tr_b16 v[54:55], v7 offset:8704
  v_mul_f32 v34, v34, v56
  v_mfma_f32_16x16x32_bf16 v[72:75], v[40:43], a[236:239], v[72:75]
  s_waitcnt lgkmcnt(4)
  ds_read_b128 a[216:219], v14 offset:0
  v_mul_f32 v35, v35, v56
  v_mfma_f32_16x16x32_bf16 v[160:163], v[44:47], a[228:231], v[160:163]
  s_cmp_eq_u32 s35, 3670016
  s_cselect_b32 s35, 0, s35
  ds_read_b64_tr_b16 v[40:41], v6 offset:1024
  v_mfma_f32_16x16x32_bf16 v[164:167], v[44:47], a[232:235], v[164:167]
  s_add_u32 s31, s31, 16384
  s_and_b32 s31, s31, 65535
  ds_read_b64_tr_b16 v[42:43], v6 offset:9216
  v_mfma_f32_16x16x32_bf16 v[168:171], v[44:47], a[236:239], v[168:171]
  s_waitcnt lgkmcnt(5)
  ds_read_b128 a[220:223], v14 offset:1024
  v_mul_f32 v36, v36, v56
  v_mfma_f32_16x16x32_bf16 v[76:79], v[48:51], a[228:231], v[76:79]
  s_add_u32 s28, s35, s36
  ds_read_b64_tr_b16 v[44:45], v7 offset:1024
  v_mul_f32 v37, v37, v56
  v_mfma_f32_16x16x32_bf16 v[80:83], v[48:51], a[232:235], v[80:83]
  ds_read_b64_tr_b16 v[46:47], v7 offset:9216
  v_mul_f32 v38, v38, v56
  v_mfma_f32_16x16x32_bf16 v[84:87], v[48:51], a[236:239], v[84:87]
  s_waitcnt lgkmcnt(6)
  ds_read_b128 a[224:227], v14 offset:2048
  v_mul_f32 v39, v39, v56
  v_mfma_f32_16x16x32_bf16 v[172:175], v[52:55], a[228:231], v[172:175]
  ds_read_b64_tr_b16 v[48:49], v6 offset:1536
  v_cvt_pk_bf16_f32 v32, v32, v33
  v_mfma_f32_16x16x32_bf16 v[176:179], v[52:55], a[232:235], v[176:179]
  ds_read_b64_tr_b16 v[50:51], v6 offset:9728
  v_cvt_pk_bf16_f32 v33, v34, v35
  v_mfma_f32_16x16x32_bf16 v[180:183], v[52:55], a[236:239], v[180:183]
  s_waitcnt lgkmcnt(6)
  v_cvt_pk_bf16_f32 v34, v36, v37
  v_cvt_pk_bf16_f32 v35, v38, v39
  v_mfma_f32_16x16x32_bf16 v[88:91], v[40:43], a[228:231], v[88:91]
  s_waitcnt lgkmcnt(2)
  ds_read_b64_tr_b16 v[52:53], v7 offset:1536
  v_accvgpr_write_b32 a252, v32
  v_mfma_f32_16x16x32_bf16 v[92:95], v[40:43], a[232:235], v[92:95]
  s_add_u32 m0, s39, 0
  ds_read_b64_tr_b16 v[54:55], v7 offset:9728
  v_accvgpr_write_b32 a253, v33
  v_mfma_f32_16x16x32_bf16 v[96:99], v[40:43], a[236:239], v[96:99]
  s_waitcnt lgkmcnt(5)
  buffer_load_dwordx4 v21, s[16:19], s40 offen offset:64 lds
  v_mfma_f32_16x16x32_bf16 v[184:187], v[44:47], a[228:231], v[184:187]
  ds_read_b64_tr_b16 v[40:41], v6 offset:2048
  v_accvgpr_write_b32 a254, v34
  v_mfma_f32_16x16x32_bf16 v[188:191], v[44:47], a[232:235], v[188:191]
  s_add_u32 m0, s39, 1024
  ds_read_b64_tr_b16 v[42:43], v6 offset:10240
  v_accvgpr_write_b32 a255, v35
  v_mfma_f32_16x16x32_bf16 v[192:195], v[44:47], a[236:239], v[192:195]
  s_waitcnt lgkmcnt(4)
  buffer_load_dwordx4 v21, s[16:19], s54 offen offset:64 lds
  v_mfma_f32_16x16x32_bf16 v[100:103], v[48:51], a[228:231], v[100:103]
  ds_read_b64_tr_b16 v[44:45], v7 offset:2048
  v_accvgpr_read_b32 v24, a0
  v_mfma_f32_16x16x32_bf16 v[104:107], v[48:51], a[232:235], v[104:107]
  s_add_u32 m0, s39, 2048
  ds_read_b64_tr_b16 v[46:47], v7 offset:10240
  v_accvgpr_read_b32 v25, a1
  v_mfma_f32_16x16x32_bf16 v[108:111], v[48:51], a[236:239], v[108:111]
  s_waitcnt lgkmcnt(4)
  buffer_load_dwordx4 v21, s[16:19], s55 offen offset:64 lds
  v_mfma_f32_16x16x32_bf16 v[196:199], v[52:55], a[228:231], v[196:199]
  ds_read_b64_tr_b16 v[48:49], v6 offset:2560
  v_accvgpr_read_b32 v26, a2
  v_mfma_f32_16x16x32_bf16 v[200:203], v[52:55], a[232:235], v[200:203]
  ds_read_b64_tr_b16 v[50:51], v6 offset:10752
  v_accvgpr_read_b32 v27, a3
  v_mfma_f32_16x16x32_bf16 v[204:207], v[52:55], a[236:239], v[204:207]
  s_waitcnt lgkmcnt(4)
  v_accvgpr_read_b32 v28, a12
  v_accvgpr_read_b32 v29, a13
  v_mfma_f32_16x16x32_bf16 v[112:115], v[40:43], a[228:231], v[112:115]
  s_waitcnt vmcnt(10)
  ds_read_b64_tr_b16 v[52:53], v7 offset:2560
  v_accvgpr_read_b32 v30, a14
  v_mfma_f32_16x16x32_bf16 v[116:119], v[40:43], a[232:235], v[116:119]
  s_barrier
  ds_read_b64_tr_b16 v[54:55], v7 offset:10752
  v_accvgpr_read_b32 v31, a15
  v_mfma_f32_16x16x32_bf16 v[120:123], v[40:43], a[236:239], v[120:123]
  s_waitcnt lgkmcnt(4)
  v_mul_f32 v24, v24, v56
  v_mul_f32 v25, v25, v56
  v_mfma_f32_16x16x32_bf16 v[208:211], v[44:47], a[228:231], v[208:211]
  ds_read_b64_tr_b16 v[40:41], v6 offset:3072
  v_mul_f32 v26, v26, v56
  v_mfma_f32_16x16x32_bf16 v[212:215], v[44:47], a[232:235], v[212:215]
  s_add_u32 m0, s31, s50
  ds_read_b64_tr_b16 v[42:43], v6 offset:11264
  v_mul_f32 v27, v27, v56
  v_mfma_f32_16x16x32_bf16 v[216:219], v[44:47], a[236:239], v[216:219]
  s_waitcnt lgkmcnt(4)
  buffer_load_dwordx4 v11, s[12:15], s28 offen offset:0 lds
  v_mfma_f32_16x16x32_bf16 v[124:127], v[48:51], a[228:231], v[124:127]
  s_add_u32 s34, s34, 16384
  ds_read_b64_tr_b16 v[44:45], v7 offset:3072
  v_mul_f32 v28, v28, v56
  v_mfma_f32_16x16x32_bf16 v[128:131], v[48:51], a[232:235], v[128:131]
  ds_read_b64_tr_b16 v[46:47], v7 offset:11264
  v_mul_f32 v29, v29, v56
  v_mfma_f32_16x16x32_bf16 v[132:135], v[48:51], a[236:239], v[132:135]
  s_waitcnt lgkmcnt(4)
  v_mul_f32 v30, v30, v56
  v_mul_f32 v31, v31, v56
  v_mfma_f32_16x16x32_bf16 v[220:223], v[52:55], a[228:231], v[220:223]
  s_and_b32 s34, s34, 65535
  ds_read_b64_tr_b16 v[48:49], v6 offset:3584
  v_cvt_pk_bf16_f32 v24, v24, v25
  v_mfma_f32_16x16x32_bf16 v[224:227], v[52:55], a[232:235], v[224:227]
  s_add_u32 m0, s31, s51
  ds_read_b64_tr_b16 v[50:51], v6 offset:11776
  v_cvt_pk_bf16_f32 v25, v26, v27
  v_mfma_f32_16x16x32_bf16 v[228:231], v[52:55], a[236:239], v[228:231]
  s_waitcnt lgkmcnt(4)
  buffer_load_dwordx4 v11, s[12:15], s28 offen offset:128 lds
  v_mfma_f32_16x16x32_bf16 v[136:139], v[40:43], a[228:231], v[136:139]
  ds_read_b64_tr_b16 v[52:53], v7 offset:3584
  v_add_u32 v6, s34, v3
  v_mfma_f32_16x16x32_bf16 v[140:143], v[40:43], a[232:235], v[140:143]
  ds_read_b64_tr_b16 v[54:55], v7 offset:11776
  v_add_u32 v7, s34, v4
  v_mfma_f32_16x16x32_bf16 v[144:147], v[40:43], a[236:239], v[144:147]
  s_waitcnt lgkmcnt(4)
  v_cvt_pk_bf16_f32 v26, v28, v29
  v_cvt_pk_bf16_f32 v27, v30, v31
  v_mfma_f32_16x16x32_bf16 v[232:235], v[44:47], a[228:231], v[232:235]
  ds_read_b64_tr_b16 v[40:41], v6 offset:0
  v_accvgpr_write_b32 a0, v24
  v_mfma_f32_16x16x32_bf16 v[236:239], v[44:47], a[232:235], v[236:239]
  s_add_u32 m0, s31, s52
  ds_read_b64_tr_b16 v[42:43], v6 offset:8192
  v_accvgpr_write_b32 a1, v25
  v_mfma_f32_16x16x32_bf16 v[240:243], v[44:47], a[236:239], v[240:243]
  s_waitcnt lgkmcnt(4)
  buffer_load_dwordx4 v11, s[12:15], s28 offen offset:256 lds
  v_mfma_f32_16x16x32_bf16 v[148:151], v[48:51], a[228:231], v[148:151]
  ds_read_b64_tr_b16 v[44:45], v7 offset:0
  v_accvgpr_write_b32 a2, v26
  v_mfma_f32_16x16x32_bf16 v[152:155], v[48:51], a[232:235], v[152:155]
  ds_read_b64_tr_b16 v[46:47], v7 offset:8192
  v_accvgpr_write_b32 a3, v27
  v_mfma_f32_16x16x32_bf16 v[156:159], v[48:51], a[236:239], v[156:159]
  s_waitcnt lgkmcnt(4)
  v_accvgpr_read_b32 v32, a4
  v_accvgpr_read_b32 v33, a5
  v_mfma_f32_16x16x32_bf16 v[244:247], v[52:55], a[228:231], v[244:247]
  ds_read_b64_tr_b16 v[48:49], v6 offset:512
  v_accvgpr_read_b32 v34, a6
  v_mfma_f32_16x16x32_bf16 v[248:251], v[52:55], a[232:235], v[248:251]
  s_add_u32 m0, s31, s53
  ds_read_b64_tr_b16 v[50:51], v6 offset:8704
  v_accvgpr_read_b32 v35, a7
  v_mfma_f32_16x16x32_bf16 v[252:255], v[52:55], a[236:239], v[252:255]
  s_waitcnt lgkmcnt(4)
  buffer_load_dwordx4 v11, s[12:15], s28 offen offset:384 lds
  v_mfma_f32_16x16x32_bf16 v[64:67], v[40:43], a[216:219], v[64:67]
  s_add_u32 s40, s40, 128
  ds_read_b64_tr_b16 v[52:53], v7 offset:512
  v_accvgpr_read_b32 v36, a16
  v_mfma_f32_16x16x32_bf16 v[68:71], v[40:43], a[220:223], v[68:71]
  s_waitcnt vmcnt(4)
  ds_read_b64_tr_b16 v[54:55], v7 offset:8704
  v_accvgpr_read_b32 v37, a17
  v_mfma_f32_16x16x32_bf16 v[72:75], v[40:43], a[224:227], v[72:75]
  s_waitcnt lgkmcnt(4)
  ds_read_b128 a[228:231], v14 offset:0
  v_accvgpr_read_b32 v38, a18
  v_mfma_f32_16x16x32_bf16 v[160:163], v[44:47], a[216:219], v[160:163]
  s_cmp_eq_u32 s40, 896
  s_cselect_b32 s40, 0, s40
  ds_read_b64_tr_b16 v[40:41], v6 offset:1024
  v_mfma_f32_16x16x32_bf16 v[164:167], v[44:47], a[220:223], v[164:167]
  s_add_u32 s54, s40, 14336
  ds_read_b64_tr_b16 v[42:43], v6 offset:9216
  v_accvgpr_read_b32 v39, a19
  v_mfma_f32_16x16x32_bf16 v[168:171], v[44:47], a[224:227], v[168:171]
  s_waitcnt lgkmcnt(5)
  ds_read_b128 a[232:235], v14 offset:1024
  v_mul_f32 v32, v32, v58
  v_mfma_f32_16x16x32_bf16 v[76:79], v[48:51], a[216:219], v[76:79]
  s_add_u32 s55, s40, 28672
  ds_read_b64_tr_b16 v[44:45], v7 offset:1024
  v_mul_f32 v33, v33, v58
  v_mfma_f32_16x16x32_bf16 v[80:83], v[48:51], a[220:223], v[80:83]
  s_add_u32 s35, s35, 262144
  ds_read_b64_tr_b16 v[46:47], v7 offset:9216
  v_mul_f32 v34, v34, v58
  v_mfma_f32_16x16x32_bf16 v[84:87], v[48:51], a[224:227], v[84:87]
  s_waitcnt lgkmcnt(6)
  ds_read_b128 a[236:239], v14 offset:2048
  v_mul_f32 v35, v35, v58
  v_mfma_f32_16x16x32_bf16 v[172:175], v[52:55], a[216:219], v[172:175]
  s_cmp_eq_u32 s35, 3670016
  s_cselect_b32 s35, 0, s35
  ds_read_b64_tr_b16 v[48:49], v6 offset:1536
  v_mfma_f32_16x16x32_bf16 v[176:179], v[52:55], a[220:223], v[176:179]
  s_add_u32 s31, s31, 16384
  s_and_b32 s31, s31, 65535
  ds_read_b64_tr_b16 v[50:51], v6 offset:9728
  v_mfma_f32_16x16x32_bf16 v[180:183], v[52:55], a[224:227], v[180:183]
  s_waitcnt lgkmcnt(6)
  v_mul_f32 v36, v36, v58
  v_mul_f32 v37, v37, v58
  v_mfma_f32_16x16x32_bf16 v[88:91], v[40:43], a[216:219], v[88:91]
  s_waitcnt lgkmcnt(2)
  ds_read_b64_tr_b16 v[52:53], v7 offset:1536
  v_mul_f32 v38, v38, v58
  v_mfma_f32_16x16x32_bf16 v[92:95], v[40:43], a[220:223], v[92:95]
  s_add_u32 m0, s39, 64
  ds_read_b64_tr_b16 v[54:55], v7 offset:9728
  v_mul_f32 v39, v39, v58
  v_mfma_f32_16x16x32_bf16 v[96:99], v[40:43], a[224:227], v[96:99]
  s_waitcnt lgkmcnt(5)
  buffer_load_dwordx4 v21, s[16:19], s40 offen offset:0 lds
  v_mfma_f32_16x16x32_bf16 v[184:187], v[44:47], a[216:219], v[184:187]
  s_add_u32 s28, s35, s36
  ds_read_b64_tr_b16 v[40:41], v6 offset:2048
  v_cvt_pk_bf16_f32 v32, v32, v33
  v_mfma_f32_16x16x32_bf16 v[188:191], v[44:47], a[220:223], v[188:191]
  s_add_u32 m0, s39, 1088
  ds_read_b64_tr_b16 v[42:43], v6 offset:10240
  v_cvt_pk_bf16_f32 v33, v34, v35
  v_mfma_f32_16x16x32_bf16 v[192:195], v[44:47], a[224:227], v[192:195]
  s_waitcnt lgkmcnt(4)
  buffer_load_dwordx4 v21, s[16:19], s54 offen offset:0 lds
  v_mfma_f32_16x16x32_bf16 v[100:103], v[48:51], a[216:219], v[100:103]
  ds_read_b64_tr_b16 v[44:45], v7 offset:2048
  v_cvt_pk_bf16_f32 v34, v36, v37
  v_mfma_f32_16x16x32_bf16 v[104:107], v[48:51], a[220:223], v[104:107]
  s_add_u32 m0, s39, 2112
  ds_read_b64_tr_b16 v[46:47], v7 offset:10240
  v_cvt_pk_bf16_f32 v35, v38, v39
  v_mfma_f32_16x16x32_bf16 v[108:111], v[48:51], a[224:227], v[108:111]
  s_waitcnt lgkmcnt(4)
  buffer_load_dwordx4 v21, s[16:19], s55 offen offset:0 lds
  v_mfma_f32_16x16x32_bf16 v[196:199], v[52:55], a[216:219], v[196:199]
  ds_read_b64_tr_b16 v[48:49], v6 offset:2560
  v_accvgpr_write_b32 a4, v32
  v_mfma_f32_16x16x32_bf16 v[200:203], v[52:55], a[220:223], v[200:203]
  ds_read_b64_tr_b16 v[50:51], v6 offset:10752
  v_accvgpr_write_b32 a5, v33
  v_mfma_f32_16x16x32_bf16 v[204:207], v[52:55], a[224:227], v[204:207]
  s_waitcnt lgkmcnt(4)
  v_accvgpr_write_b32 a6, v34
  v_accvgpr_write_b32 a7, v35
  v_mfma_f32_16x16x32_bf16 v[112:115], v[40:43], a[216:219], v[112:115]
  s_waitcnt vmcnt(10)
  ds_read_b64_tr_b16 v[52:53], v7 offset:2560
  v_accvgpr_read_b32 v24, a8
  v_mfma_f32_16x16x32_bf16 v[116:119], v[40:43], a[220:223], v[116:119]
  s_barrier
  ds_read_b64_tr_b16 v[54:55], v7 offset:10752
  v_accvgpr_read_b32 v25, a9
  v_mfma_f32_16x16x32_bf16 v[120:123], v[40:43], a[224:227], v[120:123]
  s_waitcnt lgkmcnt(4)
  v_accvgpr_read_b32 v26, a10
  v_accvgpr_read_b32 v27, a11
  v_mfma_f32_16x16x32_bf16 v[208:211], v[44:47], a[216:219], v[208:211]
  ds_read_b64_tr_b16 v[40:41], v6 offset:3072
  v_accvgpr_read_b32 v28, a20
  v_mfma_f32_16x16x32_bf16 v[212:215], v[44:47], a[220:223], v[212:215]
  s_add_u32 m0, s31, s50
  ds_read_b64_tr_b16 v[42:43], v6 offset:11264
  v_accvgpr_read_b32 v29, a21
  v_mfma_f32_16x16x32_bf16 v[216:219], v[44:47], a[224:227], v[216:219]
  s_waitcnt lgkmcnt(4)
  buffer_load_dwordx4 v11, s[12:15], s28 offen offset:0 lds
  v_mfma_f32_16x16x32_bf16 v[124:127], v[48:51], a[216:219], v[124:127]
  s_add_u32 s34, s34, 16384
  ds_read_b64_tr_b16 v[44:45], v7 offset:3072
  v_accvgpr_read_b32 v30, a22
  v_mfma_f32_16x16x32_bf16 v[128:131], v[48:51], a[220:223], v[128:131]
  ds_read_b64_tr_b16 v[46:47], v7 offset:11264
  v_accvgpr_read_b32 v31, a23
  v_mfma_f32_16x16x32_bf16 v[132:135], v[48:51], a[224:227], v[132:135]
  s_waitcnt lgkmcnt(4)
  v_mul_f32 v24, v24, v60
  v_mul_f32 v25, v25, v60
  v_mfma_f32_16x16x32_bf16 v[220:223], v[52:55], a[216:219], v[220:223]
  s_and_b32 s34, s34, 65535
  ds_read_b64_tr_b16 v[48:49], v6 offset:3584
  v_mul_f32 v26, v26, v60
  v_mfma_f32_16x16x32_bf16 v[224:227], v[52:55], a[220:223], v[224:227]
  s_add_u32 m0, s31, s51
  ds_read_b64_tr_b16 v[50:51], v6 offset:11776
  v_mul_f32 v27, v27, v60
  v_mfma_f32_16x16x32_bf16 v[228:231], v[52:55], a[224:227], v[228:231]
  s_waitcnt lgkmcnt(4)
  buffer_load_dwordx4 v11, s[12:15], s28 offen offset:128 lds
  v_mfma_f32_16x16x32_bf16 v[136:139], v[40:43], a[216:219], v[136:139]
  ds_read_b64_tr_b16 v[52:53], v7 offset:3584
  v_add_u32 v6, s34, v3
  v_mfma_f32_16x16x32_bf16 v[140:143], v[40:43], a[220:223], v[140:143]
  ds_read_b64_tr_b16 v[54:55], v7 offset:11776
  v_add_u32 v7, s34, v4
  v_mfma_f32_16x16x32_bf16 v[144:147], v[40:43], a[224:227], v[144:147]
  s_waitcnt lgkmcnt(4)
  v_mul_f32 v28, v28, v60
  v_mul_f32 v29, v29, v60
  v_mfma_f32_16x16x32_bf16 v[232:235], v[44:47], a[216:219], v[232:235]
  ds_read_b64_tr_b16 v[40:41], v6 offset:0
  v_mul_f32 v30, v30, v60
  v_mfma_f32_16x16x32_bf16 v[236:239], v[44:47], a[220:223], v[236:239]
  s_add_u32 m0, s31, s52
  ds_read_b64_tr_b16 v[42:43], v6 offset:8192
  v_mul_f32 v31, v31, v60
  v_mfma_f32_16x16x32_bf16 v[240:243], v[44:47], a[224:227], v[240:243]
  s_waitcnt lgkmcnt(4)
  buffer_load_dwordx4 v11, s[12:15], s28 offen offset:256 lds
  v_mfma_f32_16x16x32_bf16 v[148:151], v[48:51], a[216:219], v[148:151]
  ds_read_b64_tr_b16 v[44:45], v7 offset:0
  v_cvt_pk_bf16_f32 v24, v24, v25
  v_mfma_f32_16x16x32_bf16 v[152:155], v[48:51], a[220:223], v[152:155]
  ds_read_b64_tr_b16 v[46:47], v7 offset:8192
  v_cvt_pk_bf16_f32 v25, v26, v27
  v_mfma_f32_16x16x32_bf16 v[156:159], v[48:51], a[224:227], v[156:159]
  s_waitcnt lgkmcnt(4)
  v_cvt_pk_bf16_f32 v26, v28, v29
  v_cvt_pk_bf16_f32 v27, v30, v31
  v_mfma_f32_16x16x32_bf16 v[244:247], v[52:55], a[216:219], v[244:247]
  ds_read_b64_tr_b16 v[48:49], v6 offset:512
  v_accvgpr_write_b32 a8, v24
  v_mfma_f32_16x16x32_bf16 v[248:251], v[52:55], a[220:223], v[248:251]
  s_add_u32 m0, s31, s53
  ds_read_b64_tr_b16 v[50:51], v6 offset:8704
  v_accvgpr_write_b32 a9, v25
  v_mfma_f32_16x16x32_bf16 v[252:255], v[52:55], a[224:227], v[252:255]
  s_waitcnt lgkmcnt(4)
  buffer_load_dwordx4 v11, s[12:15], s28 offen offset:384 lds
  v_mfma_f32_16x16x32_bf16 v[64:67], v[40:43], a[228:231], v[64:67]
  s_add_u32 s35, s35, 262144
  ds_read_b64_tr_b16 v[52:53], v7 offset:512
  v_accvgpr_write_b32 a10, v26
  v_mfma_f32_16x16x32_bf16 v[68:71], v[40:43], a[232:235], v[68:71]
  s_waitcnt vmcnt(4)
  ds_read_b64_tr_b16 v[54:55], v7 offset:8704
  v_accvgpr_write_b32 a11, v27
  v_mfma_f32_16x16x32_bf16 v[72:75], v[40:43], a[236:239], v[72:75]
  s_waitcnt lgkmcnt(4)
  ds_read_b128 a[216:219], v14 offset:0
  v_accvgpr_read_b32 v32, a24
  v_mfma_f32_16x16x32_bf16 v[160:163], v[44:47], a[228:231], v[160:163]
  s_cmp_eq_u32 s35, 3670016
  s_cselect_b32 s35, 0, s35
  ds_read_b64_tr_b16 v[40:41], v6 offset:1024
  v_mfma_f32_16x16x32_bf16 v[164:167], v[44:47], a[232:235], v[164:167]
  s_add_u32 s31, s31, 16384
  s_and_b32 s31, s31, 65535
  ds_read_b64_tr_b16 v[42:43], v6 offset:9216
  v_mfma_f32_16x16x32_bf16 v[168:171], v[44:47], a[236:239], v[168:171]
  s_waitcnt lgkmcnt(5)
  ds_read_b128 a[220:223], v14 offset:1024
  v_accvgpr_read_b32 v33, a25
  v_mfma_f32_16x16x32_bf16 v[76:79], v[48:51], a[228:231], v[76:79]
  s_add_u32 s28, s35, s36
  ds_read_b64_tr_b16 v[44:45], v7 offset:1024
  v_accvgpr_read_b32 v34, a26
  v_mfma_f32_16x16x32_bf16 v[80:83], v[48:51], a[232:235], v[80:83]
  ds_read_b64_tr_b16 v[46:47], v7 offset:9216
  v_accvgpr_read_b32 v35, a27
  v_mfma_f32_16x16x32_bf16 v[84:87], v[48:51], a[236:239], v[84:87]
  s_waitcnt lgkmcnt(6)
  ds_read_b128 a[224:227], v14 offset:2048
  v_accvgpr_read_b32 v36, a36
  v_mfma_f32_16x16x32_bf16 v[172:175], v[52:55], a[228:231], v[172:175]
  ds_read_b64_tr_b16 v[48:49], v6 offset:1536
  v_accvgpr_read_b32 v37, a37
  v_mfma_f32_16x16x32_bf16 v[176:179], v[52:55], a[232:235], v[176:179]
  ds_read_b64_tr_b16 v[50:51], v6 offset:9728
  v_accvgpr_read_b32 v38, a38
  v_mfma_f32_16x16x32_bf16 v[180:183], v[52:55], a[236:239], v[180:183]
  s_waitcnt lgkmcnt(6)
  v_accvgpr_read_b32 v39, a39
  v_mul_f32 v32, v32, v56
  v_mfma_f32_16x16x32_bf16 v[88:91], v[40:43], a[228:231], v[88:91]
  s_waitcnt lgkmcnt(2)
  ds_read_b64_tr_b16 v[52:53], v7 offset:1536
  v_mul_f32 v33, v33, v56
  v_mfma_f32_16x16x32_bf16 v[92:95], v[40:43], a[232:235], v[92:95]
  s_add_u32 m0, s39, 0
  ds_read_b64_tr_b16 v[54:55], v7 offset:9728
  v_mul_f32 v34, v34, v56
  v_mfma_f32_16x16x32_bf16 v[96:99], v[40:43], a[236:239], v[96:99]
  s_waitcnt lgkmcnt(5)
  buffer_load_dwordx4 v21, s[16:19], s40 offen offset:64 lds
  v_mfma_f32_16x16x32_bf16 v[184:187], v[44:47], a[228:231], v[184:187]
  ds_read_b64_tr_b16 v[40:41], v6 offset:2048
  v_mul_f32 v35, v35, v56
  v_mfma_f32_16x16x32_bf16 v[188:191], v[44:47], a[232:235], v[188:191]
  s_add_u32 m0, s39, 1024
  ds_read_b64_tr_b16 v[42:43], v6 offset:10240
  v_mul_f32 v36, v36, v56
  v_mfma_f32_16x16x32_bf16 v[192:195], v[44:47], a[236:239], v[192:195]
  s_waitcnt lgkmcnt(4)
  buffer_load_dwordx4 v21, s[16:19], s54 offen offset:64 lds
  v_mfma_f32_16x16x32_bf16 v[100:103], v[48:51], a[228:231], v[100:103]
  ds_read_b64_tr_b16 v[44:45], v7 offset:2048
  v_mul_f32 v37, v37, v56
  v_mfma_f32_16x16x32_bf16 v[104:107], v[48:51], a[232:235], v[104:107]
  s_add_u32 m0, s39, 2048
  ds_read_b64_tr_b16 v[46:47], v7 offset:10240
  v_mul_f32 v38, v38, v56
  v_mfma_f32_16x16x32_bf16 v[108:111], v[48:51], a[236:239], v[108:111]
  s_waitcnt lgkmcnt(4)
  buffer_load_dwordx4 v21, s[16:19], s55 offen offset:64 lds
  v_mfma_f32_16x16x32_bf16 v[196:199], v[52:55], a[228:231], v[196:199]
  ds_read_b64_tr_b16 v[48:49], v6 offset:2560
  v_mul_f32 v39, v39, v56
  v_mfma_f32_16x16x32_bf16 v[200:203], v[52:55], a[232:235], v[200:203]
  ds_read_b64_tr_b16 v[50:51], v6 offset:10752
  v_cvt_pk_bf16_f32 v32, v32, v33
  v_mfma_f32_16x16x32_bf16 v[204:207], v[52:55], a[236:239], v[204:207]
  s_waitcnt lgkmcnt(4)
  v_cvt_pk_bf16_f32 v33, v34, v35
  v_cvt_pk_bf16_f32 v34, v36, v37
  v_mfma_f32_16x16x32_bf16 v[112:115], v[40:43], a[228:231], v[112:115]
  s_waitcnt vmcnt(10)
  ds_read_b64_tr_b16 v[52:53], v7 offset:2560
  v_cvt_pk_bf16_f32 v35, v38, v39
  v_mfma_f32_16x16x32_bf16 v[116:119], v[40:43], a[232:235], v[116:119]
  s_barrier
  ds_read_b64_tr_b16 v[54:55], v7 offset:10752
  v_accvgpr_write_b32 a24, v32
  v_mfma_f32_16x16x32_bf16 v[120:123], v[40:43], a[236:239], v[120:123]
  s_waitcnt lgkmcnt(4)
  v_accvgpr_write_b32 a25, v33
  v_accvgpr_write_b32 a26, v34
  v_mfma_f32_16x16x32_bf16 v[208:211], v[44:47], a[228:231], v[208:211]
  ds_read_b64_tr_b16 v[40:41], v6 offset:3072
  v_accvgpr_write_b32 a27, v35
  v_mfma_f32_16x16x32_bf16 v[212:215], v[44:47], a[232:235], v[212:215]
  s_add_u32 m0, s31, s50
  ds_read_b64_tr_b16 v[42:43], v6 offset:11264
  v_accvgpr_read_b32 v24, a28
  v_mfma_f32_16x16x32_bf16 v[216:219], v[44:47], a[236:239], v[216:219]
  s_waitcnt lgkmcnt(4)
  buffer_load_dwordx4 v11, s[12:15], s28 offen offset:0 lds
  v_mfma_f32_16x16x32_bf16 v[124:127], v[48:51], a[228:231], v[124:127]
  s_add_u32 s34, s34, 16384
  ds_read_b64_tr_b16 v[44:45], v7 offset:3072
  v_accvgpr_read_b32 v25, a29
  v_mfma_f32_16x16x32_bf16 v[128:131], v[48:51], a[232:235], v[128:131]
  ds_read_b64_tr_b16 v[46:47], v7 offset:11264
  v_accvgpr_read_b32 v26, a30
  v_mfma_f32_16x16x32_bf16 v[132:135], v[48:51], a[236:239], v[132:135]
  s_waitcnt lgkmcnt(4)
  v_accvgpr_read_b32 v27, a31
  v_accvgpr_read_b32 v28, a40
  v_mfma_f32_16x16x32_bf16 v[220:223], v[52:55], a[228:231], v[220:223]
  s_and_b32 s34, s34, 65535
  ds_read_b64_tr_b16 v[48:49], v6 offset:3584
  v_accvgpr_read_b32 v29, a41
  v_mfma_f32_16x16x32_bf16 v[224:227], v[52:55], a[232:235], v[224:227]
  s_add_u32 m0, s31, s51
  ds_read_b64_tr_b16 v[50:51], v6 offset:11776
  v_accvgpr_read_b32 v30, a42
  v_mfma_f32_16x16x32_bf16 v[228:231], v[52:55], a[236:239], v[228:231]
  s_waitcnt lgkmcnt(4)
  buffer_load_dwordx4 v11, s[12:15], s28 offen offset:128 lds
  v_mfma_f32_16x16x32_bf16 v[136:139], v[40:43], a[228:231], v[136:139]
  ds_read_b64_tr_b16 v[52:53], v7 offset:3584
  v_add_u32 v6, s34, v3
  v_mfma_f32_16x16x32_bf16 v[140:143], v[40:43], a[232:235], v[140:143]
  ds_read_b64_tr_b16 v[54:55], v7 offset:11776
  v_add_u32 v7, s34, v4
  v_mfma_f32_16x16x32_bf16 v[144:147], v[40:43], a[236:239], v[144:147]
  s_waitcnt lgkmcnt(4)
  v_accvgpr_read_b32 v31, a43
  v_mul_f32 v24, v24, v58
  v_mfma_f32_16x16x32_bf16 v[232:235], v[44:47], a[228:231], v[232:235]
  ds_read_b64_tr_b16 v[40:41], v6 offset:0
  v_mul_f32 v25, v25, v58
  v_mfma_f32_16x16x32_bf16 v[236:239], v[44:47], a[232:235], v[236:239]
  s_add_u32 m0, s31, s52
  ds_read_b64_tr_b16 v[42:43], v6 offset:8192
  v_mul_f32 v26, v26, v58
  v_mfma_f32_16x16x32_bf16 v[240:243], v[44:47], a[236:239], v[240:243]
  s_waitcnt lgkmcnt(4)
  buffer_load_dwordx4 v11, s[12:15], s28 offen offset:256 lds
  v_mfma_f32_16x16x32_bf16 v[148:151], v[48:51], a[228:231], v[148:151]
  ds_read_b64_tr_b16 v[44:45], v7 offset:0
  v_mul_f32 v27, v27, v58
  v_mfma_f32_16x16x32_bf16 v[152:155], v[48:51], a[232:235], v[152:155]
  ds_read_b64_tr_b16 v[46:47], v7 offset:8192
  v_mul_f32 v28, v28, v58
  v_mfma_f32_16x16x32_bf16 v[156:159], v[48:51], a[236:239], v[156:159]
  s_waitcnt lgkmcnt(4)
  v_mul_f32 v29, v29, v58
  v_mul_f32 v30, v30, v58
  v_mfma_f32_16x16x32_bf16 v[244:247], v[52:55], a[228:231], v[244:247]
  ds_read_b64_tr_b16 v[48:49], v6 offset:512
  v_mul_f32 v31, v31, v58
  v_mfma_f32_16x16x32_bf16 v[248:251], v[52:55], a[232:235], v[248:251]
  s_add_u32 m0, s31, s53
  ds_read_b64_tr_b16 v[50:51], v6 offset:8704
  v_cvt_pk_bf16_f32 v24, v24, v25
  v_mfma_f32_16x16x32_bf16 v[252:255], v[52:55], a[236:239], v[252:255]
  s_waitcnt lgkmcnt(4)
  buffer_load_dwordx4 v11, s[12:15], s28 offen offset:384 lds
  v_mfma_f32_16x16x32_bf16 v[64:67], v[40:43], a[216:219], v[64:67]
  s_add_u32 s40, s40, 128
  ds_read_b64_tr_b16 v[52:53], v7 offset:512
  v_cvt_pk_bf16_f32 v25, v26, v27
  v_mfma_f32_16x16x32_bf16 v[68:71], v[40:43], a[220:223], v[68:71]
  s_waitcnt vmcnt(4)
  ds_read_b64_tr_b16 v[54:55], v7 offset:8704
  v_cvt_pk_bf16_f32 v26, v28, v29
  v_mfma_f32_16x16x32_bf16 v[72:75], v[40:43], a[224:227], v[72:75]
  s_waitcnt lgkmcnt(4)
  ds_read_b128 a[228:231], v14 offset:0
  v_cvt_pk_bf16_f32 v27, v30, v31
  v_mfma_f32_16x16x32_bf16 v[160:163], v[44:47], a[216:219], v[160:163]
  s_cmp_eq_u32 s40, 896
  s_cselect_b32 s40, 0, s40
  ds_read_b64_tr_b16 v[40:41], v6 offset:1024
  v_mfma_f32_16x16x32_bf16 v[164:167], v[44:47], a[220:223], v[164:167]
  s_add_u32 s54, s40, 14336
  ds_read_b64_tr_b16 v[42:43], v6 offset:9216
  v_accvgpr_write_b32 a28, v24
  v_mfma_f32_16x16x32_bf16 v[168:171], v[44:47], a[224:227], v[168:171]
  s_waitcnt lgkmcnt(5)
  ds_read_b128 a[232:235], v14 offset:1024
  v_accvgpr_write_b32 a29, v25
  v_mfma_f32_16x16x32_bf16 v[76:79], v[48:51], a[216:219], v[76:79]
  s_add_u32 s55, s40, 28672
  ds_read_b64_tr_b16 v[44:45], v7 offset:1024
  v_accvgpr_write_b32 a30, v26
  v_mfma_f32_16x16x32_bf16 v[80:83], v[48:51], a[220:223], v[80:83]
  s_add_u32 s35, s35, 262144
  ds_read_b64_tr_b16 v[46:47], v7 offset:9216
  v_accvgpr_write_b32 a31, v27
  v_mfma_f32_16x16x32_bf16 v[84:87], v[48:51], a[224:227], v[84:87]
  s_waitcnt lgkmcnt(6)
  ds_read_b128 a[236:239], v14 offset:2048
  v_accvgpr_read_b32 v32, a32
  v_mfma_f32_16x16x32_bf16 v[172:175], v[52:55], a[216:219], v[172:175]
  s_cmp_eq_u32 s35, 3670016
  s_cselect_b32 s35, 0, s35
  ds_read_b64_tr_b16 v[48:49], v6 offset:1536
  v_mfma_f32_16x16x32_bf16 v[176:179], v[52:55], a[220:223], v[176:179]
  s_add_u32 s31, s31, 16384
  s_and_b32 s31, s31, 65535
  ds_read_b64_tr_b16 v[50:51], v6 offset:9728
  v_mfma_f32_16x16x32_bf16 v[180:183], v[52:55], a[224:227], v[180:183]
  s_waitcnt lgkmcnt(6)
  v_accvgpr_read_b32 v33, a33
  v_accvgpr_read_b32 v34, a34
  v_mfma_f32_16x16x32_bf16 v[88:91], v[40:43], a[216:219], v[88:91]
  s_waitcnt lgkmcnt(2)
  ds_read_b64_tr_b16 v[52:53], v7 offset:1536
  v_accvgpr_read_b32 v35, a35
  v_mfma_f32_16x16x32_bf16 v[92:95], v[40:43], a[220:223], v[92:95]
  s_add_u32 m0, s39, 64
  ds_read_b64_tr_b16 v[54:55], v7 offset:9728
  v_accvgpr_read_b32 v36, a44
  v_mfma_f32_16x16x32_bf16 v[96:99], v[40:43], a[224:227], v[96:99]
  s_waitcnt lgkmcnt(5)
  buffer_load_dwordx4 v21, s[16:19], s40 offen offset:0 lds
  v_mfma_f32_16x16x32_bf16 v[184:187], v[44:47], a[216:219], v[184:187]
  s_add_u32 s28, s35, s36
  ds_read_b64_tr_b16 v[40:41], v6 offset:2048
  v_accvgpr_read_b32 v37, a45
  v_mfma_f32_16x16x32_bf16 v[188:191], v[44:47], a[220:223], v[188:191]
  s_add_u32 m0, s39, 1088
  ds_read_b64_tr_b16 v[42:43], v6 offset:10240
  v_accvgpr_read_b32 v38, a46
  v_mfma_f32_16x16x32_bf16 v[192:195], v[44:47], a[224:227], v[192:195]
  s_waitcnt lgkmcnt(4)
  buffer_load_dwordx4 v21, s[16:19], s54 offen offset:0 lds
  v_mfma_f32_16x16x32_bf16 v[100:103], v[48:51], a[216:219], v[100:103]
  ds_read_b64_tr_b16 v[44:45], v7 offset:2048
  v_accvgpr_read_b32 v39, a47
  v_mfma_f32_16x16x32_bf16 v[104:107], v[48:51], a[220:223], v[104:107]
  s_add_u32 m0, s39, 2112
  ds_read_b64_tr_b16 v[46:47], v7 offset:10240
  v_mul_f32 v32, v32, v60
  v_mfma_f32_16x16x32_bf16 v[108:111], v[48:51], a[224:227], v[108:111]
  s_waitcnt lgkmcnt(4)
  buffer_load_dwordx4 v21, s[16:19], s55 offen offset:0 lds
  v_mfma_f32_16x16x32_bf16 v[196:199], v[52:55], a[216:219], v[196:199]
  ds_read_b64_tr_b16 v[48:49], v6 offset:2560
  v_mul_f32 v33, v33, v60
  v_mfma_f32_16x16x32_bf16 v[200:203], v[52:55], a[220:223], v[200:203]
  ds_read_b64_tr_b16 v[50:51], v6 offset:10752
  v_mul_f32 v34, v34, v60
  v_mfma_f32_16x16x32_bf16 v[204:207], v[52:55], a[224:227], v[204:207]
  s_waitcnt lgkmcnt(4)
  v_mul_f32 v35, v35, v60
  v_mul_f32 v36, v36, v60
  v_mfma_f32_16x16x32_bf16 v[112:115], v[40:43], a[216:219], v[112:115]
  s_waitcnt vmcnt(10)
  ds_read_b64_tr_b16 v[52:53], v7 offset:2560
  v_mul_f32 v37, v37, v60
  v_mfma_f32_16x16x32_bf16 v[116:119], v[40:43], a[220:223], v[116:119]
  s_barrier
  ds_read_b64_tr_b16 v[54:55], v7 offset:10752
  v_mul_f32 v38, v38, v60
  v_mfma_f32_16x16x32_bf16 v[120:123], v[40:43], a[224:227], v[120:123]
  s_waitcnt lgkmcnt(4)
  v_mul_f32 v39, v39, v60
  v_cvt_pk_bf16_f32 v32, v32, v33
  v_mfma_f32_16x16x32_bf16 v[208:211], v[44:47], a[216:219], v[208:211]
  ds_read_b64_tr_b16 v[40:41], v6 offset:3072
  v_cvt_pk_bf16_f32 v33, v34, v35
  v_mfma_f32_16x16x32_bf16 v[212:215], v[44:47], a[220:223], v[212:215]
  s_add_u32 m0, s31, s50
  ds_read_b64_tr_b16 v[42:43], v6 offset:11264
  v_cvt_pk_bf16_f32 v34, v36, v37
  v_mfma_f32_16x16x32_bf16 v[216:219], v[44:47], a[224:227], v[216:219]
  s_waitcnt lgkmcnt(4)
  buffer_load_dwordx4 v11, s[12:15], s28 offen offset:0 lds
  v_mfma_f32_16x16x32_bf16 v[124:127], v[48:51], a[216:219], v[124:127]
  s_add_u32 s34, s34, 16384
  ds_read_b64_tr_b16 v[44:45], v7 offset:3072
  v_cvt_pk_bf16_f32 v35, v38, v39
  v_mfma_f32_16x16x32_bf16 v[128:131], v[48:51], a[220:223], v[128:131]
  ds_read_b64_tr_b16 v[46:47], v7 offset:11264
  v_accvgpr_write_b32 a32, v32
  v_mfma_f32_16x16x32_bf16 v[132:135], v[48:51], a[224:227], v[132:135]
  s_waitcnt lgkmcnt(4)
  v_accvgpr_write_b32 a33, v33
  v_accvgpr_write_b32 a34, v34
  v_mfma_f32_16x16x32_bf16 v[220:223], v[52:55], a[216:219], v[220:223]
  s_and_b32 s34, s34, 65535
  ds_read_b64_tr_b16 v[48:49], v6 offset:3584
  v_accvgpr_write_b32 a35, v35
  v_mfma_f32_16x16x32_bf16 v[224:227], v[52:55], a[220:223], v[224:227]
  s_add_u32 m0, s31, s51
  ds_read_b64_tr_b16 v[50:51], v6 offset:11776
  v_accvgpr_read_b32 v24, a124
  v_mfma_f32_16x16x32_bf16 v[228:231], v[52:55], a[224:227], v[228:231]
  s_waitcnt lgkmcnt(4)
  buffer_load_dwordx4 v11, s[12:15], s28 offen offset:128 lds
  v_mfma_f32_16x16x32_bf16 v[136:139], v[40:43], a[216:219], v[136:139]
  ds_read_b64_tr_b16 v[52:53], v7 offset:3584
  v_add_u32 v6, s34, v3
  v_mfma_f32_16x16x32_bf16 v[140:143], v[40:43], a[220:223], v[140:143]
  ds_read_b64_tr_b16 v[54:55], v7 offset:11776
  v_add_u32 v7, s34, v4
  v_mfma_f32_16x16x32_bf16 v[144:147], v[40:43], a[224:227], v[144:147]
  s_waitcnt lgkmcnt(4)
  v_accvgpr_read_b32 v25, a125
  v_accvgpr_read_b32 v26, a126
  v_mfma_f32_16x16x32_bf16 v[232:235], v[44:47], a[216:219], v[232:235]
  ds_read_b64_tr_b16 v[40:41], v6 offset:0
  v_accvgpr_read_b32 v27, a127
  v_mfma_f32_16x16x32_bf16 v[236:239], v[44:47], a[220:223], v[236:239]
  s_add_u32 m0, s31, s52
  ds_read_b64_tr_b16 v[42:43], v6 offset:8192
  v_accvgpr_read_b32 v28, a136
  v_mfma_f32_16x16x32_bf16 v[240:243], v[44:47], a[224:227], v[240:243]
  s_waitcnt lgkmcnt(4)
  buffer_load_dwordx4 v11, s[12:15], s28 offen offset:256 lds
  v_mfma_f32_16x16x32_bf16 v[148:151], v[48:51], a[216:219], v[148:151]
  ds_read_b64_tr_b16 v[44:45], v7 offset:0
  v_accvgpr_read_b32 v29, a137
  v_mfma_f32_16x16x32_bf16 v[152:155], v[48:51], a[220:223], v[152:155]
  ds_read_b64_tr_b16 v[46:47], v7 offset:8192
  v_accvgpr_read_b32 v30, a138
  v_mfma_f32_16x16x32_bf16 v[156:159], v[48:51], a[224:227], v[156:159]
  s_waitcnt lgkmcnt(4)
  v_accvgpr_read_b32 v31, a139
  v_mul_f32 v24, v24, v58
  v_mfma_f32_16x16x32_bf16 v[244:247], v[52:55], a[216:219], v[244:247]
  ds_read_b64_tr_b16 v[48:49], v6 offset:512
  v_mul_f32 v25, v25, v58
  v_mfma_f32_16x16x32_bf16 v[248:251], v[52:55], a[220:223], v[248:251]
  s_add_u32 m0, s31, s53
  ds_read_b64_tr_b16 v[50:51], v6 offset:8704
  v_mul_f32 v26, v26, v58
  v_mfma_f32_16x16x32_bf16 v[252:255], v[52:55], a[224:227], v[252:255]
  s_waitcnt lgkmcnt(4)
  buffer_load_dwordx4 v11, s[12:15], s28 offen offset:384 lds
  v_mfma_f32_16x16x32_bf16 v[64:67], v[40:43], a[228:231], v[64:67]
  s_add_u32 s35, s35, 262144
  ds_read_b64_tr_b16 v[52:53], v7 offset:512
  v_mul_f32 v27, v27, v58
  v_mfma_f32_16x16x32_bf16 v[68:71], v[40:43], a[232:235], v[68:71]
  s_waitcnt vmcnt(4)
  ds_read_b64_tr_b16 v[54:55], v7 offset:8704
  v_mul_f32 v28, v28, v58
  v_mfma_f32_16x16x32_bf16 v[72:75], v[40:43], a[236:239], v[72:75]
  s_waitcnt lgkmcnt(4)
  ds_read_b128 a[216:219], v14 offset:0
  v_mul_f32 v29, v29, v58
  v_mfma_f32_16x16x32_bf16 v[160:163], v[44:47], a[228:231], v[160:163]
  s_cmp_eq_u32 s35, 3670016
  s_cselect_b32 s35, 0, s35
  ds_read_b64_tr_b16 v[40:41], v6 offset:1024
  v_mfma_f32_16x16x32_bf16 v[164:167], v[44:47], a[232:235], v[164:167]
  s_add_u32 s31, s31, 16384
  s_and_b32 s31, s31, 65535
  ds_read_b64_tr_b16 v[42:43], v6 offset:9216
  v_mfma_f32_16x16x32_bf16 v[168:171], v[44:47], a[236:239], v[168:171]
  s_waitcnt lgkmcnt(5)
  ds_read_b128 a[220:223], v14 offset:1024
  v_mul_f32 v30, v30, v58
  v_mfma_f32_16x16x32_bf16 v[76:79], v[48:51], a[228:231], v[76:79]
  s_add_u32 s28, s35, s36
  ds_read_b64_tr_b16 v[44:45], v7 offset:1024
  v_mul_f32 v31, v31, v58
  v_mfma_f32_16x16x32_bf16 v[80:83], v[48:51], a[232:235], v[80:83]
  ds_read_b64_tr_b16 v[46:47], v7 offset:9216
  v_cvt_pk_bf16_f32 v24, v24, v25
  v_mfma_f32_16x16x32_bf16 v[84:87], v[48:51], a[236:239], v[84:87]
  s_waitcnt lgkmcnt(6)
  ds_read_b128 a[224:227], v14 offset:2048
  v_cvt_pk_bf16_f32 v25, v26, v27
  v_mfma_f32_16x16x32_bf16 v[172:175], v[52:55], a[228:231], v[172:175]
  ds_read_b64_tr_b16 v[48:49], v6 offset:1536
  v_cvt_pk_bf16_f32 v26, v28, v29
  v_mfma_f32_16x16x32_bf16 v[176:179], v[52:55], a[232:235], v[176:179]
  ds_read_b64_tr_b16 v[50:51], v6 offset:9728
  v_cvt_pk_bf16_f32 v27, v30, v31
  v_mfma_f32_16x16x32_bf16 v[180:183], v[52:55], a[236:239], v[180:183]
  s_waitcnt lgkmcnt(6)
  v_accvgpr_write_b32 a124, v24
  v_accvgpr_write_b32 a125, v25
  v_mfma_f32_16x16x32_bf16 v[88:91], v[40:43], a[228:231], v[88:91]
  s_waitcnt lgkmcnt(2)
  ds_read_b64_tr_b16 v[52:53], v7 offset:1536
  v_accvgpr_write_b32 a126, v26
  v_mfma_f32_16x16x32_bf16 v[92:95], v[40:43], a[232:235], v[92:95]
  s_add_u32 m0, s39, 0
  ds_read_b64_tr_b16 v[54:55], v7 offset:9728
  v_accvgpr_write_b32 a127, v27
  v_mfma_f32_16x16x32_bf16 v[96:99], v[40:43], a[236:239], v[96:99]
  s_waitcnt lgkmcnt(5)
  buffer_load_dwordx4 v21, s[16:19], s40 offen offset:64 lds
  v_mfma_f32_16x16x32_bf16 v[184:187], v[44:47], a[228:231], v[184:187]
  ds_read_b64_tr_b16 v[40:41], v6 offset:2048
  v_accvgpr_read_b32 v32, a128
  v_mfma_f32_16x16x32_bf16 v[188:191], v[44:47], a[232:235], v[188:191]
  s_add_u32 m0, s39, 1024
  ds_read_b64_tr_b16 v[42:43], v6 offset:10240
  v_accvgpr_read_b32 v33, a129
  v_mfma_f32_16x16x32_bf16 v[192:195], v[44:47], a[236:239], v[192:195]
  s_waitcnt lgkmcnt(4)
  buffer_load_dwordx4 v21, s[16:19], s54 offen offset:64 lds
  v_mfma_f32_16x16x32_bf16 v[100:103], v[48:51], a[228:231], v[100:103]
  ds_read_b64_tr_b16 v[44:45], v7 offset:2048
  v_accvgpr_read_b32 v34, a130
  v_mfma_f32_16x16x32_bf16 v[104:107], v[48:51], a[232:235], v[104:107]
  s_add_u32 m0, s39, 2048
  ds_read_b64_tr_b16 v[46:47], v7 offset:10240
  v_accvgpr_read_b32 v35, a131
  v_mfma_f32_16x16x32_bf16 v[108:111], v[48:51], a[236:239], v[108:111]
  s_waitcnt lgkmcnt(4)
  buffer_load_dwordx4 v21, s[16:19], s55 offen offset:64 lds
  v_mfma_f32_16x16x32_bf16 v[196:199], v[52:55], a[228:231], v[196:199]
  ds_read_b64_tr_b16 v[48:49], v6 offset:2560
  v_accvgpr_read_b32 v36, a140
  v_mfma_f32_16x16x32_bf16 v[200:203], v[52:55], a[232:235], v[200:203]
  ds_read_b64_tr_b16 v[50:51], v6 offset:10752
  v_accvgpr_read_b32 v37, a141
  v_mfma_f32_16x16x32_bf16 v[204:207], v[52:55], a[236:239], v[204:207]
  s_waitcnt lgkmcnt(4)
  v_accvgpr_read_b32 v38, a142
  v_accvgpr_read_b32 v39, a143
  v_mfma_f32_16x16x32_bf16 v[112:115], v[40:43], a[228:231], v[112:115]
  s_waitcnt vmcnt(10)
  ds_read_b64_tr_b16 v[52:53], v7 offset:2560
  v_mul_f32 v32, v32, v60
  v_mfma_f32_16x16x32_bf16 v[116:119], v[40:43], a[232:235], v[116:119]
  s_barrier
  ds_read_b64_tr_b16 v[54:55], v7 offset:10752
  v_mul_f32 v33, v33, v60
  v_mfma_f32_16x16x32_bf16 v[120:123], v[40:43], a[236:239], v[120:123]
  s_waitcnt lgkmcnt(4)
  v_mul_f32 v34, v34, v60
  v_mul_f32 v35, v35, v60
  v_mfma_f32_16x16x32_bf16 v[208:211], v[44:47], a[228:231], v[208:211]
  ds_read_b64_tr_b16 v[40:41], v6 offset:3072
  v_mul_f32 v36, v36, v60
  v_mfma_f32_16x16x32_bf16 v[212:215], v[44:47], a[232:235], v[212:215]
  s_add_u32 m0, s31, s50
  ds_read_b64_tr_b16 v[42:43], v6 offset:11264
  v_mul_f32 v37, v37, v60
  v_mfma_f32_16x16x32_bf16 v[216:219], v[44:47], a[236:239], v[216:219]
  s_waitcnt lgkmcnt(4)
  buffer_load_dwordx4 v11, s[12:15], s28 offen offset:0 lds
  v_mfma_f32_16x16x32_bf16 v[124:127], v[48:51], a[228:231], v[124:127]
  s_add_u32 s34, s34, 16384
  ds_read_b64_tr_b16 v[44:45], v7 offset:3072
  v_mul_f32 v38, v38, v60
  v_mfma_f32_16x16x32_bf16 v[128:131], v[48:51], a[232:235], v[128:131]
  ds_read_b64_tr_b16 v[46:47], v7 offset:11264
  v_mul_f32 v39, v39, v60
  v_mfma_f32_16x16x32_bf16 v[132:135], v[48:51], a[236:239], v[132:135]
  s_waitcnt lgkmcnt(4)
  v_cvt_pk_bf16_f32 v32, v32, v33
  v_cvt_pk_bf16_f32 v33, v34, v35
  v_mfma_f32_16x16x32_bf16 v[220:223], v[52:55], a[228:231], v[220:223]
  s_and_b32 s34, s34, 65535
  ds_read_b64_tr_b16 v[48:49], v6 offset:3584
  v_cvt_pk_bf16_f32 v34, v36, v37
  v_mfma_f32_16x16x32_bf16 v[224:227], v[52:55], a[232:235], v[224:227]
  s_add_u32 m0, s31, s51
  ds_read_b64_tr_b16 v[50:51], v6 offset:11776
  v_cvt_pk_bf16_f32 v35, v38, v39
  v_mfma_f32_16x16x32_bf16 v[228:231], v[52:55], a[236:239], v[228:231]
  s_waitcnt lgkmcnt(4)
  buffer_load_dwordx4 v11, s[12:15], s28 offen offset:128 lds
  v_mfma_f32_16x16x32_bf16 v[136:139], v[40:43], a[228:231], v[136:139]
  ds_read_b64_tr_b16 v[52:53], v7 offset:3584
  v_add_u32 v6, s34, v3
  v_mfma_f32_16x16x32_bf16 v[140:143], v[40:43], a[232:235], v[140:143]
  ds_read_b64_tr_b16 v[54:55], v7 offset:11776
  v_add_u32 v7, s34, v4
  v_mfma_f32_16x16x32_bf16 v[144:147], v[40:43], a[236:239], v[144:147]
  s_waitcnt lgkmcnt(4)
  v_accvgpr_write_b32 a128, v32
  v_accvgpr_write_b32 a129, v33
  v_mfma_f32_16x16x32_bf16 v[232:235], v[44:47], a[228:231], v[232:235]
  ds_read_b64_tr_b16 v[40:41], v6 offset:0
  v_accvgpr_write_b32 a130, v34
  v_mfma_f32_16x16x32_bf16 v[236:239], v[44:47], a[232:235], v[236:239]
  s_add_u32 m0, s31, s52
  ds_read_b64_tr_b16 v[42:43], v6 offset:8192
  v_accvgpr_write_b32 a131, v35
  v_mfma_f32_16x16x32_bf16 v[240:243], v[44:47], a[236:239], v[240:243]
  s_waitcnt lgkmcnt(4)
  buffer_load_dwordx4 v11, s[12:15], s28 offen offset:256 lds
  v_mfma_f32_16x16x32_bf16 v[148:151], v[48:51], a[228:231], v[148:151]
  ds_read_b64_tr_b16 v[44:45], v7 offset:0
  v_accvgpr_read_b32 v24, a144
  v_mfma_f32_16x16x32_bf16 v[152:155], v[48:51], a[232:235], v[152:155]
  ds_read_b64_tr_b16 v[46:47], v7 offset:8192
  v_accvgpr_read_b32 v25, a145
  v_mfma_f32_16x16x32_bf16 v[156:159], v[48:51], a[236:239], v[156:159]
  s_waitcnt lgkmcnt(4)
  v_accvgpr_read_b32 v26, a146
  v_accvgpr_read_b32 v27, a147
  v_mfma_f32_16x16x32_bf16 v[244:247], v[52:55], a[228:231], v[244:247]
  ds_read_b64_tr_b16 v[48:49], v6 offset:512
  v_accvgpr_read_b32 v28, a156
  v_mfma_f32_16x16x32_bf16 v[248:251], v[52:55], a[232:235], v[248:251]
  s_add_u32 m0, s31, s53
  ds_read_b64_tr_b16 v[50:51], v6 offset:8704
  v_accvgpr_read_b32 v29, a157
  v_mfma_f32_16x16x32_bf16 v[252:255], v[52:55], a[236:239], v[252:255]
  s_waitcnt lgkmcnt(4)
  buffer_load_dwordx4 v11, s[12:15], s28 offen offset:384 lds
  v_mfma_f32_16x16x32_bf16 v[64:67], v[40:43], a[216:219], v[64:67]
  s_add_u32 s40, s40, 128
  ds_read_b64_tr_b16 v[52:53], v7 offset:512
  v_accvgpr_read_b32 v30, a158
  v_mfma_f32_16x16x32_bf16 v[68:71], v[40:43], a[220:223], v[68:71]
  s_waitcnt vmcnt(4)
  ds_read_b64_tr_b16 v[54:55], v7 offset:8704
  v_accvgpr_read_b32 v31, a159
  v_mfma_f32_16x16x32_bf16 v[72:75], v[40:43], a[224:227], v[72:75]
  s_waitcnt lgkmcnt(4)
  ds_read_b128 a[228:231], v14 offset:0
  v_mul_f32 v24, v24, v56
  v_mfma_f32_16x16x32_bf16 v[160:163], v[44:47], a[216:219], v[160:163]
  s_cmp_eq_u32 s40, 896
  s_cselect_b32 s40, 0, s40
  ds_read_b64_tr_b16 v[40:41], v6 offset:1024
  v_mfma_f32_16x16x32_bf16 v[164:167], v[44:47], a[220:223], v[164:167]
  s_add_u32 s54, s40, 14336
  ds_read_b64_tr_b16 v[42:43], v6 offset:9216
  v_mul_f32 v25, v25, v56
  v_mfma_f32_16x16x32_bf16 v[168:171], v[44:47], a[224:227], v[168:171]
  s_waitcnt lgkmcnt(5)
  ds_read_b128 a[232:235], v14 offset:1024
  v_mul_f32 v26, v26, v56
  v_mfma_f32_16x16x32_bf16 v[76:79], v[48:51], a[216:219], v[76:79]
  s_add_u32 s55, s40, 28672
  ds_read_b64_tr_b16 v[44:45], v7 offset:1024
  v_mul_f32 v27, v27, v56
  v_mfma_f32_16x16x32_bf16 v[80:83], v[48:51], a[220:223], v[80:83]
  s_add_u32 s35, s35, 262144
  ds_read_b64_tr_b16 v[46:47], v7 offset:9216
  v_mul_f32 v28, v28, v56
  v_mfma_f32_16x16x32_bf16 v[84:87], v[48:51], a[224:227], v[84:87]
  s_waitcnt lgkmcnt(6)
  ds_read_b128 a[236:239], v14 offset:2048
  v_mul_f32 v29, v29, v56
  v_mfma_f32_16x16x32_bf16 v[172:175], v[52:55], a[216:219], v[172:175]
  s_cmp_eq_u32 s35, 3670016
  s_cselect_b32 s35, 0, s35
  ds_read_b64_tr_b16 v[48:49], v6 offset:1536
  v_mfma_f32_16x16x32_bf16 v[176:179], v[52:55], a[220:223], v[176:179]
  s_add_u32 s31, s31, 16384
  s_and_b32 s31, s31, 65535
  ds_read_b64_tr_b16 v[50:51], v6 offset:9728
  v_mfma_f32_16x16x32_bf16 v[180:183], v[52:55], a[224:227], v[180:183]
  s_waitcnt lgkmcnt(6)
  v_mul_f32 v30, v30, v56
  v_mul_f32 v31, v31, v56
  v_mfma_f32_16x16x32_bf16 v[88:91], v[40:43], a[216:219], v[88:91]
  s_waitcnt lgkmcnt(2)
  ds_read_b64_tr_b16 v[52:53], v7 offset:1536
  v_cvt_pk_bf16_f32 v24, v24, v25
  v_mfma_f32_16x16x32_bf16 v[92:95], v[40:43], a[220:223], v[92:95]
  s_add_u32 m0, s39, 64
  ds_read_b64_tr_b16 v[54:55], v7 offset:9728
  v_cvt_pk_bf16_f32 v25, v26, v27
  v_mfma_f32_16x16x32_bf16 v[96:99], v[40:43], a[224:227], v[96:99]
  s_waitcnt lgkmcnt(5)
  buffer_load_dwordx4 v21, s[16:19], s40 offen offset:0 lds
  v_mfma_f32_16x16x32_bf16 v[184:187], v[44:47], a[216:219], v[184:187]
  s_add_u32 s28, s35, s36
  ds_read_b64_tr_b16 v[40:41], v6 offset:2048
  v_cvt_pk_bf16_f32 v26, v28, v29
  v_mfma_f32_16x16x32_bf16 v[188:191], v[44:47], a[220:223], v[188:191]
  s_add_u32 m0, s39, 1088
  ds_read_b64_tr_b16 v[42:43], v6 offset:10240
  v_cvt_pk_bf16_f32 v27, v30, v31
  v_mfma_f32_16x16x32_bf16 v[192:195], v[44:47], a[224:227], v[192:195]
  s_waitcnt lgkmcnt(4)
  buffer_load_dwordx4 v21, s[16:19], s54 offen offset:0 lds
  v_mfma_f32_16x16x32_bf16 v[100:103], v[48:51], a[216:219], v[100:103]
  ds_read_b64_tr_b16 v[44:45], v7 offset:2048
  v_accvgpr_write_b32 a144, v24
  v_mfma_f32_16x16x32_bf16 v[104:107], v[48:51], a[220:223], v[104:107]
  s_add_u32 m0, s39, 2112
  ds_read_b64_tr_b16 v[46:47], v7 offset:10240
  v_accvgpr_write_b32 a145, v25
  v_mfma_f32_16x16x32_bf16 v[108:111], v[48:51], a[224:227], v[108:111]
  s_waitcnt lgkmcnt(4)
  buffer_load_dwordx4 v21, s[16:19], s55 offen offset:0 lds
  v_mfma_f32_16x16x32_bf16 v[196:199], v[52:55], a[216:219], v[196:199]
  ds_read_b64_tr_b16 v[48:49], v6 offset:2560
  v_accvgpr_write_b32 a146, v26
  v_mfma_f32_16x16x32_bf16 v[200:203], v[52:55], a[220:223], v[200:203]
  ds_read_b64_tr_b16 v[50:51], v6 offset:10752
  v_accvgpr_write_b32 a147, v27
  v_mfma_f32_16x16x32_bf16 v[204:207], v[52:55], a[224:227], v[204:207]
  s_waitcnt lgkmcnt(4)
  v_accvgpr_read_b32 v32, a148
  v_accvgpr_read_b32 v33, a149
  v_mfma_f32_16x16x32_bf16 v[112:115], v[40:43], a[216:219], v[112:115]
  s_waitcnt vmcnt(10)
  ds_read_b64_tr_b16 v[52:53], v7 offset:2560
  v_accvgpr_read_b32 v34, a150
  v_mfma_f32_16x16x32_bf16 v[116:119], v[40:43], a[220:223], v[116:119]
  s_barrier
  ds_read_b64_tr_b16 v[54:55], v7 offset:10752
  v_accvgpr_read_b32 v35, a151
  v_mfma_f32_16x16x32_bf16 v[120:123], v[40:43], a[224:227], v[120:123]
  s_waitcnt lgkmcnt(4)
  v_accvgpr_read_b32 v36, a160
  v_accvgpr_read_b32 v37, a161
  v_mfma_f32_16x16x32_bf16 v[208:211], v[44:47], a[216:219], v[208:211]
  ds_read_b64_tr_b16 v[40:41], v6 offset:3072
  v_accvgpr_read_b32 v38, a162
  v_mfma_f32_16x16x32_bf16 v[212:215], v[44:47], a[220:223], v[212:215]
  s_add_u32 m0, s31, s50
  ds_read_b64_tr_b16 v[42:43], v6 offset:11264
  v_accvgpr_read_b32 v39, a163
  v_mfma_f32_16x16x32_bf16 v[216:219], v[44:47], a[224:227], v[216:219]
  s_waitcnt lgkmcnt(4)
  buffer_load_dwordx4 v11, s[12:15], s28 offen offset:0 lds
  v_mfma_f32_16x16x32_bf16 v[124:127], v[48:51], a[216:219], v[124:127]
  s_add_u32 s34, s34, 16384
  ds_read_b64_tr_b16 v[44:45], v7 offset:3072
  v_mul_f32 v32, v32, v58
  v_mfma_f32_16x16x32_bf16 v[128:131], v[48:51], a[220:223], v[128:131]
  ds_read_b64_tr_b16 v[46:47], v7 offset:11264
  v_mul_f32 v33, v33, v58
  v_mfma_f32_16x16x32_bf16 v[132:135], v[48:51], a[224:227], v[132:135]
  s_waitcnt lgkmcnt(4)
  v_mul_f32 v34, v34, v58
  v_mul_f32 v35, v35, v58
  v_mfma_f32_16x16x32_bf16 v[220:223], v[52:55], a[216:219], v[220:223]
  s_and_b32 s34, s34, 65535
  ds_read_b64_tr_b16 v[48:49], v6 offset:3584
  v_mul_f32 v36, v36, v58
  v_mfma_f32_16x16x32_bf16 v[224:227], v[52:55], a[220:223], v[224:227]
  s_add_u32 m0, s31, s51
  ds_read_b64_tr_b16 v[50:51], v6 offset:11776
  v_mul_f32 v37, v37, v58
  v_mfma_f32_16x16x32_bf16 v[228:231], v[52:55], a[224:227], v[228:231]
  s_waitcnt lgkmcnt(4)
  buffer_load_dwordx4 v11, s[12:15], s28 offen offset:128 lds
  v_mfma_f32_16x16x32_bf16 v[136:139], v[40:43], a[216:219], v[136:139]
  ds_read_b64_tr_b16 v[52:53], v7 offset:3584
  v_add_u32 v6, s34, v3
  v_mfma_f32_16x16x32_bf16 v[140:143], v[40:43], a[220:223], v[140:143]
  ds_read_b64_tr_b16 v[54:55], v7 offset:11776
  v_add_u32 v7, s34, v4
  v_mfma_f32_16x16x32_bf16 v[144:147], v[40:43], a[224:227], v[144:147]
  s_waitcnt lgkmcnt(4)
  v_mul_f32 v38, v38, v58
  v_mul_f32 v39, v39, v58
  v_mfma_f32_16x16x32_bf16 v[232:235], v[44:47], a[216:219], v[232:235]
  ds_read_b64_tr_b16 v[40:41], v6 offset:0
  v_cvt_pk_bf16_f32 v32, v32, v33
  v_mfma_f32_16x16x32_bf16 v[236:239], v[44:47], a[220:223], v[236:239]
  s_add_u32 m0, s31, s52
  ds_read_b64_tr_b16 v[42:43], v6 offset:8192
  v_cvt_pk_bf16_f32 v33, v34, v35
  v_mfma_f32_16x16x32_bf16 v[240:243], v[44:47], a[224:227], v[240:243]
  s_waitcnt lgkmcnt(4)
  buffer_load_dwordx4 v11, s[12:15], s28 offen offset:256 lds
  v_mfma_f32_16x16x32_bf16 v[148:151], v[48:51], a[216:219], v[148:151]
  ds_read_b64_tr_b16 v[44:45], v7 offset:0
  v_cvt_pk_bf16_f32 v34, v36, v37
  v_mfma_f32_16x16x32_bf16 v[152:155], v[48:51], a[220:223], v[152:155]
  ds_read_b64_tr_b16 v[46:47], v7 offset:8192
  v_cvt_pk_bf16_f32 v35, v38, v39
  v_mfma_f32_16x16x32_bf16 v[156:159], v[48:51], a[224:227], v[156:159]
  s_waitcnt lgkmcnt(4)
  v_accvgpr_write_b32 a148, v32
  v_accvgpr_write_b32 a149, v33
  v_mfma_f32_16x16x32_bf16 v[244:247], v[52:55], a[216:219], v[244:247]
  ds_read_b64_tr_b16 v[48:49], v6 offset:512
  v_accvgpr_write_b32 a150, v34
  v_mfma_f32_16x16x32_bf16 v[248:251], v[52:55], a[220:223], v[248:251]
  s_add_u32 m0, s31, s53
  ds_read_b64_tr_b16 v[50:51], v6 offset:8704
  v_accvgpr_write_b32 a151, v35
  v_mfma_f32_16x16x32_bf16 v[252:255], v[52:55], a[224:227], v[252:255]
  s_waitcnt lgkmcnt(4)
  buffer_load_dwordx4 v11, s[12:15], s28 offen offset:384 lds
  s_xor_b32 s36, s36, 512
  s_add_u32 s35, s35, 262144
  s_cmp_eq_u32 s35, 3670016
  s_cselect_b32 s35, 0, s35
  s_add_u32 s31, s31, 16384
  s_and_b32 s31, s31, 65535
  s_add_u32 s28, s35, s36
  s_add_u32 s98, s41, 0
  s_cmp_eq_u32 s45, 1
  s_cselect_b32 s28, s98, s28
  s_cselect_b32 s101, 28544, 0
  s_add_u32 s98, s28, s101
  s_add_u32 s99, s98, s101
  s_add_u32 s100, s99, s101
  v_mfma_f32_16x16x32_bf16 v[64:67], v[40:43], a[228:231], v[64:67]
  ds_read_b64_tr_b16 v[52:53], v7 offset:512
  v_accvgpr_read_b32 v24, a152
  v_mfma_f32_16x16x32_bf16 v[68:71], v[40:43], a[232:235], v[68:71]
  s_waitcnt vmcnt(4)
  ds_read_b64_tr_b16 v[54:55], v7 offset:8704
  v_accvgpr_read_b32 v25, a153
  v_mfma_f32_16x16x32_bf16 v[72:75], v[40:43], a[236:239], v[72:75]
  s_waitcnt lgkmcnt(4)
  ds_read_b128 a[216:219], v14 offset:0
  v_accvgpr_read_b32 v26, a154
  v_mfma_f32_16x16x32_bf16 v[160:163], v[44:47], a[228:231], v[160:163]
  s_cmp_eq_u32 s45, s60
  s_cselect_b32 s6, 524288, 0
  s_cselect_b32 s10, 524288, 0
  s_cselect_b32 s61, 16384, 0
  ds_read_b64_tr_b16 v[40:41], v6 offset:1024
  v_mfma_f32_16x16x32_bf16 v[164:167], v[44:47], a[232:235], v[164:167]
  s_add_u32 s26, s26, s61
  s_add_u32 s29, s29, s61
  ds_read_b64_tr_b16 v[42:43], v6 offset:9216
  v_mfma_f32_16x16x32_bf16 v[168:171], v[44:47], a[236:239], v[168:171]
  s_waitcnt lgkmcnt(5)
  ds_read_b128 a[220:223], v14 offset:1024
  v_accvgpr_read_b32 v27, a155
  v_mfma_f32_16x16x32_bf16 v[76:79], v[48:51], a[228:231], v[76:79]
  s_cmp_eq_u32 s29, 114688
  s_cselect_b32 s29, 65536, s29
  ds_read_b64_tr_b16 v[44:45], v7 offset:1024
  v_mfma_f32_16x16x32_bf16 v[80:83], v[48:51], a[232:235], v[80:83]
  s_cmp_eq_u32 s45, s60
  s_cselect_b32 s38, s29, 0x28000
  ds_read_b64_tr_b16 v[46:47], v7 offset:9216
  v_mfma_f32_16x16x32_bf16 v[84:87], v[48:51], a[236:239], v[84:87]
  s_waitcnt lgkmcnt(6)
  ds_read_b128 a[224:227], v14 offset:2048
  v_accvgpr_read_b32 v28, a164
  v_mfma_f32_16x16x32_bf16 v[172:175], v[52:55], a[228:231], v[172:175]
  ds_read_b64_tr_b16 v[48:49], v6 offset:1536
  v_accvgpr_read_b32 v29, a165
  v_mfma_f32_16x16x32_bf16 v[176:179], v[52:55], a[232:235], v[176:179]
  ds_read_b64_tr_b16 v[50:51], v6 offset:9728
  v_accvgpr_read_b32 v30, a166
  v_mfma_f32_16x16x32_bf16 v[180:183], v[52:55], a[236:239], v[180:183]
  s_waitcnt lgkmcnt(6)
  v_accvgpr_read_b32 v31, a167
  v_mul_f32 v24, v24, v60
  v_mfma_f32_16x16x32_bf16 v[88:91], v[40:43], a[228:231], v[88:91]
  s_waitcnt lgkmcnt(2)
  ds_read_b64_tr_b16 v[52:53], v7 offset:1536
  v_mul_f32 v25, v25, v60
  v_mfma_f32_16x16x32_bf16 v[92:95], v[40:43], a[232:235], v[92:95]
  s_add_u32 m0, s39, 0
  ds_read_b64_tr_b16 v[54:55], v7 offset:9728
  v_mul_f32 v26, v26, v60
  v_mfma_f32_16x16x32_bf16 v[96:99], v[40:43], a[236:239], v[96:99]
  s_waitcnt lgkmcnt(5)
  buffer_load_dwordx4 v21, s[16:19], s40 offen offset:64 lds
  v_mfma_f32_16x16x32_bf16 v[184:187], v[44:47], a[228:231], v[184:187]
  s_cmp_eq_u32 s45, 1
  s_cselect_b32 s12, s56, s12
  s_cselect_b32 s13, s57, s13
  s_cselect_b32 s14, s58, s14
  ds_read_b64_tr_b16 v[40:41], v6 offset:2048
  v_mfma_f32_16x16x32_bf16 v[188:191], v[44:47], a[232:235], v[188:191]
  s_add_u32 m0, s39, 1024
  ds_read_b64_tr_b16 v[42:43], v6 offset:10240
  v_mul_f32 v27, v27, v60
  v_mfma_f32_16x16x32_bf16 v[192:195], v[44:47], a[236:239], v[192:195]
  s_waitcnt lgkmcnt(4)
  buffer_load_dwordx4 v21, s[16:19], s54 offen offset:64 lds
  v_mfma_f32_16x16x32_bf16 v[100:103], v[48:51], a[228:231], v[100:103]
  ds_read_b64_tr_b16 v[44:45], v7 offset:2048
  v_mul_f32 v28, v28, v60
  v_mfma_f32_16x16x32_bf16 v[104:107], v[48:51], a[232:235], v[104:107]
  s_add_u32 m0, s39, 2048
  ds_read_b64_tr_b16 v[46:47], v7 offset:10240
  v_mul_f32 v29, v29, v60
  v_mfma_f32_16x16x32_bf16 v[108:111], v[48:51], a[236:239], v[108:111]
  s_waitcnt lgkmcnt(4)
  buffer_load_dwordx4 v21, s[16:19], s55 offen offset:64 lds
  v_mfma_f32_16x16x32_bf16 v[196:199], v[52:55], a[228:231], v[196:199]
  s_cmp_eq_u32 s45, 1
  s_cselect_b64 vcc, -1, 0
  ds_read_b64_tr_b16 v[48:49], v6 offset:2560
  v_mfma_f32_16x16x32_bf16 v[200:203], v[52:55], a[232:235], v[200:203]
  ds_read_b64_tr_b16 v[50:51], v6 offset:10752
  v_mul_f32 v30, v30, v60
  v_mfma_f32_16x16x32_bf16 v[204:207], v[52:55], a[236:239], v[204:207]
  s_waitcnt lgkmcnt(4)
  v_cndmask_b32 v11, v11, v22, vcc
  v_mul_f32 v31, v31, v60
  v_mfma_f32_16x16x32_bf16 v[112:115], v[40:43], a[228:231], v[112:115]
  s_waitcnt vmcnt(10)
  ds_read_b64_tr_b16 v[52:53], v7 offset:2560
  v_cvt_pk_bf16_f32 v24, v24, v25
  v_mfma_f32_16x16x32_bf16 v[116:119], v[40:43], a[232:235], v[116:119]
  s_barrier
  s_add_u32 m0, s38, s46
  ds_read_b64_tr_b16 v[54:55], v7 offset:10752
  v_mfma_f32_16x16x32_bf16 v[120:123], v[40:43], a[236:239], v[120:123]
  s_waitcnt lgkmcnt(4)
  buffer_load_dwordx4 v8, s[4:7], s26 offen offset:0 nt lds
  v_mfma_f32_16x16x32_bf16 v[208:211], v[44:47], a[228:231], v[208:211]
  ds_read_b64_tr_b16 v[40:41], v6 offset:3072
  v_cvt_pk_bf16_f32 v25, v26, v27
  v_mfma_f32_16x16x32_bf16 v[212:215], v[44:47], a[232:235], v[212:215]
  s_add_u32 m0, s31, s50
  ds_read_b64_tr_b16 v[42:43], v6 offset:11264
  v_cvt_pk_bf16_f32 v26, v28, v29
  v_mfma_f32_16x16x32_bf16 v[216:219], v[44:47], a[236:239], v[216:219]
  s_waitcnt lgkmcnt(4)
  buffer_load_dwordx4 v11, s[12:15], s28 offen offset:0 lds
  v_mfma_f32_16x16x32_bf16 v[124:127], v[48:51], a[228:231], v[124:127]
  s_add_u32 s34, s34, 16384
  ds_read_b64_tr_b16 v[44:45], v7 offset:3072
  v_cvt_pk_bf16_f32 v27, v30, v31
  v_mfma_f32_16x16x32_bf16 v[128:131], v[48:51], a[232:235], v[128:131]
  s_add_u32 m0, s38, s47
  ds_read_b64_tr_b16 v[46:47], v7 offset:11264
  v_accvgpr_write_b32 a152, v24
  v_mfma_f32_16x16x32_bf16 v[132:135], v[48:51], a[236:239], v[132:135]
  s_waitcnt lgkmcnt(4)
  buffer_load_dwordx4 v8, s[4:7], s26 offen offset:256 nt lds
  v_mfma_f32_16x16x32_bf16 v[220:223], v[52:55], a[228:231], v[220:223]
  s_and_b32 s34, s34, 65535
  ds_read_b64_tr_b16 v[48:49], v6 offset:3584
  v_accvgpr_write_b32 a153, v25
  v_mfma_f32_16x16x32_bf16 v[224:227], v[52:55], a[232:235], v[224:227]
  s_add_u32 m0, s31, s51
  ds_read_b64_tr_b16 v[50:51], v6 offset:11776
  v_accvgpr_write_b32 a154, v26
  v_mfma_f32_16x16x32_bf16 v[228:231], v[52:55], a[236:239], v[228:231]
  s_waitcnt lgkmcnt(4)
  buffer_load_dwordx4 v11, s[12:15], s98 offen offset:128 lds
  v_mfma_f32_16x16x32_bf16 v[136:139], v[40:43], a[228:231], v[136:139]
  ds_read_b64_tr_b16 v[52:53], v7 offset:3584
  v_add_u32 v6, s34, v3
  v_mfma_f32_16x16x32_bf16 v[140:143], v[40:43], a[232:235], v[140:143]
  s_add_u32 m0, s38, s48
  ds_read_b64_tr_b16 v[54:55], v7 offset:11776
  v_add_u32 v7, s34, v4
  v_mfma_f32_16x16x32_bf16 v[144:147], v[40:43], a[236:239], v[144:147]
  s_waitcnt lgkmcnt(4)
  buffer_load_dwordx4 v9, s[4:7], s26 offen offset:0 nt lds
  v_mfma_f32_16x16x32_bf16 v[232:235], v[44:47], a[228:231], v[232:235]
  ds_read_b64_tr_b16 v[40:41], v6 offset:0
  v_accvgpr_write_b32 a155, v27
  v_mfma_f32_16x16x32_bf16 v[236:239], v[44:47], a[232:235], v[236:239]
  s_add_u32 m0, s31, s52
  ds_read_b64_tr_b16 v[42:43], v6 offset:8192
  v_accvgpr_read_b32 v32, a168
  v_mfma_f32_16x16x32_bf16 v[240:243], v[44:47], a[236:239], v[240:243]
  s_waitcnt lgkmcnt(4)
  buffer_load_dwordx4 v11, s[12:15], s99 offen offset:256 lds
  v_mfma_f32_16x16x32_bf16 v[148:151], v[48:51], a[228:231], v[148:151]
  ds_read_b64_tr_b16 v[44:45], v7 offset:0
  v_accvgpr_read_b32 v33, a169
  v_mfma_f32_16x16x32_bf16 v[152:155], v[48:51], a[232:235], v[152:155]
  s_add_u32 m0, s38, s49
  ds_read_b64_tr_b16 v[46:47], v7 offset:8192
  v_accvgpr_read_b32 v34, a170
  v_mfma_f32_16x16x32_bf16 v[156:159], v[48:51], a[236:239], v[156:159]
  s_waitcnt lgkmcnt(4)
  buffer_load_dwordx4 v9, s[4:7], s26 offen offset:256 nt lds
  v_mfma_f32_16x16x32_bf16 v[244:247], v[52:55], a[228:231], v[244:247]
  ds_read_b64_tr_b16 v[48:49], v6 offset:512
  v_accvgpr_read_b32 v35, a171
  v_mfma_f32_16x16x32_bf16 v[248:251], v[52:55], a[232:235], v[248:251]
  s_add_u32 m0, s31, s53
  ds_read_b64_tr_b16 v[50:51], v6 offset:8704
  v_accvgpr_read_b32 v36, a180
  v_mfma_f32_16x16x32_bf16 v[252:255], v[52:55], a[236:239], v[252:255]
  s_waitcnt lgkmcnt(4)
  buffer_load_dwordx4 v11, s[12:15], s100 offen offset:384 lds
  s_add_u32 s35, s35, 262144
  s_cmp_eq_u32 s35, 3670016
  s_cselect_b32 s35, 0, s35
  s_add_u32 s31, s31, 16384
  s_and_b32 s31, s31, 65535
  s_add_u32 s28, s35, s36
  s_add_u32 s98, s41, 114688
  s_cmp_eq_u32 s45, 1
  s_cselect_b32 s28, s98, s28
  s_cselect_b32 s101, 28544, 0
  s_add_u32 s98, s28, s101
  s_add_u32 s99, s98, s101
  s_add_u32 s100, s99, s101
  v_mfma_f32_16x16x32_bf16 v[64:67], v[40:43], a[216:219], v[64:67]
  s_add_u32 s26, s26, s61
  s_add_u32 s29, s29, s61
  ds_read_b64_tr_b16 v[52:53], v7 offset:512
  v_mfma_f32_16x16x32_bf16 v[68:71], v[40:43], a[220:223], v[68:71]
  s_waitcnt vmcnt(8)
  ds_read_b64_tr_b16 v[54:55], v7 offset:8704
  v_accvgpr_read_b32 v37, a181
  v_mfma_f32_16x16x32_bf16 v[72:75], v[40:43], a[224:227], v[72:75]
  s_waitcnt lgkmcnt(4)
  ds_read_b128 a[228:231], v14 offset:0
  v_accvgpr_read_b32 v38, a182
  v_mfma_f32_16x16x32_bf16 v[160:163], v[44:47], a[216:219], v[160:163]
  s_cmp_eq_u32 s29, 114688
  s_cselect_b32 s29, 65536, s29
  ds_read_b64_tr_b16 v[40:41], v6 offset:1024
  v_mfma_f32_16x16x32_bf16 v[164:167], v[44:47], a[220:223], v[164:167]
  s_cmp_eq_u32 s45, s60
  s_cselect_b32 s38, s29, 0x28000
  ds_read_b64_tr_b16 v[42:43], v6 offset:9216
  v_mfma_f32_16x16x32_bf16 v[168:171], v[44:47], a[224:227], v[168:171]
  s_waitcnt lgkmcnt(5)
  ds_read_b128 a[232:235], v14 offset:1024
  v_accvgpr_read_b32 v39, a183
  v_mfma_f32_16x16x32_bf16 v[76:79], v[48:51], a[216:219], v[76:79]
  s_add_u32 s27, s27, s61
  s_add_u32 s30, s30, s61
  ds_read_b64_tr_b16 v[44:45], v7 offset:1024
  v_mfma_f32_16x16x32_bf16 v[80:83], v[48:51], a[220:223], v[80:83]
  s_cmp_eq_u32 s30, 163840
  s_cselect_b32 s30, 114688, s30
  ds_read_b64_tr_b16 v[46:47], v7 offset:9216
  v_mfma_f32_16x16x32_bf16 v[84:87], v[48:51], a[224:227], v[84:87]
  s_waitcnt lgkmcnt(6)
  ds_read_b128 a[236:239], v14 offset:2048
  v_mul_f32 v32, v32, v56
  v_mfma_f32_16x16x32_bf16 v[172:175], v[52:55], a[216:219], v[172:175]
  s_cmp_eq_u32 s45, s60
  s_cselect_b32 s54, s30, 0x28000
  ds_read_b64_tr_b16 v[48:49], v6 offset:1536
  v_mfma_f32_16x16x32_bf16 v[176:179], v[52:55], a[220:223], v[176:179]
  s_add_u32 m0, s38, s46
  ds_read_b64_tr_b16 v[50:51], v6 offset:9728
  v_mul_f32 v33, v33, v56
  v_mfma_f32_16x16x32_bf16 v[180:183], v[52:55], a[224:227], v[180:183]
  s_waitcnt lgkmcnt(6)
  buffer_load_dwordx4 v8, s[4:7], s26 offen offset:0 nt lds
  v_mfma_f32_16x16x32_bf16 v[88:91], v[40:43], a[216:219], v[88:91]
  s_waitcnt lgkmcnt(2)
  ds_read_b64_tr_b16 v[52:53], v7 offset:1536
  v_mul_f32 v34, v34, v56
  v_mfma_f32_16x16x32_bf16 v[92:95], v[40:43], a[220:223], v[92:95]
  s_add_u32 m0, s38, s47
  ds_read_b64_tr_b16 v[54:55], v7 offset:9728
  v_mul_f32 v35, v35, v56
  v_mfma_f32_16x16x32_bf16 v[96:99], v[40:43], a[224:227], v[96:99]
  s_waitcnt lgkmcnt(5)
  buffer_load_dwordx4 v8, s[4:7], s26 offen offset:256 nt lds
  v_mfma_f32_16x16x32_bf16 v[184:187], v[44:47], a[216:219], v[184:187]
  ds_read_b64_tr_b16 v[40:41], v6 offset:2048
  v_mul_f32 v36, v36, v56
  v_mfma_f32_16x16x32_bf16 v[188:191], v[44:47], a[220:223], v[188:191]
  s_add_u32 m0, s38, s48
  ds_read_b64_tr_b16 v[42:43], v6 offset:10240
  v_mul_f32 v37, v37, v56
  v_mfma_f32_16x16x32_bf16 v[192:195], v[44:47], a[224:227], v[192:195]
  s_waitcnt lgkmcnt(4)
  buffer_load_dwordx4 v9, s[4:7], s26 offen offset:0 nt lds
  v_mfma_f32_16x16x32_bf16 v[100:103], v[48:51], a[216:219], v[100:103]
  ds_read_b64_tr_b16 v[44:45], v7 offset:2048
  v_mul_f32 v38, v38, v56
  v_mfma_f32_16x16x32_bf16 v[104:107], v[48:51], a[220:223], v[104:107]
  s_add_u32 m0, s38, s49
  ds_read_b64_tr_b16 v[46:47], v7 offset:10240
  v_mul_f32 v39, v39, v56
  v_mfma_f32_16x16x32_bf16 v[108:111], v[48:51], a[224:227], v[108:111]
  s_waitcnt lgkmcnt(4)
  buffer_load_dwordx4 v9, s[4:7], s26 offen offset:256 nt lds
  v_mfma_f32_16x16x32_bf16 v[196:199], v[52:55], a[216:219], v[196:199]
  ds_read_b64_tr_b16 v[48:49], v6 offset:2560
  v_cvt_pk_bf16_f32 v32, v32, v33
  v_mfma_f32_16x16x32_bf16 v[200:203], v[52:55], a[220:223], v[200:203]
  ds_read_b64_tr_b16 v[50:51], v6 offset:10752
  v_cvt_pk_bf16_f32 v33, v34, v35
  v_mfma_f32_16x16x32_bf16 v[204:207], v[52:55], a[224:227], v[204:207]
  s_waitcnt lgkmcnt(4)
  v_cvt_pk_bf16_f32 v34, v36, v37
  v_cvt_pk_bf16_f32 v35, v38, v39
  v_mfma_f32_16x16x32_bf16 v[112:115], v[40:43], a[216:219], v[112:115]
  s_waitcnt vmcnt(15)
  ds_read_b64_tr_b16 v[52:53], v7 offset:2560
  v_accvgpr_write_b32 a168, v32
  v_mfma_f32_16x16x32_bf16 v[116:119], v[40:43], a[220:223], v[116:119]
  s_barrier
  s_add_u32 m0, s54, s50
  ds_read_b64_tr_b16 v[54:55], v7 offset:10752
  v_mfma_f32_16x16x32_bf16 v[120:123], v[40:43], a[224:227], v[120:123]
  s_waitcnt lgkmcnt(4)
  buffer_load_dwordx4 v10, s[8:11], s27 offen offset:0 nt lds
  v_mfma_f32_16x16x32_bf16 v[208:211], v[44:47], a[216:219], v[208:211]
  ds_read_b64_tr_b16 v[40:41], v6 offset:3072
  v_accvgpr_write_b32 a169, v33
  v_mfma_f32_16x16x32_bf16 v[212:215], v[44:47], a[220:223], v[212:215]
  s_add_u32 m0, s31, s50
  ds_read_b64_tr_b16 v[42:43], v6 offset:11264
  v_accvgpr_write_b32 a170, v34
  v_mfma_f32_16x16x32_bf16 v[216:219], v[44:47], a[224:227], v[216:219]
  s_waitcnt lgkmcnt(4)
  buffer_load_dwordx4 v11, s[12:15], s28 offen offset:0 lds
  v_mfma_f32_16x16x32_bf16 v[124:127], v[48:51], a[216:219], v[124:127]
  s_add_u32 s34, s34, 16384
  ds_read_b64_tr_b16 v[44:45], v7 offset:3072
  v_accvgpr_write_b32 a171, v35
  v_mfma_f32_16x16x32_bf16 v[128:131], v[48:51], a[220:223], v[128:131]
  s_add_u32 m0, s54, s51
  ds_read_b64_tr_b16 v[46:47], v7 offset:11264
  v_accvgpr_read_b32 v24, a172
  v_mfma_f32_16x16x32_bf16 v[132:135], v[48:51], a[224:227], v[132:135]
  s_waitcnt lgkmcnt(4)
  buffer_load_dwordx4 v10, s[8:11], s27 offen offset:128 nt lds
  v_mfma_f32_16x16x32_bf16 v[220:223], v[52:55], a[216:219], v[220:223]
  s_and_b32 s34, s34, 65535
  ds_read_b64_tr_b16 v[48:49], v6 offset:3584
  v_accvgpr_read_b32 v25, a173
  v_mfma_f32_16x16x32_bf16 v[224:227], v[52:55], a[220:223], v[224:227]
  s_add_u32 m0, s31, s51
  ds_read_b64_tr_b16 v[50:51], v6 offset:11776
  v_accvgpr_read_b32 v26, a174
  v_mfma_f32_16x16x32_bf16 v[228:231], v[52:55], a[224:227], v[228:231]
  s_waitcnt lgkmcnt(4)
  buffer_load_dwordx4 v11, s[12:15], s98 offen offset:128 lds
  v_mfma_f32_16x16x32_bf16 v[136:139], v[40:43], a[216:219], v[136:139]
  ds_read_b64_tr_b16 v[52:53], v7 offset:3584
  v_add_u32 v6, s34, v3
  v_mfma_f32_16x16x32_bf16 v[140:143], v[40:43], a[220:223], v[140:143]
  s_add_u32 m0, s54, s52
  ds_read_b64_tr_b16 v[54:55], v7 offset:11776
  v_add_u32 v7, s34, v4
  v_mfma_f32_16x16x32_bf16 v[144:147], v[40:43], a[224:227], v[144:147]
  s_waitcnt lgkmcnt(4)
  buffer_load_dwordx4 v10, s[8:11], s27 offen offset:256 nt lds
  v_mfma_f32_16x16x32_bf16 v[232:235], v[44:47], a[216:219], v[232:235]
  ds_read_b64_tr_b16 v[40:41], v6 offset:0
  v_accvgpr_read_b32 v27, a175
  v_mfma_f32_16x16x32_bf16 v[236:239], v[44:47], a[220:223], v[236:239]
  s_add_u32 m0, s31, s52
  ds_read_b64_tr_b16 v[42:43], v6 offset:8192
  v_accvgpr_read_b32 v28, a184
  v_mfma_f32_16x16x32_bf16 v[240:243], v[44:47], a[224:227], v[240:243]
  s_waitcnt lgkmcnt(4)
  buffer_load_dwordx4 v11, s[12:15], s99 offen offset:256 lds
  v_mfma_f32_16x16x32_bf16 v[148:151], v[48:51], a[216:219], v[148:151]
  ds_read_b64_tr_b16 v[44:45], v7 offset:0
  v_accvgpr_read_b32 v29, a185
  v_mfma_f32_16x16x32_bf16 v[152:155], v[48:51], a[220:223], v[152:155]
  s_add_u32 m0, s54, s53
  ds_read_b64_tr_b16 v[46:47], v7 offset:8192
  v_accvgpr_read_b32 v30, a186
  v_mfma_f32_16x16x32_bf16 v[156:159], v[48:51], a[224:227], v[156:159]
  s_waitcnt lgkmcnt(4)
  buffer_load_dwordx4 v10, s[8:11], s27 offen offset:384 nt lds
  v_mfma_f32_16x16x32_bf16 v[244:247], v[52:55], a[216:219], v[244:247]
  ds_read_b64_tr_b16 v[48:49], v6 offset:512
  v_accvgpr_read_b32 v31, a187
  v_mfma_f32_16x16x32_bf16 v[248:251], v[52:55], a[220:223], v[248:251]
  s_add_u32 m0, s31, s53
  ds_read_b64_tr_b16 v[50:51], v6 offset:8704
  v_mul_f32 v24, v24, v58
  v_mfma_f32_16x16x32_bf16 v[252:255], v[52:55], a[224:227], v[252:255]
  s_waitcnt lgkmcnt(4)
  buffer_load_dwordx4 v11, s[12:15], s100 offen offset:384 lds
  v_mul_f32 v25, v25, v58
  v_mul_f32 v26, v26, v58
  v_mul_f32 v27, v27, v58
  v_mul_f32 v28, v28, v58
  v_mul_f32 v29, v29, v58
  v_mul_f32 v30, v30, v58
  v_mul_f32 v31, v31, v58
  v_cvt_pk_bf16_f32 v24, v24, v25
  v_cvt_pk_bf16_f32 v25, v26, v27
  v_cvt_pk_bf16_f32 v26, v28, v29
  v_cvt_pk_bf16_f32 v27, v30, v31
  v_accvgpr_write_b32 a172, v24
  v_accvgpr_write_b32 a173, v25
  v_accvgpr_write_b32 a174, v26
  v_accvgpr_write_b32 a175, v27
  v_accvgpr_read_b32 v32, a176
  v_accvgpr_read_b32 v33, a177
  v_accvgpr_read_b32 v34, a178
  v_accvgpr_read_b32 v35, a179
  v_accvgpr_read_b32 v36, a188
  v_accvgpr_read_b32 v37, a189
  v_accvgpr_read_b32 v38, a190
  v_accvgpr_read_b32 v39, a191
  v_mul_f32 v32, v32, v60
  v_mul_f32 v33, v33, v60
  v_mul_f32 v34, v34, v60
  v_mul_f32 v35, v35, v60
  v_mul_f32 v36, v36, v60
  v_mul_f32 v37, v37, v60
  v_mul_f32 v38, v38, v60
  v_mul_f32 v39, v39, v60
  v_cvt_pk_bf16_f32 v32, v32, v33
  v_cvt_pk_bf16_f32 v33, v34, v35
  v_cvt_pk_bf16_f32 v34, v36, v37
  v_cvt_pk_bf16_f32 v35, v38, v39
  v_accvgpr_write_b32 a176, v32
  v_accvgpr_write_b32 a177, v33
  v_accvgpr_write_b32 a178, v34
  v_accvgpr_write_b32 a179, v35
  s_add_u32 s35, s35, 262144
  s_cmp_eq_u32 s35, 3670016
  s_cselect_b32 s35, 0, s35
  s_add_u32 s31, s31, 16384
  s_and_b32 s31, s31, 65535
  s_add_u32 s28, s35, s36
  s_add_u32 s98, s41, 229376
  s_cmp_eq_u32 s45, 1
  s_cselect_b32 s28, s98, s28
  s_cselect_b32 s101, 28544, 0
  s_add_u32 s98, s28, s101
  s_add_u32 s99, s98, s101
  s_add_u32 s100, s99, s101
  v_mfma_f32_16x16x32_bf16 v[64:67], v[40:43], a[228:231], v[64:67]
  s_add_u32 s26, s26, s61
  s_add_u32 s29, s29, s61
  ds_read_b64_tr_b16 v[52:53], v7 offset:512
  v_mfma_f32_16x16x32_bf16 v[68:71], v[40:43], a[232:235], v[68:71]
  s_cmp_eq_u32 s29, 114688
  s_cselect_b32 s29, 65536, s29
  ds_read_b64_tr_b16 v[54:55], v7 offset:8704
  v_mfma_f32_16x16x32_bf16 v[72:75], v[40:43], a[236:239], v[72:75]
  s_waitcnt lgkmcnt(4)
  v_mfma_f32_16x16x32_bf16 v[160:163], v[44:47], a[228:231], v[160:163]
  s_cmp_eq_u32 s45, s60
  s_cselect_b32 s38, s29, 0x28000
  ds_read_b64_tr_b16 v[40:41], v6 offset:1024
  v_mfma_f32_16x16x32_bf16 v[164:167], v[44:47], a[232:235], v[164:167]
  ds_read_b64_tr_b16 v[42:43], v6 offset:9216
  v_cvt_pk_bf16_f32 v64, v64, v65
  v_mfma_f32_16x16x32_bf16 v[168:171], v[44:47], a[236:239], v[168:171]
  s_waitcnt lgkmcnt(4)
  v_cvt_pk_bf16_f32 v65, v66, v67
  v_cvt_pk_bf16_f32 v66, v160, v161
  v_mfma_f32_16x16x32_bf16 v[76:79], v[48:51], a[228:231], v[76:79]
  ds_read_b64_tr_b16 v[44:45], v7 offset:1024
  v_cvt_pk_bf16_f32 v67, v162, v163
  v_mfma_f32_16x16x32_bf16 v[80:83], v[48:51], a[232:235], v[80:83]
  s_add_u32 m0, s38, s46
  ds_read_b64_tr_b16 v[46:47], v7 offset:9216
  v_cvt_pk_bf16_f32 v68, v68, v69
  v_mfma_f32_16x16x32_bf16 v[84:87], v[48:51], a[236:239], v[84:87]
  s_waitcnt lgkmcnt(4)
  buffer_load_dwordx4 v8, s[4:7], s26 offen offset:0 nt lds
  v_mfma_f32_16x16x32_bf16 v[172:175], v[52:55], a[228:231], v[172:175]
  ds_read_b64_tr_b16 v[48:49], v6 offset:1536
  v_cvt_pk_bf16_f32 v69, v70, v71
  v_mfma_f32_16x16x32_bf16 v[176:179], v[52:55], a[232:235], v[176:179]
  ds_read_b64_tr_b16 v[50:51], v6 offset:9728
  v_cvt_pk_bf16_f32 v70, v164, v165
  v_mfma_f32_16x16x32_bf16 v[180:183], v[52:55], a[236:239], v[180:183]
  s_waitcnt lgkmcnt(4)
  v_cvt_pk_bf16_f32 v71, v166, v167
  v_permlane32_swap_b32 v64, v66
  v_mfma_f32_16x16x32_bf16 v[88:91], v[40:43], a[228:231], v[88:91]
  ds_read_b64_tr_b16 v[52:53], v7 offset:1536
  v_permlane32_swap_b32 v65, v67
  v_mfma_f32_16x16x32_bf16 v[92:95], v[40:43], a[232:235], v[92:95]
  s_add_u32 m0, s38, s47
  ds_read_b64_tr_b16 v[54:55], v7 offset:9728
  v_cvt_pk_bf16_f32 v72, v72, v73
  v_mfma_f32_16x16x32_bf16 v[96:99], v[40:43], a[236:239], v[96:99]
  s_waitcnt lgkmcnt(4)
  buffer_load_dwordx4 v8, s[4:7], s26 offen offset:256 nt lds
  v_mfma_f32_16x16x32_bf16 v[184:187], v[44:47], a[228:231], v[184:187]
  ds_read_b64_tr_b16 v[40:41], v6 offset:2048
  v_cvt_pk_bf16_f32 v73, v74, v75
  v_mfma_f32_16x16x32_bf16 v[188:191], v[44:47], a[232:235], v[188:191]
  ds_read_b64_tr_b16 v[42:43], v6 offset:10240
  v_cvt_pk_bf16_f32 v74, v168, v169
  v_mfma_f32_16x16x32_bf16 v[192:195], v[44:47], a[236:239], v[192:195]
  s_waitcnt lgkmcnt(4)
  v_cvt_pk_bf16_f32 v75, v170, v171
  v_permlane32_swap_b32 v68, v70
  v_mfma_f32_16x16x32_bf16 v[100:103], v[48:51], a[228:231], v[100:103]
  ds_read_b64_tr_b16 v[44:45], v7 offset:2048
  v_permlane32_swap_b32 v69, v71
  v_mfma_f32_16x16x32_bf16 v[104:107], v[48:51], a[232:235], v[104:107]
  s_add_u32 m0, s38, s48
  ds_read_b64_tr_b16 v[46:47], v7 offset:10240
  v_permlane16_swap_b32 v64, v66
  v_mfma_f32_16x16x32_bf16 v[108:111], v[48:51], a[236:239], v[108:111]
  s_waitcnt lgkmcnt(4)
  buffer_load_dwordx4 v9, s[4:7], s26 offen offset:0 nt lds
  v_mfma_f32_16x16x32_bf16 v[196:199], v[52:55], a[228:231], v[196:199]
  ds_read_b64_tr_b16 v[48:49], v6 offset:2560
  v_permlane16_swap_b32 v65, v67
  v_mfma_f32_16x16x32_bf16 v[200:203], v[52:55], a[232:235], v[200:203]
  s_add_u32 m0, s38, s49
  ds_read_b64_tr_b16 v[50:51], v6 offset:10752
  v_cvt_pk_bf16_f32 v76, v76, v77
  v_mfma_f32_16x16x32_bf16 v[204:207], v[52:55], a[236:239], v[204:207]
  s_waitcnt lgkmcnt(4)
  buffer_load_dwordx4 v9, s[4:7], s26 offen offset:256 nt lds
  v_mfma_f32_16x16x32_bf16 v[112:115], v[40:43], a[228:231], v[112:115]
  s_waitcnt vmcnt(17)
  ds_read_b64_tr_b16 v[52:53], v7 offset:2560
  v_cvt_pk_bf16_f32 v77, v78, v79
  v_mfma_f32_16x16x32_bf16 v[116:119], v[40:43], a[232:235], v[116:119]
  s_barrier
  ds_read_b64_tr_b16 v[54:55], v7 offset:10752
  v_cvt_pk_bf16_f32 v78, v172, v173
  v_mfma_f32_16x16x32_bf16 v[120:123], v[40:43], a[236:239], v[120:123]
  s_waitcnt lgkmcnt(4)
  v_cvt_pk_bf16_f32 v79, v174, v175
  v_permlane32_swap_b32 v72, v74
  v_mfma_f32_16x16x32_bf16 v[208:211], v[44:47], a[228:231], v[208:211]
  ds_read_b64_tr_b16 v[40:41], v6 offset:3072
  v_permlane32_swap_b32 v73, v75
  v_mfma_f32_16x16x32_bf16 v[212:215], v[44:47], a[232:235], v[212:215]
  s_add_u32 m0, s31, s50
  ds_read_b64_tr_b16 v[42:43], v6 offset:11264
  v_permlane16_swap_b32 v68, v70
  v_mfma_f32_16x16x32_bf16 v[216:219], v[44:47], a[236:239], v[216:219]
  s_waitcnt lgkmcnt(4)
  buffer_load_dwordx4 v11, s[12:15], s28 offen offset:0 lds
  v_mfma_f32_16x16x32_bf16 v[124:127], v[48:51], a[228:231], v[124:127]
  ds_read_b64_tr_b16 v[44:45], v7 offset:3072
  v_permlane16_swap_b32 v69, v71
  v_mfma_f32_16x16x32_bf16 v[128:131], v[48:51], a[232:235], v[128:131]
  ds_read_b64_tr_b16 v[46:47], v7 offset:11264
  v_cvt_pk_bf16_f32 v80, v80, v81
  v_mfma_f32_16x16x32_bf16 v[132:135], v[48:51], a[236:239], v[132:135]
  s_waitcnt lgkmcnt(4)
  v_cvt_pk_bf16_f32 v81, v82, v83
  v_cvt_pk_bf16_f32 v82, v176, v177
  v_mfma_f32_16x16x32_bf16 v[220:223], v[52:55], a[228:231], v[220:223]
  ds_read_b64_tr_b16 v[48:49], v6 offset:3584
  v_cvt_pk_bf16_f32 v83, v178, v179
  v_mfma_f32_16x16x32_bf16 v[224:227], v[52:55], a[232:235], v[224:227]
  s_add_u32 m0, s31, s51
  ds_read_b64_tr_b16 v[50:51], v6 offset:11776
  v_permlane32_swap_b32 v76, v78
  v_mfma_f32_16x16x32_bf16 v[228:231], v[52:55], a[236:239], v[228:231]
  s_waitcnt lgkmcnt(4)
  buffer_load_dwordx4 v11, s[12:15], s98 offen offset:128 lds
  v_mfma_f32_16x16x32_bf16 v[136:139], v[40:43], a[228:231], v[136:139]
  ds_read_b64_tr_b16 v[52:53], v7 offset:3584
  v_permlane32_swap_b32 v77, v79
  v_mfma_f32_16x16x32_bf16 v[140:143], v[40:43], a[232:235], v[140:143]
  ds_read_b64_tr_b16 v[54:55], v7 offset:11776
  v_permlane16_swap_b32 v72, v74
  v_mfma_f32_16x16x32_bf16 v[144:147], v[40:43], a[236:239], v[144:147]
  s_waitcnt lgkmcnt(4)
  v_permlane16_swap_b32 v73, v75
  v_cvt_pk_bf16_f32 v84, v84, v85
  v_mfma_f32_16x16x32_bf16 v[232:235], v[44:47], a[228:231], v[232:235]
  ds_read_b128 v[24:27], v5 offset:0
  v_cvt_pk_bf16_f32 v85, v86, v87
  v_mfma_f32_16x16x32_bf16 v[236:239], v[44:47], a[232:235], v[236:239]
  s_add_u32 m0, s31, s52
  v_cvt_pk_bf16_f32 v86, v180, v181
  v_cvt_pk_bf16_f32 v87, v182, v183
  v_mfma_f32_16x16x32_bf16 v[240:243], v[44:47], a[236:239], v[240:243]
  s_waitcnt lgkmcnt(3)
  buffer_load_dwordx4 v11, s[12:15], s99 offen offset:256 lds
  v_mfma_f32_16x16x32_bf16 v[148:151], v[48:51], a[228:231], v[148:151]
  ds_read_b128 v[28:31], v5 offset:8192
  v_permlane32_swap_b32 v80, v82
  v_mfma_f32_16x16x32_bf16 v[152:155], v[48:51], a[232:235], v[152:155]
  v_permlane32_swap_b32 v81, v83
  v_permlane16_swap_b32 v76, v78
  v_mfma_f32_16x16x32_bf16 v[156:159], v[48:51], a[236:239], v[156:159]
  s_waitcnt lgkmcnt(2)
  v_permlane16_swap_b32 v77, v79
  v_cvt_pk_bf16_f32 v88, v88, v89
  v_mfma_f32_16x16x32_bf16 v[244:247], v[52:55], a[228:231], v[244:247]
  ds_read_b128 v[32:35], v5 offset:256
  v_cvt_pk_bf16_f32 v89, v90, v91
  v_mfma_f32_16x16x32_bf16 v[248:251], v[52:55], a[232:235], v[248:251]
  s_add_u32 m0, s31, s53
  v_cvt_pk_bf16_f32 v90, v184, v185
  v_cvt_pk_bf16_f32 v91, v186, v187
  v_mfma_f32_16x16x32_bf16 v[252:255], v[52:55], a[236:239], v[252:255]
  s_waitcnt lgkmcnt(2)
  buffer_load_dwordx4 v11, s[12:15], s100 offen offset:384 lds
  s_nop 0
  s_add_u32 s35, s35, 262144
  s_cmp_eq_u32 s35, 3670016
  s_cselect_b32 s35, 0, s35
  s_add_u32 s31, s31, 16384
  s_and_b32 s31, s31, 65535
  s_add_u32 s28, s35, s36
  s_add_u32 s98, s41, 344064
  s_cmp_eq_u32 s45, 1
  s_cselect_b32 s28, s98, s28
  s_cselect_b32 s101, 28544, 0
  s_add_u32 s98, s28, s101
  s_add_u32 s99, s98, s101
  s_add_u32 s100, s99, s101
  v_mfma_f32_16x16x32_bf16 v[160:163], v[24:27], v[64:67], 0
  s_add_u32 s27, s27, s61
  s_add_u32 s30, s30, s61
  ds_read_b128 v[36:39], v5 offset:8448
  v_mfma_f32_16x16x32_bf16 v[164:167], v[24:27], v[68:71], 0
  s_cmp_eq_u32 s30, 163840
  s_cselect_b32 s30, 114688, s30
  v_permlane32_swap_b32 v84, v86
  v_mfma_f32_16x16x32_bf16 v[168:171], v[24:27], v[72:75], 0
  s_waitcnt lgkmcnt(2)
  v_permlane32_swap_b32 v85, v87
  v_permlane16_swap_b32 v80, v82
  v_mfma_f32_16x16x32_bf16 v[172:175], v[28:31], v[64:67], 0
  s_cmp_eq_u32 s45, s60
  s_cselect_b32 s54, s30, 0x28000
  ds_read_b128 v[24:27], v5 offset:512
  v_permlane16_swap_b32 v81, v83
  v_mfma_f32_16x16x32_bf16 v[176:179], v[28:31], v[68:71], 0
  v_cvt_pk_bf16_f32 v92, v92, v93
  v_cvt_pk_bf16_f32 v93, v94, v95
  v_cvt_pk_bf16_f32 v94, v188, v189
  v_cvt_pk_bf16_f32 v95, v190, v191
  v_permlane32_swap_b32 v88, v90
  v_permlane32_swap_b32 v89, v91
  v_permlane16_swap_b32 v84, v86
  v_permlane16_swap_b32 v85, v87
  v_mfma_f32_16x16x32_bf16 v[180:183], v[28:31], v[72:75], 0
  s_waitcnt lgkmcnt(2)
  v_cvt_pk_bf16_f32 v96, v96, v97
  v_cvt_pk_bf16_f32 v97, v98, v99
  v_mfma_f32_16x16x32_bf16 v[160:163], v[32:35], v[76:79], v[160:163]
  ds_read_b128 v[28:31], v5 offset:8704
  v_cvt_pk_bf16_f32 v98, v192, v193
  v_mfma_f32_16x16x32_bf16 v[164:167], v[32:35], v[80:83], v[164:167]
  s_add_u32 m0, s54, s50
  v_cvt_pk_bf16_f32 v99, v194, v195
  v_permlane32_swap_b32 v92, v94
  v_permlane32_swap_b32 v93, v95
  v_permlane16_swap_b32 v88, v90
  v_permlane16_swap_b32 v89, v91
  v_mfma_f32_16x16x32_bf16 v[168:171], v[32:35], v[84:87], v[168:171]
  s_waitcnt lgkmcnt(2)
  buffer_load_dwordx4 v10, s[8:11], s27 offen offset:0 nt lds
  v_mfma_f32_16x16x32_bf16 v[172:175], v[36:39], v[76:79], v[172:175]
  ds_read_b128 v[32:35], v5 offset:768
  v_cvt_pk_bf16_f32 v100, v100, v101
  v_mfma_f32_16x16x32_bf16 v[176:179], v[36:39], v[80:83], v[176:179]
  v_cvt_pk_bf16_f32 v101, v102, v103
  v_cvt_pk_bf16_f32 v102, v196, v197
  v_mfma_f32_16x16x32_bf16 v[180:183], v[36:39], v[84:87], v[180:183]
  s_waitcnt lgkmcnt(2)
  v_cvt_pk_bf16_f32 v103, v198, v199
  v_permlane32_swap_b32 v96, v98
  v_permlane32_swap_b32 v97, v99
  v_permlane16_swap_b32 v92, v94
  v_permlane16_swap_b32 v93, v95
  v_mfma_f32_16x16x32_bf16 v[160:163], v[24:27], v[88:91], v[160:163]
  ds_read_b128 v[36:39], v5 offset:8960
  v_cvt_pk_bf16_f32 v104, v104, v105
  v_cvt_pk_bf16_f32 v105, v106, v107
  v_cvt_pk_bf16_f32 v106, v200, v201
  v_cvt_pk_bf16_f32 v107, v202, v203
  v_permlane32_swap_b32 v100, v102
  v_permlane32_swap_b32 v101, v103
  v_permlane16_swap_b32 v96, v98
  v_permlane16_swap_b32 v97, v99
  v_mfma_f32_16x16x32_bf16 v[164:167], v[24:27], v[92:95], v[164:167]
  s_add_u32 m0, s54, s51
  v_cvt_pk_bf16_f32 v108, v108, v109
  v_cvt_pk_bf16_f32 v109, v110, v111
  v_cvt_pk_bf16_f32 v110, v204, v205
  v_cvt_pk_bf16_f32 v111, v206, v207
  v_permlane32_swap_b32 v104, v106
  v_permlane32_swap_b32 v105, v107
  v_permlane16_swap_b32 v100, v102
  v_permlane16_swap_b32 v101, v103
  v_mfma_f32_16x16x32_bf16 v[168:171], v[24:27], v[96:99], v[168:171]
  s_waitcnt lgkmcnt(2)
  buffer_load_dwordx4 v10, s[8:11], s27 offen offset:128 nt lds
  v_mfma_f32_16x16x32_bf16 v[172:175], v[28:31], v[88:91], v[172:175]
  ds_read_b128 v[24:27], v5 offset:1024
  v_cvt_pk_bf16_f32 v112, v112, v113
  v_mfma_f32_16x16x32_bf16 v[176:179], v[28:31], v[92:95], v[176:179]
  v_cvt_pk_bf16_f32 v113, v114, v115
  v_cvt_pk_bf16_f32 v114, v208, v209
  v_mfma_f32_16x16x32_bf16 v[180:183], v[28:31], v[96:99], v[180:183]
  s_waitcnt lgkmcnt(2)
  v_cvt_pk_bf16_f32 v115, v210, v211
  v_permlane32_swap_b32 v108, v110
  v_permlane32_swap_b32 v109, v111
  v_permlane16_swap_b32 v104, v106
  v_permlane16_swap_b32 v105, v107
  v_mfma_f32_16x16x32_bf16 v[160:163], v[32:35], v[100:103], v[160:163]
  ds_read_b128 v[28:31], v5 offset:9216
  v_cvt_pk_bf16_f32 v116, v116, v117
  v_cvt_pk_bf16_f32 v117, v118, v119
  v_cvt_pk_bf16_f32 v118, v212, v213
  v_cvt_pk_bf16_f32 v119, v214, v215
  v_permlane32_swap_b32 v112, v114
  v_permlane32_swap_b32 v113, v115
  v_permlane16_swap_b32 v108, v110
  v_permlane16_swap_b32 v109, v111
  v_mfma_f32_16x16x32_bf16 v[164:167], v[32:35], v[104:107], v[164:167]
  s_add_u32 m0, s54, s52
  v_cvt_pk_bf16_f32 v120, v120, v121
  v_cvt_pk_bf16_f32 v121, v122, v123
  v_cvt_pk_bf16_f32 v122, v216, v217
  v_cvt_pk_bf16_f32 v123, v218, v219
  v_permlane32_swap_b32 v116, v118
  v_permlane32_swap_b32 v117, v119
  v_permlane16_swap_b32 v112, v114
  v_permlane16_swap_b32 v113, v115
  v_mfma_f32_16x16x32_bf16 v[168:171], v[32:35], v[108:111], v[168:171]
  s_waitcnt lgkmcnt(2)
  buffer_load_dwordx4 v10, s[8:11], s27 offen offset:256 nt lds
  v_mfma_f32_16x16x32_bf16 v[172:175], v[36:39], v[100:103], v[172:175]
  ds_read_b128 v[32:35], v5 offset:1280
  v_cvt_pk_bf16_f32 v124, v124, v125
  v_mfma_f32_16x16x32_bf16 v[176:179], v[36:39], v[104:107], v[176:179]
  s_add_u32 m0, s54, s53
  v_cvt_pk_bf16_f32 v125, v126, v127
  v_cvt_pk_bf16_f32 v126, v220, v221
  v_mfma_f32_16x16x32_bf16 v[180:183], v[36:39], v[108:111], v[180:183]
  s_waitcnt lgkmcnt(2)
  buffer_load_dwordx4 v10, s[8:11], s27 offen offset:384 nt lds
  v_cvt_pk_bf16_f32 v127, v222, v223
  v_permlane32_swap_b32 v120, v122
  v_permlane32_swap_b32 v121, v123
  v_permlane16_swap_b32 v116, v118
  v_permlane16_swap_b32 v117, v119
  v_mfma_f32_16x16x32_bf16 v[160:163], v[24:27], v[112:115], v[160:163]
  s_waitcnt vmcnt(20)
  ds_read_b128 v[36:39], v5 offset:9472
  v_cvt_pk_bf16_f32 v128, v128, v129
  v_cvt_pk_bf16_f32 v129, v130, v131
  v_cvt_pk_bf16_f32 v130, v224, v225
  v_cvt_pk_bf16_f32 v131, v226, v227
  v_permlane32_swap_b32 v124, v126
  v_permlane32_swap_b32 v125, v127
  v_permlane16_swap_b32 v120, v122
  v_permlane16_swap_b32 v121, v123
  v_mfma_f32_16x16x32_bf16 v[164:167], v[24:27], v[116:119], v[164:167]
  s_barrier
  v_cvt_pk_bf16_f32 v132, v132, v133
  v_cvt_pk_bf16_f32 v133, v134, v135
  v_cvt_pk_bf16_f32 v134, v228, v229
  v_cvt_pk_bf16_f32 v135, v230, v231
  v_permlane32_swap_b32 v128, v130
  v_permlane32_swap_b32 v129, v131
  v_permlane16_swap_b32 v124, v126
  v_permlane16_swap_b32 v125, v127
  v_mfma_f32_16x16x32_bf16 v[168:171], v[24:27], v[120:123], v[168:171]
  s_waitcnt lgkmcnt(2)
  v_cvt_pk_bf16_f32 v136, v136, v137
  v_cvt_pk_bf16_f32 v137, v138, v139
  v_mfma_f32_16x16x32_bf16 v[172:175], v[28:31], v[112:115], v[172:175]
  ds_read_b128 v[24:27], v5 offset:1536
  v_cvt_pk_bf16_f32 v138, v232, v233
  v_mfma_f32_16x16x32_bf16 v[176:179], v[28:31], v[116:119], v[176:179]
  s_add_u32 m0, s31, s50
  v_cvt_pk_bf16_f32 v139, v234, v235
  v_permlane32_swap_b32 v132, v134
  v_mfma_f32_16x16x32_bf16 v[180:183], v[28:31], v[120:123], v[180:183]
  s_waitcnt lgkmcnt(2)
  buffer_load_dwordx4 v11, s[12:15], s28 offen offset:0 lds
  v_permlane32_swap_b32 v133, v135
  v_permlane16_swap_b32 v128, v130
  v_permlane16_swap_b32 v129, v131
  v_mfma_f32_16x16x32_bf16 v[160:163], v[32:35], v[124:127], v[160:163]
  s_add_u32 s32, s32, 16384
  ds_read_b128 v[28:31], v5 offset:9728
  v_cvt_pk_bf16_f32 v140, v140, v141
  v_cvt_pk_bf16_f32 v141, v142, v143
  v_cvt_pk_bf16_f32 v142, v236, v237
  v_cvt_pk_bf16_f32 v143, v238, v239
  v_permlane32_swap_b32 v136, v138
  v_permlane32_swap_b32 v137, v139
  v_permlane16_swap_b32 v132, v134
  v_permlane16_swap_b32 v133, v135
  v_mfma_f32_16x16x32_bf16 v[164:167], v[32:35], v[128:131], v[164:167]
  v_cvt_pk_bf16_f32 v144, v144, v145
  v_cvt_pk_bf16_f32 v145, v146, v147
  v_cvt_pk_bf16_f32 v146, v240, v241
  v_cvt_pk_bf16_f32 v147, v242, v243
  v_permlane32_swap_b32 v140, v142
  v_permlane32_swap_b32 v141, v143
  v_permlane16_swap_b32 v136, v138
  v_permlane16_swap_b32 v137, v139
  v_mfma_f32_16x16x32_bf16 v[168:171], v[32:35], v[132:135], v[168:171]
  s_waitcnt lgkmcnt(2)
  v_cvt_pk_bf16_f32 v148, v148, v149
  v_cvt_pk_bf16_f32 v149, v150, v151
  v_mfma_f32_16x16x32_bf16 v[172:175], v[36:39], v[124:127], v[172:175]
  s_cmp_eq_u32 s32, 114688
  s_cselect_b32 s32, 65536, s32
  ds_read_b128 v[32:35], v5 offset:1792
  v_mfma_f32_16x16x32_bf16 v[176:179], v[36:39], v[128:131], v[176:179]
  s_add_u32 m0, s31, s51
  v_cvt_pk_bf16_f32 v150, v244, v245
  v_cvt_pk_bf16_f32 v151, v246, v247
  v_mfma_f32_16x16x32_bf16 v[180:183], v[36:39], v[132:135], v[180:183]
  s_waitcnt lgkmcnt(2)
  buffer_load_dwordx4 v11, s[12:15], s98 offen offset:128 lds
  v_permlane32_swap_b32 v144, v146
  v_permlane32_swap_b32 v145, v147
  v_permlane16_swap_b32 v140, v142
  v_permlane16_swap_b32 v141, v143
  v_mfma_f32_16x16x32_bf16 v[160:163], v[24:27], v[136:139], v[160:163]
  ds_read_b128 v[36:39], v5 offset:9984
  v_cvt_pk_bf16_f32 v152, v152, v153
  v_cvt_pk_bf16_f32 v153, v154, v155
  v_cvt_pk_bf16_f32 v154, v248, v249
  v_cvt_pk_bf16_f32 v155, v250, v251
  v_permlane32_swap_b32 v148, v150
  v_permlane32_swap_b32 v149, v151
  v_permlane16_swap_b32 v144, v146
  v_permlane16_swap_b32 v145, v147
  v_mfma_f32_16x16x32_bf16 v[164:167], v[24:27], v[140:143], v[164:167]
  v_add_u32 v5, s32, v2
  v_cvt_pk_bf16_f32 v156, v156, v157
  v_cvt_pk_bf16_f32 v157, v158, v159
  v_cvt_pk_bf16_f32 v158, v252, v253
  v_cvt_pk_bf16_f32 v159, v254, v255
  v_permlane32_swap_b32 v152, v154
  v_permlane32_swap_b32 v153, v155
  v_permlane16_swap_b32 v148, v150
  v_permlane16_swap_b32 v149, v151
  v_mfma_f32_16x16x32_bf16 v[168:171], v[24:27], v[144:147], v[168:171]
  s_waitcnt lgkmcnt(2)
  v_permlane32_swap_b32 v156, v158
  v_permlane32_swap_b32 v157, v159
  v_mfma_f32_16x16x32_bf16 v[172:175], v[28:31], v[136:139], v[172:175]
  ds_read_b128 v[24:27], v5 offset:0
  v_permlane16_swap_b32 v152, v154
  v_mfma_f32_16x16x32_bf16 v[176:179], v[28:31], v[140:143], v[176:179]
  s_add_u32 m0, s31, s52
  v_permlane16_swap_b32 v153, v155
  v_permlane16_swap_b32 v156, v158
  v_mfma_f32_16x16x32_bf16 v[180:183], v[28:31], v[144:147], v[180:183]
  s_waitcnt lgkmcnt(2)
  buffer_load_dwordx4 v11, s[12:15], s99 offen offset:256 lds
  v_mfma_f32_16x16x32_bf16 v[160:163], v[32:35], v[148:151], v[160:163]
  ds_read_b128 v[28:31], v5 offset:256
  v_permlane16_swap_b32 v157, v159
  v_mfma_f32_16x16x32_bf16 v[164:167], v[32:35], v[152:155], v[164:167]
  s_nop 0
  v_mfma_f32_16x16x32_bf16 v[168:171], v[32:35], v[156:159], v[168:171]
  s_waitcnt lgkmcnt(2)
  v_mfma_f32_16x16x32_bf16 v[172:175], v[36:39], v[148:151], v[172:175]
  ds_read_b128 v[32:35], v5 offset:512
  v_mfma_f32_16x16x32_bf16 v[176:179], v[36:39], v[152:155], v[176:179]
  s_add_u32 m0, s31, s53
  v_mfma_f32_16x16x32_bf16 v[180:183], v[36:39], v[156:159], v[180:183]
  s_waitcnt lgkmcnt(2)
  buffer_load_dwordx4 v11, s[12:15], s100 offen offset:384 lds
L_k1_max:
  s_barrier
  s_mov_b32 s6, 524288
  s_mov_b32 s10, 524288
  s_add_u32 s26, s26, 16384
  s_add_u32 s29, s29, 16384
  s_cmp_eq_u32 s29, 114688
  s_cselect_b32 s29, 65536, s29
  s_add_u32 m0, s29, s46
  s_nop 0
  buffer_load_dwordx4 v8, s[4:7], s26 offen offset:0 nt lds
  s_add_u32 m0, s29, s47
  s_nop 0
  buffer_load_dwordx4 v8, s[4:7], s26 offen offset:256 nt lds
  s_lshl_b32 s38, s60, 1
  s_add_u32 s38, s38, s25
  s_cmp_eq_u32 s38, 1
  s_cbranch_scc0 L_k1_nomva
  v_accvgpr_mov_b32 a192, a0
  v_accvgpr_mov_b32 a193, a1
  v_accvgpr_mov_b32 a194, a2
  v_accvgpr_mov_b32 a195, a3
  v_accvgpr_mov_b32 a196, a4
  v_accvgpr_mov_b32 a197, a5
  v_accvgpr_mov_b32 a198, a6
  v_accvgpr_mov_b32 a199, a7
  v_accvgpr_mov_b32 a200, a8
  v_accvgpr_mov_b32 a201, a9
  v_accvgpr_mov_b32 a202, a10
  v_accvgpr_mov_b32 a203, a11
  v_accvgpr_mov_b32 a204, a24
  v_accvgpr_mov_b32 a205, a25
  v_accvgpr_mov_b32 a206, a26
  v_accvgpr_mov_b32 a207, a27
  v_accvgpr_mov_b32 a208, a28
  v_accvgpr_mov_b32 a209, a29
  v_accvgpr_mov_b32 a210, a30
  v_accvgpr_mov_b32 a211, a31
  v_accvgpr_mov_b32 a212, a32
  v_accvgpr_mov_b32 a213, a33
  v_accvgpr_mov_b32 a214, a34
  v_accvgpr_mov_b32 a215, a35
  v_accvgpr_mov_b32 a216, a48
  v_accvgpr_mov_b32 a217, a49
  v_accvgpr_mov_b32 a218, a50
  v_accvgpr_mov_b32 a219, a51
  v_accvgpr_mov_b32 a220, a52
  v_accvgpr_mov_b32 a221, a53
  v_accvgpr_mov_b32 a222, a54
  v_accvgpr_mov_b32 a223, a55
  v_accvgpr_mov_b32 a224, a56
  v_accvgpr_mov_b32 a225, a57
  v_accvgpr_mov_b32 a226, a58
  v_accvgpr_mov_b32 a227, a59
  v_accvgpr_mov_b32 a228, a72
  v_accvgpr_mov_b32 a229, a73
  v_accvgpr_mov_b32 a230, a74
  v_accvgpr_mov_b32 a231, a75
  v_accvgpr_mov_b32 a232, a76
  v_accvgpr_mov_b32 a233, a77
  v_accvgpr_mov_b32 a234, a78
  v_accvgpr_mov_b32 a235, a79
  v_accvgpr_mov_b32 a236, a80
  v_accvgpr_mov_b32 a237, a81
  v_accvgpr_mov_b32 a238, a82
  v_accvgpr_mov_b32 a239, a83
  v_accvgpr_read_b32 v232, a124
  v_accvgpr_read_b32 v233, a125
  v_accvgpr_read_b32 v234, a126
  v_accvgpr_read_b32 v235, a127
  v_accvgpr_read_b32 v236, a128
  v_accvgpr_read_b32 v237, a129
  v_accvgpr_read_b32 v238, a130
  v_accvgpr_read_b32 v239, a131
  v_accvgpr_read_b32 v240, a144
  v_accvgpr_read_b32 v241, a145
  v_accvgpr_read_b32 v242, a146
  v_accvgpr_read_b32 v243, a147
  v_accvgpr_read_b32 v244, a148
  v_accvgpr_read_b32 v245, a149
  v_accvgpr_read_b32 v246, a150
  v_accvgpr_read_b32 v247, a151
  v_accvgpr_read_b32 v248, a152
  v_accvgpr_read_b32 v249, a153
  v_accvgpr_read_b32 v250, a154
  v_accvgpr_read_b32 v251, a155
  v_accvgpr_read_b32 v252, a168
  v_accvgpr_read_b32 v253, a169
  v_accvgpr_read_b32 v254, a170
  v_accvgpr_read_b32 v255, a171
  v_accvgpr_read_b32 v56, a172
  v_accvgpr_read_b32 v57, a173
  v_accvgpr_read_b32 v58, a174
  v_accvgpr_read_b32 v59, a175
  v_accvgpr_read_b32 v60, a176
  v_accvgpr_read_b32 v61, a177
  v_accvgpr_read_b32 v62, a178
  v_accvgpr_read_b32 v63, a179
L_k1_nomva:
  v_max3_f32 v208, v160, v161, v162
  v_max3_f32 v209, v164, v165, v166
  v_max3_f32 v210, v168, v169, v170
  v_max3_f32 v208, v208, v163, v172
  v_max3_f32 v209, v209, v167, v176
  v_max3_f32 v210, v210, v171, v180
  v_max3_f32 v208, v208, v173, v174
  v_max3_f32 v209, v209, v177, v178
  v_max3_f32 v210, v210, v181, v182
  v_max_f32 v208, v208, v175
  v_max_f32 v209, v209, v179
  v_max_f32 v210, v210, v183
  v_mov_b32 v211, v208
  v_mov_b32 v212, v209
  v_mov_b32 v213, v210
  v_permlane32_swap_b32 v208, v211
  v_permlane32_swap_b32 v209, v212
  v_permlane32_swap_b32 v210, v213
  v_max_f32 v208, v208, v211
  v_max_f32 v209, v209, v212
  v_max_f32 v210, v210, v213
  v_mov_b32 v211, v208
  v_mov_b32 v212, v209
  v_mov_b32 v213, v210
  v_permlane16_swap_b32 v208, v211
  v_permlane16_swap_b32 v209, v212
  v_permlane16_swap_b32 v210, v213
  v_max_f32 v208, v208, v211
  v_max_f32 v209, v209, v212
  v_max_f32 v210, v210, v213
  v_sub_f32 v220, 0, v208
  v_sub_f32 v221, 0, v208
  v_sub_f32 v222, 0, v208
  v_sub_f32 v223, 0, v208
  v_sub_f32 v224, 0, v209
  v_sub_f32 v225, 0, v209
  v_sub_f32 v226, 0, v209
  v_sub_f32 v227, 0, v209
  v_sub_f32 v228, 0, v210
  v_sub_f32 v229, 0, v210
  v_sub_f32 v230, 0, v210
  v_sub_f32 v231, 0, v210
  v_mov_b32 v16, 0
  v_mov_b32 v17, 0
  v_mov_b32 v18, 0
  v_mul_f32 v211, s42, v208
  v_mul_f32 v212, s42, v209
  v_mul_f32 v213, s42, v210
  v_fma_f32 v160, v160, s42, -v211
  v_fma_f32 v161, v161, s42, -v211
  v_fma_f32 v162, v162, s42, -v211
  v_fma_f32 v163, v163, s42, -v211
  v_fma_f32 v172, v172, s42, -v211
  v_fma_f32 v173, v173, s42, -v211
  v_fma_f32 v174, v174, s42, -v211
  v_fma_f32 v175, v175, s42, -v211
  v_fma_f32 v164, v164, s42, -v212
  v_fma_f32 v165, v165, s42, -v212
  v_fma_f32 v166, v166, s42, -v212
  v_fma_f32 v167, v167, s42, -v212
  v_fma_f32 v176, v176, s42, -v212
  v_fma_f32 v177, v177, s42, -v212
  v_fma_f32 v178, v178, s42, -v212
  v_fma_f32 v179, v179, s42, -v212
  v_fma_f32 v168, v168, s42, -v213
  v_fma_f32 v169, v169, s42, -v213
  v_fma_f32 v170, v170, s42, -v213
  v_fma_f32 v171, v171, s42, -v213
  v_fma_f32 v180, v180, s42, -v213
  v_fma_f32 v181, v181, s42, -v213
  v_fma_f32 v182, v182, s42, -v213
  v_fma_f32 v183, v183, s42, -v213
  v_mfma_f32_16x16x32_bf16 v[184:187], v[24:27], v[64:67], v[220:223]
  ds_read_b128 v[36:39], v5 offset:768
  v_mfma_f32_16x16x32_bf16 v[188:191], v[24:27], v[68:71], v[224:227]
  v_exp_f32 v160, v160
  v_mfma_f32_16x16x32_bf16 v[192:195], v[24:27], v[72:75], v[228:231]
  s_waitcnt lgkmcnt(2)
  v_exp_f32 v161, v161
  v_mfma_f32_16x16x32_bf16 v[184:187], v[28:31], v[76:79], v[184:187]
  ds_read_b128 v[24:27], v5 offset:1024
  v_cvt_pk_bf16_f32 v208, v160, v161
  v_mfma_f32_16x16x32_bf16 v[188:191], v[28:31], v[80:83], v[188:191]
  s_add_u32 m0, s29, s48
  v_exp_f32 v162, v162
  v_mfma_f32_16x16x32_bf16 v[192:195], v[28:31], v[84:87], v[192:195]
  s_waitcnt lgkmcnt(2)
  buffer_load_dwordx4 v9, s[4:7], s26 offen offset:0 nt lds
  v_mfma_f32_16x16x32_bf16 v[184:187], v[32:35], v[88:91], v[184:187]
  ds_read_b128 v[28:31], v5 offset:1280
  v_add_f32 v16, v16, v160
  v_mfma_f32_16x16x32_bf16 v[188:191], v[32:35], v[92:95], v[188:191]
  v_exp_f32 v163, v163
  v_mfma_f32_16x16x32_bf16 v[192:195], v[32:35], v[96:99], v[192:195]
  s_waitcnt lgkmcnt(2)
  v_exp_f32 v172, v172
  v_mfma_f32_16x16x32_bf16 v[184:187], v[36:39], v[100:103], v[184:187]
  ds_read_b128 v[32:35], v5 offset:1536
  v_cvt_pk_bf16_f32 v209, v162, v163
  v_mfma_f32_16x16x32_bf16 v[188:191], v[36:39], v[104:107], v[188:191]
  v_exp_f32 v173, v173
  v_mfma_f32_16x16x32_bf16 v[192:195], v[36:39], v[108:111], v[192:195]
  s_waitcnt lgkmcnt(2)
  v_exp_f32 v174, v174
  v_mfma_f32_16x16x32_bf16 v[184:187], v[24:27], v[112:115], v[184:187]
  ds_read_b128 v[36:39], v5 offset:1792
  v_cvt_pk_bf16_f32 v210, v172, v173
  v_mfma_f32_16x16x32_bf16 v[188:191], v[24:27], v[116:119], v[188:191]
  v_exp_f32 v175, v175
  v_mfma_f32_16x16x32_bf16 v[192:195], v[24:27], v[120:123], v[192:195]
  s_waitcnt lgkmcnt(2)
  v_exp_f32 v164, v164
  v_mfma_f32_16x16x32_bf16 v[184:187], v[28:31], v[124:127], v[184:187]
  ds_read_b128 v[24:27], v5 offset:8192
  v_cvt_pk_bf16_f32 v211, v174, v175
  v_mfma_f32_16x16x32_bf16 v[188:191], v[28:31], v[128:131], v[188:191]
  s_add_u32 m0, s29, s49
  v_exp_f32 v165, v165
  v_mfma_f32_16x16x32_bf16 v[192:195], v[28:31], v[132:135], v[192:195]
  s_waitcnt lgkmcnt(2)
  buffer_load_dwordx4 v9, s[4:7], s26 offen offset:256 nt lds
  v_mfma_f32_16x16x32_bf16 v[184:187], v[32:35], v[136:139], v[184:187]
  s_add_u32 s27, s27, 16384
  ds_read_b128 v[28:31], v5 offset:8448
  v_cvt_pk_bf16_f32 v212, v164, v165
  v_mfma_f32_16x16x32_bf16 v[188:191], v[32:35], v[140:143], v[188:191]
  s_add_u32 s30, s30, 16384
  v_exp_f32 v166, v166
  v_mfma_f32_16x16x32_bf16 v[192:195], v[32:35], v[144:147], v[192:195]
  s_waitcnt lgkmcnt(2)
  v_exp_f32 v167, v167
  v_mfma_f32_16x16x32_bf16 v[184:187], v[36:39], v[148:151], v[184:187]
  s_cmp_eq_u32 s30, 163840
  s_cselect_b32 s30, 114688, s30
  ds_read_b128 v[32:35], v5 offset:8704
  v_mfma_f32_16x16x32_bf16 v[188:191], v[36:39], v[152:155], v[188:191]
  v_exp_f32 v176, v176
  v_mfma_f32_16x16x32_bf16 v[192:195], v[36:39], v[156:159], v[192:195]
  s_waitcnt lgkmcnt(2)
  v_exp_f32 v177, v177
  v_mfma_f32_16x16x32_bf16 v[196:199], v[24:27], v[64:67], v[220:223]
  s_waitcnt vmcnt(21)
  ds_read_b128 v[36:39], v5 offset:8960
  v_cvt_pk_bf16_f32 v213, v166, v167
  v_mfma_f32_16x16x32_bf16 v[200:203], v[24:27], v[68:71], v[224:227]
  s_barrier
  v_exp_f32 v178, v178
  v_mfma_f32_16x16x32_bf16 v[204:207], v[24:27], v[72:75], v[228:231]
  s_waitcnt lgkmcnt(2)
  v_exp_f32 v179, v179
  v_mfma_f32_16x16x32_bf16 v[196:199], v[28:31], v[76:79], v[196:199]
  s_add_u32 s33, s33, 16384
  ds_read_b128 v[24:27], v5 offset:9216
  v_cvt_pk_bf16_f32 v214, v176, v177
  v_mfma_f32_16x16x32_bf16 v[200:203], v[28:31], v[80:83], v[200:203]
  s_add_u32 m0, s30, s50
  v_exp_f32 v168, v168
  v_mfma_f32_16x16x32_bf16 v[204:207], v[28:31], v[84:87], v[204:207]
  s_waitcnt lgkmcnt(2)
  buffer_load_dwordx4 v10, s[8:11], s27 offen offset:0 nt lds
  v_mfma_f32_16x16x32_bf16 v[196:199], v[32:35], v[88:91], v[196:199]
  s_cmp_eq_u32 s33, 163840
  s_cselect_b32 s33, 114688, s33
  ds_read_b128 v[28:31], v5 offset:9472
  v_mfma_f32_16x16x32_bf16 v[200:203], v[32:35], v[92:95], v[200:203]
  v_exp_f32 v169, v169
  v_mfma_f32_16x16x32_bf16 v[204:207], v[32:35], v[96:99], v[204:207]
  s_waitcnt lgkmcnt(2)
  v_exp_f32 v170, v170
  v_mfma_f32_16x16x32_bf16 v[196:199], v[36:39], v[100:103], v[196:199]
  ds_read_b128 v[32:35], v5 offset:9728
  v_add_u32 v6, s33, v3
  v_mfma_f32_16x16x32_bf16 v[200:203], v[36:39], v[104:107], v[200:203]
  v_exp_f32 v171, v171
  v_mfma_f32_16x16x32_bf16 v[204:207], v[36:39], v[108:111], v[204:207]
  s_waitcnt lgkmcnt(2)
  v_exp_f32 v180, v180
  v_mfma_f32_16x16x32_bf16 v[196:199], v[24:27], v[112:115], v[196:199]
  ds_read_b128 v[36:39], v5 offset:9984
  v_add_u32 v7, s33, v4
  v_mfma_f32_16x16x32_bf16 v[200:203], v[24:27], v[116:119], v[200:203]
  v_exp_f32 v181, v181
  v_mfma_f32_16x16x32_bf16 v[204:207], v[24:27], v[120:123], v[204:207]
  s_waitcnt lgkmcnt(2)
  v_exp_f32 v182, v182
  v_mfma_f32_16x16x32_bf16 v[196:199], v[28:31], v[124:127], v[196:199]
  ds_read_b64_tr_b16 v[40:41], v6 offset:0
  v_cvt_pk_bf16_f32 v215, v178, v179
  v_mfma_f32_16x16x32_bf16 v[200:203], v[28:31], v[128:131], v[200:203]
  s_add_u32 m0, s30, s51
  ds_read_b64_tr_b16 v[42:43], v6 offset:8192
  v_cvt_pk_bf16_f32 v216, v168, v169
  v_mfma_f32_16x16x32_bf16 v[204:207], v[28:31], v[132:135], v[204:207]
  s_waitcnt lgkmcnt(3)
  buffer_load_dwordx4 v10, s[8:11], s27 offen offset:128 nt lds
  v_mfma_f32_16x16x32_bf16 v[196:199], v[32:35], v[136:139], v[196:199]
  ds_read_b64_tr_b16 v[44:45], v7 offset:0
  v_cvt_pk_bf16_f32 v217, v170, v171
  v_mfma_f32_16x16x32_bf16 v[200:203], v[32:35], v[140:143], v[200:203]
  ds_read_b64_tr_b16 v[46:47], v7 offset:8192
  v_cvt_pk_bf16_f32 v218, v180, v181
  v_mfma_f32_16x16x32_bf16 v[204:207], v[32:35], v[144:147], v[204:207]
  s_waitcnt lgkmcnt(4)
  v_exp_f32 v183, v183
  v_mfma_f32_16x16x32_bf16 v[196:199], v[36:39], v[148:151], v[196:199]
  ds_read_b64_tr_b16 v[48:49], v6 offset:512
  v_cvt_pk_bf16_f32 v219, v182, v183
  v_mfma_f32_16x16x32_bf16 v[200:203], v[36:39], v[152:155], v[200:203]
  ds_read_b64_tr_b16 v[50:51], v6 offset:8704
  v_add_f32 v16, v16, v161
  v_mfma_f32_16x16x32_bf16 v[204:207], v[36:39], v[156:159], v[204:207]
  s_waitcnt lgkmcnt(4)
  v_add_f32 v16, v16, v162
  v_add_f32 v16, v16, v163
  v_mfma_f32_16x16x32_bf16 a[0:3], v[40:43], v[208:211], 0
  ds_read_b64_tr_b16 v[52:53], v7 offset:512
  v_mul_f32 v184, s42, v184
  v_mfma_f32_16x16x32_bf16 a[4:7], v[40:43], v[212:215], 0
  ds_read_b64_tr_b16 v[54:55], v7 offset:8704
  v_mul_f32 v185, s42, v185
  v_mfma_f32_16x16x32_bf16 a[8:11], v[40:43], v[216:219], 0
  s_waitcnt lgkmcnt(4)
  v_mul_f32 v186, s42, v186
  v_mul_f32 v187, s42, v187
  v_mfma_f32_16x16x32_bf16 a[12:15], v[44:47], v[208:211], 0
  ds_read_b64_tr_b16 v[40:41], v6 offset:1024
  v_mul_f32 v188, s42, v188
  v_mfma_f32_16x16x32_bf16 a[16:19], v[44:47], v[212:215], 0
  s_add_u32 m0, s30, s52
  ds_read_b64_tr_b16 v[42:43], v6 offset:9216
  v_mul_f32 v189, s42, v189
  v_mfma_f32_16x16x32_bf16 a[20:23], v[44:47], v[216:219], 0
  s_waitcnt lgkmcnt(4)
  buffer_load_dwordx4 v10, s[8:11], s27 offen offset:256 nt lds
  v_mfma_f32_16x16x32_bf16 a[24:27], v[48:51], v[208:211], 0
  ds_read_b64_tr_b16 v[44:45], v7 offset:1024
  v_mul_f32 v190, s42, v190
  v_mfma_f32_16x16x32_bf16 a[28:31], v[48:51], v[212:215], 0
  ds_read_b64_tr_b16 v[46:47], v7 offset:9216
  v_mul_f32 v191, s42, v191
  v_mfma_f32_16x16x32_bf16 a[32:35], v[48:51], v[216:219], 0
  s_waitcnt lgkmcnt(4)
  v_mul_f32 v192, s42, v192
  v_mul_f32 v193, s42, v193
  v_mfma_f32_16x16x32_bf16 a[36:39], v[52:55], v[208:211], 0
  ds_read_b64_tr_b16 v[48:49], v6 offset:1536
  v_mul_f32 v194, s42, v194
  v_mfma_f32_16x16x32_bf16 a[40:43], v[52:55], v[212:215], 0
  ds_read_b64_tr_b16 v[50:51], v6 offset:9728
  v_mul_f32 v195, s42, v195
  v_mfma_f32_16x16x32_bf16 a[44:47], v[52:55], v[216:219], 0
  s_waitcnt lgkmcnt(4)
  v_mul_f32 v196, s42, v196
  v_mul_f32 v197, s42, v197
  v_mfma_f32_16x16x32_bf16 a[48:51], v[40:43], v[208:211], 0
  ds_read_b64_tr_b16 v[52:53], v7 offset:1536
  v_mul_f32 v198, s42, v198
  v_mfma_f32_16x16x32_bf16 a[52:55], v[40:43], v[212:215], 0
  ds_read_b64_tr_b16 v[54:55], v7 offset:9728
  v_mul_f32 v199, s42, v199
  v_mfma_f32_16x16x32_bf16 a[56:59], v[40:43], v[216:219], 0
  s_waitcnt lgkmcnt(4)
  v_mul_f32 v200, s42, v200
  v_mul_f32 v201, s42, v201
  v_mfma_f32_16x16x32_bf16 a[60:63], v[44:47], v[208:211], 0
  ds_read_b64_tr_b16 v[40:41], v6 offset:2048
  v_mul_f32 v202, s42, v202
  v_mfma_f32_16x16x32_bf16 a[64:67], v[44:47], v[212:215], 0
  s_add_u32 m0, s30, s53
  ds_read_b64_tr_b16 v[42:43], v6 offset:10240
  v_mul_f32 v203, s42, v203
  v_mfma_f32_16x16x32_bf16 a[68:71], v[44:47], v[216:219], 0
  s_waitcnt lgkmcnt(4)
  buffer_load_dwordx4 v10, s[8:11], s27 offen offset:384 nt lds
  v_mfma_f32_16x16x32_bf16 a[72:75], v[48:51], v[208:211], 0
  s_add_u32 s26, s26, 16384
  ds_read_b64_tr_b16 v[44:45], v7 offset:2048
  v_mul_f32 v204, s42, v204
  v_mfma_f32_16x16x32_bf16 a[76:79], v[48:51], v[212:215], 0
  s_add_u32 s29, s29, 16384
  ds_read_b64_tr_b16 v[46:47], v7 offset:10240
  v_mul_f32 v205, s42, v205
  v_mfma_f32_16x16x32_bf16 a[80:83], v[48:51], v[216:219], 0
  s_waitcnt lgkmcnt(4)
  v_mul_f32 v206, s42, v206
  v_mul_f32 v207, s42, v207
  v_mfma_f32_16x16x32_bf16 a[84:87], v[52:55], v[208:211], 0
  s_cmp_eq_u32 s29, 114688
  s_cselect_b32 s29, 65536, s29
  ds_read_b64_tr_b16 v[48:49], v6 offset:2560
  v_mfma_f32_16x16x32_bf16 a[88:91], v[52:55], v[212:215], 0
  ds_read_b64_tr_b16 v[50:51], v6 offset:10752
  v_max3_f32 v14, v184, v185, v186
  v_mfma_f32_16x16x32_bf16 a[92:95], v[52:55], v[216:219], 0
  s_waitcnt lgkmcnt(4)
  v_max3_f32 v14, v14, v187, v188
  v_max3_f32 v14, v14, v189, v190
  v_mfma_f32_16x16x32_bf16 a[96:99], v[40:43], v[208:211], 0
  s_waitcnt vmcnt(20)
  ds_read_b64_tr_b16 v[52:53], v7 offset:2560
  v_max3_f32 v14, v14, v191, v192
  v_mfma_f32_16x16x32_bf16 a[100:103], v[40:43], v[212:215], 0
  s_barrier
  ds_read_b64_tr_b16 v[54:55], v7 offset:10752
  v_max3_f32 v14, v14, v193, v194
  v_mfma_f32_16x16x32_bf16 a[104:107], v[40:43], v[216:219], 0
  s_waitcnt lgkmcnt(4)
  v_max3_f32 v14, v14, v195, v196
  v_max3_f32 v14, v14, v197, v198
  v_mfma_f32_16x16x32_bf16 a[108:111], v[44:47], v[208:211], 0
  ds_read_b64_tr_b16 v[40:41], v6 offset:3072
  v_max3_f32 v14, v14, v199, v200
  v_mfma_f32_16x16x32_bf16 a[112:115], v[44:47], v[212:215], 0
  s_add_u32 m0, s29, s46
  ds_read_b64_tr_b16 v[42:43], v6 offset:11264
  v_max3_f32 v14, v14, v201, v202
  v_mfma_f32_16x16x32_bf16 a[116:119], v[44:47], v[216:219], 0
  s_waitcnt lgkmcnt(4)
  buffer_load_dwordx4 v8, s[4:7], s26 offen offset:0 nt lds
  v_mfma_f32_16x16x32_bf16 a[120:123], v[48:51], v[208:211], 0
  s_add_u32 s32, s32, 16384
  ds_read_b64_tr_b16 v[44:45], v7 offset:3072
  v_max3_f32 v14, v14, v203, v204
  v_mfma_f32_16x16x32_bf16 a[124:127], v[48:51], v[212:215], 0
  ds_read_b64_tr_b16 v[46:47], v7 offset:11264
  v_max3_f32 v14, v14, v205, v206
  v_mfma_f32_16x16x32_bf16 a[128:131], v[48:51], v[216:219], 0
  s_waitcnt lgkmcnt(4)
  v_max_f32 v14, v14, v207
  v_cmp_lt_f32 vcc, s44, v14
  v_mfma_f32_16x16x32_bf16 a[132:135], v[52:55], v[208:211], 0
  s_cmp_eq_u32 s32, 114688
  s_cselect_b32 s32, 65536, s32
  ds_read_b64_tr_b16 v[48:49], v6 offset:3584
  v_mfma_f32_16x16x32_bf16 a[136:139], v[52:55], v[212:215], 0
  ds_read_b64_tr_b16 v[50:51], v6 offset:11776
  v_add_f32 v16, v16, v172
  v_mfma_f32_16x16x32_bf16 a[140:143], v[52:55], v[216:219], 0
  s_waitcnt lgkmcnt(4)
  v_add_f32 v16, v16, v173
  v_add_f32 v16, v16, v174
  v_mfma_f32_16x16x32_bf16 a[144:147], v[40:43], v[208:211], 0
  ds_read_b64_tr_b16 v[52:53], v7 offset:3584
  v_add_f32 v16, v16, v175
  v_mfma_f32_16x16x32_bf16 a[148:151], v[40:43], v[212:215], 0
  ds_read_b64_tr_b16 v[54:55], v7 offset:11776
  v_add_u32 v5, s32, v2
  v_mfma_f32_16x16x32_bf16 a[152:155], v[40:43], v[216:219], 0
  s_waitcnt lgkmcnt(4)
  v_add_f32 v17, v17, v164
  v_add_f32 v17, v17, v165
  v_mfma_f32_16x16x32_bf16 a[156:159], v[44:47], v[208:211], 0
  ds_read_b128 v[24:27], v5 offset:0
  v_add_f32 v17, v17, v166
  v_mfma_f32_16x16x32_bf16 a[160:163], v[44:47], v[212:215], 0
  s_add_u32 m0, s29, s47
  v_add_f32 v17, v17, v167
  v_add_f32 v17, v17, v176
  v_mfma_f32_16x16x32_bf16 a[164:167], v[44:47], v[216:219], 0
  s_waitcnt lgkmcnt(3)
  buffer_load_dwordx4 v8, s[4:7], s26 offen offset:256 nt lds
  v_mfma_f32_16x16x32_bf16 a[168:171], v[48:51], v[208:211], 0
  ds_read_b128 v[28:31], v5 offset:256
  v_add_f32 v17, v17, v177
  v_mfma_f32_16x16x32_bf16 a[172:175], v[48:51], v[212:215], 0
  v_add_f32 v17, v17, v178
  v_add_f32 v17, v17, v179
  v_mfma_f32_16x16x32_bf16 a[176:179], v[48:51], v[216:219], 0
  s_waitcnt lgkmcnt(2)
  v_add_f32 v18, v18, v168
  v_add_f32 v18, v18, v169
  v_mfma_f32_16x16x32_bf16 a[180:183], v[52:55], v[208:211], 0
  ds_read_b128 v[32:35], v5 offset:512
  v_add_f32 v18, v18, v170
  v_mfma_f32_16x16x32_bf16 a[184:187], v[52:55], v[212:215], 0
  v_add_f32 v18, v18, v171
  v_add_f32 v18, v18, v180
  v_mfma_f32_16x16x32_bf16 a[188:191], v[52:55], v[216:219], 0
  s_waitcnt lgkmcnt(2)
  v_add_f32 v18, v18, v181
  v_add_f32 v18, v18, v182
  v_add_f32 v18, v18, v183
  s_cbranch_vccnz L_k1_rareF
L_k1_retF:
  s_mov_b32 s37, 7
L_k1_loop:
  v_mfma_f32_16x16x32_bf16 v[160:163], v[24:27], v[64:67], v[220:223]
  ds_read_b128 v[36:39], v5 offset:768
  v_mfma_f32_16x16x32_bf16 v[164:167], v[24:27], v[68:71], v[224:227]
  v_exp_f32 v184, v184
  v_mfma_f32_16x16x32_bf16 v[168:171], v[24:27], v[72:75], v[228:231]
  s_waitcnt lgkmcnt(2)
  v_exp_f32 v185, v185
  v_mfma_f32_16x16x32_bf16 v[160:163], v[28:31], v[76:79], v[160:163]
  ds_read_b128 v[24:27], v5 offset:1024
  v_cvt_pk_bf16_f32 v208, v184, v185
  v_mfma_f32_16x16x32_bf16 v[164:167], v[28:31], v[80:83], v[164:167]
  s_add_u32 m0, s29, s48
  v_exp_f32 v186, v186
  v_mfma_f32_16x16x32_bf16 v[168:171], v[28:31], v[84:87], v[168:171]
  s_waitcnt lgkmcnt(2)
  buffer_load_dwordx4 v9, s[4:7], s26 offen offset:0 nt lds
  v_mfma_f32_16x16x32_bf16 v[160:163], v[32:35], v[88:91], v[160:163]
  ds_read_b128 v[28:31], v5 offset:1280
  v_add_f32 v16, v16, v184
  v_mfma_f32_16x16x32_bf16 v[164:167], v[32:35], v[92:95], v[164:167]
  v_exp_f32 v187, v187
  v_mfma_f32_16x16x32_bf16 v[168:171], v[32:35], v[96:99], v[168:171]
  s_waitcnt lgkmcnt(2)
  v_exp_f32 v196, v196
  v_mfma_f32_16x16x32_bf16 v[160:163], v[36:39], v[100:103], v[160:163]
  ds_read_b128 v[32:35], v5 offset:1536
  v_cvt_pk_bf16_f32 v209, v186, v187
  v_mfma_f32_16x16x32_bf16 v[164:167], v[36:39], v[104:107], v[164:167]
  v_exp_f32 v197, v197
  v_mfma_f32_16x16x32_bf16 v[168:171], v[36:39], v[108:111], v[168:171]
  s_waitcnt lgkmcnt(2)
  v_exp_f32 v198, v198
  v_mfma_f32_16x16x32_bf16 v[160:163], v[24:27], v[112:115], v[160:163]
  ds_read_b128 v[36:39], v5 offset:1792
  v_cvt_pk_bf16_f32 v210, v196, v197
  v_mfma_f32_16x16x32_bf16 v[164:167], v[24:27], v[116:119], v[164:167]
  v_exp_f32 v199, v199
  v_mfma_f32_16x16x32_bf16 v[168:171], v[24:27], v[120:123], v[168:171]
  s_waitcnt lgkmcnt(2)
  v_exp_f32 v188, v188
  v_mfma_f32_16x16x32_bf16 v[160:163], v[28:31], v[124:127], v[160:163]
  ds_read_b128 v[24:27], v5 offset:8192
  v_cvt_pk_bf16_f32 v211, v198, v199
  v_mfma_f32_16x16x32_bf16 v[164:167], v[28:31], v[128:131], v[164:167]
  s_add_u32 m0, s29, s49
  v_exp_f32 v189, v189
  v_mfma_f32_16x16x32_bf16 v[168:171], v[28:31], v[132:135], v[168:171]
  s_waitcnt lgkmcnt(2)
  buffer_load_dwordx4 v9, s[4:7], s26 offen offset:256 nt lds
  v_mfma_f32_16x16x32_bf16 v[160:163], v[32:35], v[136:139], v[160:163]
  s_add_u32 s27, s27, 16384
  ds_read_b128 v[28:31], v5 offset:8448
  v_cvt_pk_bf16_f32 v212, v188, v189
  v_mfma_f32_16x16x32_bf16 v[164:167], v[32:35], v[140:143], v[164:167]
  s_add_u32 s30, s30, 16384
  v_exp_f32 v190, v190
  v_mfma_f32_16x16x32_bf16 v[168:171], v[32:35], v[144:147], v[168:171]
  s_waitcnt lgkmcnt(2)
  v_exp_f32 v191, v191
  v_mfma_f32_16x16x32_bf16 v[160:163], v[36:39], v[148:151], v[160:163]
  s_cmp_eq_u32 s30, 163840
  s_cselect_b32 s30, 114688, s30
  ds_read_b128 v[32:35], v5 offset:8704
  v_mfma_f32_16x16x32_bf16 v[164:167], v[36:39], v[152:155], v[164:167]
  v_exp_f32 v200, v200
  v_mfma_f32_16x16x32_bf16 v[168:171], v[36:39], v[156:159], v[168:171]
  s_waitcnt lgkmcnt(2)
  v_exp_f32 v201, v201
  v_mfma_f32_16x16x32_bf16 v[172:175], v[24:27], v[64:67], v[220:223]
  s_waitcnt vmcnt(12)
  ds_read_b128 v[36:39], v5 offset:8960
  v_cvt_pk_bf16_f32 v213, v190, v191
  v_mfma_f32_16x16x32_bf16 v[176:179], v[24:27], v[68:71], v[224:227]
  s_barrier
  v_exp_f32 v202, v202
  v_mfma_f32_16x16x32_bf16 v[180:183], v[24:27], v[72:75], v[228:231]
  s_waitcnt lgkmcnt(2)
  v_exp_f32 v203, v203
  v_mfma_f32_16x16x32_bf16 v[172:175], v[28:31], v[76:79], v[172:175]
  s_add_u32 s33, s33, 16384
  ds_read_b128 v[24:27], v5 offset:9216
  v_cvt_pk_bf16_f32 v214, v200, v201
  v_mfma_f32_16x16x32_bf16 v[176:179], v[28:31], v[80:83], v[176:179]
  s_add_u32 m0, s30, s50
  v_exp_f32 v192, v192
  v_mfma_f32_16x16x32_bf16 v[180:183], v[28:31], v[84:87], v[180:183]
  s_waitcnt lgkmcnt(2)
  buffer_load_dwordx4 v10, s[8:11], s27 offen offset:0 nt lds
  v_mfma_f32_16x16x32_bf16 v[172:175], v[32:35], v[88:91], v[172:175]
  s_cmp_eq_u32 s33, 163840
  s_cselect_b32 s33, 114688, s33
  ds_read_b128 v[28:31], v5 offset:9472
  v_mfma_f32_16x16x32_bf16 v[176:179], v[32:35], v[92:95], v[176:179]
  v_exp_f32 v193, v193
  v_mfma_f32_16x16x32_bf16 v[180:183], v[32:35], v[96:99], v[180:183]
  s_waitcnt lgkmcnt(2)
  v_exp_f32 v194, v194
  v_mfma_f32_16x16x32_bf16 v[172:175], v[36:39], v[100:103], v[172:175]
  ds_read_b128 v[32:35], v5 offset:9728
  v_add_u32 v6, s33, v3
  v_mfma_f32_16x16x32_bf16 v[176:179], v[36:39], v[104:107], v[176:179]
  v_exp_f32 v195, v195
  v_mfma_f32_16x16x32_bf16 v[180:183], v[36:39], v[108:111], v[180:183]
  s_waitcnt lgkmcnt(2)
  v_exp_f32 v204, v204
  v_mfma_f32_16x16x32_bf16 v[172:175], v[24:27], v[112:115], v[172:175]
  ds_read_b128 v[36:39], v5 offset:9984
  v_add_u32 v7, s33, v4
  v_mfma_f32_16x16x32_bf16 v[176:179], v[24:27], v[116:119], v[176:179]
  v_exp_f32 v205, v205
  v_mfma_f32_16x16x32_bf16 v[180:183], v[24:27], v[120:123], v[180:183]
  s_waitcnt lgkmcnt(2)
  v_exp_f32 v206, v206
  v_mfma_f32_16x16x32_bf16 v[172:175], v[28:31], v[124:127], v[172:175]
  ds_read_b64_tr_b16 v[40:41], v6 offset:0
  v_cvt_pk_bf16_f32 v215, v202, v203
  v_mfma_f32_16x16x32_bf16 v[176:179], v[28:31], v[128:131], v[176:179]
  s_add_u32 m0, s30, s51
  ds_read_b64_tr_b16 v[42:43], v6 offset:8192
  v_cvt_pk_bf16_f32 v216, v192, v193
  v_mfma_f32_16x16x32_bf16 v[180:183], v[28:31], v[132:135], v[180:183]
  s_waitcnt lgkmcnt(3)
  buffer_load_dwordx4 v10, s[8:11], s27 offen offset:128 nt lds
  v_mfma_f32_16x16x32_bf16 v[172:175], v[32:35], v[136:139], v[172:175]
  ds_read_b64_tr_b16 v[44:45], v7 offset:0
  v_cvt_pk_bf16_f32 v217, v194, v195
  v_mfma_f32_16x16x32_bf16 v[176:179], v[32:35], v[140:143], v[176:179]
  ds_read_b64_tr_b16 v[46:47], v7 offset:8192
  v_cvt_pk_bf16_f32 v218, v204, v205
  v_mfma_f32_16x16x32_bf16 v[180:183], v[32:35], v[144:147], v[180:183]
  s_waitcnt lgkmcnt(4)
  v_exp_f32 v207, v207
  v_mfma_f32_16x16x32_bf16 v[172:175], v[36:39], v[148:151], v[172:175]
  ds_read_b64_tr_b16 v[48:49], v6 offset:512
  v_cvt_pk_bf16_f32 v219, v206, v207
  v_mfma_f32_16x16x32_bf16 v[176:179], v[36:39], v[152:155], v[176:179]
  ds_read_b64_tr_b16 v[50:51], v6 offset:8704
  v_add_f32 v16, v16, v185
  v_mfma_f32_16x16x32_bf16 v[180:183], v[36:39], v[156:159], v[180:183]
  s_waitcnt lgkmcnt(4)
  v_add_f32 v16, v16, v186
  v_add_f32 v16, v16, v187
  v_mfma_f32_16x16x32_bf16 a[0:3], v[40:43], v[208:211], a[0:3]
  ds_read_b64_tr_b16 v[52:53], v7 offset:512
  v_mul_f32 v160, s42, v160
  v_mfma_f32_16x16x32_bf16 a[4:7], v[40:43], v[212:215], a[4:7]
  ds_read_b64_tr_b16 v[54:55], v7 offset:8704
  v_mul_f32 v161, s42, v161
  v_mfma_f32_16x16x32_bf16 a[8:11], v[40:43], v[216:219], a[8:11]
  s_waitcnt lgkmcnt(4)
  v_mul_f32 v162, s42, v162
  v_mul_f32 v163, s42, v163
  v_mfma_f32_16x16x32_bf16 a[12:15], v[44:47], v[208:211], a[12:15]
  ds_read_b64_tr_b16 v[40:41], v6 offset:1024
  v_mul_f32 v164, s42, v164
  v_mfma_f32_16x16x32_bf16 a[16:19], v[44:47], v[212:215], a[16:19]
  s_add_u32 m0, s30, s52
  ds_read_b64_tr_b16 v[42:43], v6 offset:9216
  v_mul_f32 v165, s42, v165
  v_mfma_f32_16x16x32_bf16 a[20:23], v[44:47], v[216:219], a[20:23]
  s_waitcnt lgkmcnt(4)
  buffer_load_dwordx4 v10, s[8:11], s27 offen offset:256 nt lds
  v_mfma_f32_16x16x32_bf16 a[24:27], v[48:51], v[208:211], a[24:27]
  ds_read_b64_tr_b16 v[44:45], v7 offset:1024
  v_mul_f32 v166, s42, v166
  v_mfma_f32_16x16x32_bf16 a[28:31], v[48:51], v[212:215], a[28:31]
  ds_read_b64_tr_b16 v[46:47], v7 offset:9216
  v_mul_f32 v167, s42, v167
  v_mfma_f32_16x16x32_bf16 a[32:35], v[48:51], v[216:219], a[32:35]
  s_waitcnt lgkmcnt(4)
  v_mul_f32 v168, s42, v168
  v_mul_f32 v169, s42, v169
  v_mfma_f32_16x16x32_bf16 a[36:39], v[52:55], v[208:211], a[36:39]
  ds_read_b64_tr_b16 v[48:49], v6 offset:1536
  v_mul_f32 v170, s42, v170
  v_mfma_f32_16x16x32_bf16 a[40:43], v[52:55], v[212:215], a[40:43]
  ds_read_b64_tr_b16 v[50:51], v6 offset:9728
  v_mul_f32 v171, s42, v171
  v_mfma_f32_16x16x32_bf16 a[44:47], v[52:55], v[216:219], a[44:47]
  s_waitcnt lgkmcnt(4)
  v_mul_f32 v172, s42, v172
  v_mul_f32 v173, s42, v173
  v_mfma_f32_16x16x32_bf16 a[48:51], v[40:43], v[208:211], a[48:51]
  ds_read_b64_tr_b16 v[52:53], v7 offset:1536
  v_mul_f32 v174, s42, v174
  v_mfma_f32_16x16x32_bf16 a[52:55], v[40:43], v[212:215], a[52:55]
  ds_read_b64_tr_b16 v[54:55], v7 offset:9728
  v_mul_f32 v175, s42, v175
  v_mfma_f32_16x16x32_bf16 a[56:59], v[40:43], v[216:219], a[56:59]
  s_waitcnt lgkmcnt(4)
  v_mul_f32 v176, s42, v176
  v_mul_f32 v177, s42, v177
  v_mfma_f32_16x16x32_bf16 a[60:63], v[44:47], v[208:211], a[60:63]
  ds_read_b64_tr_b16 v[40:41], v6 offset:2048
  v_mul_f32 v178, s42, v178
  v_mfma_f32_16x16x32_bf16 a[64:67], v[44:47], v[212:215], a[64:67]
  s_add_u32 m0, s30, s53
  ds_read_b64_tr_b16 v[42:43], v6 offset:10240
  v_mul_f32 v179, s42, v179
  v_mfma_f32_16x16x32_bf16 a[68:71], v[44:47], v[216:219], a[68:71]
  s_waitcnt lgkmcnt(4)
  buffer_load_dwordx4 v10, s[8:11], s27 offen offset:384 nt lds
  v_mfma_f32_16x16x32_bf16 a[72:75], v[48:51], v[208:211], a[72:75]
  s_add_u32 s26, s26, 16384
  ds_read_b64_tr_b16 v[44:45], v7 offset:2048
  v_mul_f32 v180, s42, v180
  v_mfma_f32_16x16x32_bf16 a[76:79], v[48:51], v[212:215], a[76:79]
  s_add_u32 s29, s29, 16384
  ds_read_b64_tr_b16 v[46:47], v7 offset:10240
  v_mul_f32 v181, s42, v181
  v_mfma_f32_16x16x32_bf16 a[80:83], v[48:51], v[216:219], a[80:83]
  s_waitcnt lgkmcnt(4)
  v_mul_f32 v182, s42, v182
  v_mul_f32 v183, s42, v183
  v_mfma_f32_16x16x32_bf16 a[84:87], v[52:55], v[208:211], a[84:87]
  s_cmp_eq_u32 s29, 114688
  s_cselect_b32 s29, 65536, s29
  ds_read_b64_tr_b16 v[48:49], v6 offset:2560
  v_mfma_f32_16x16x32_bf16 a[88:91], v[52:55], v[212:215], a[88:91]
  ds_read_b64_tr_b16 v[50:51], v6 offset:10752
  v_max3_f32 v14, v160, v161, v162
  v_mfma_f32_16x16x32_bf16 a[92:95], v[52:55], v[216:219], a[92:95]
  s_waitcnt lgkmcnt(4)
  v_max3_f32 v14, v14, v163, v164
  v_max3_f32 v14, v14, v165, v166
  v_mfma_f32_16x16x32_bf16 a[96:99], v[40:43], v[208:211], a[96:99]
  s_waitcnt vmcnt(12)
  ds_read_b64_tr_b16 v[52:53], v7 offset:2560
  v_max3_f32 v14, v14, v167, v168
  v_mfma_f32_16x16x32_bf16 a[100:103], v[40:43], v[212:215], a[100:103]
  s_barrier
  ds_read_b64_tr_b16 v[54:55], v7 offset:10752
  v_max3_f32 v14, v14, v169, v170
  v_mfma_f32_16x16x32_bf16 a[104:107], v[40:43], v[216:219], a[104:107]
  s_waitcnt lgkmcnt(4)
  v_max3_f32 v14, v14, v171, v172
  v_max3_f32 v14, v14, v173, v174
  v_mfma_f32_16x16x32_bf16 a[108:111], v[44:47], v[208:211], a[108:111]
  ds_read_b64_tr_b16 v[40:41], v6 offset:3072
  v_max3_f32 v14, v14, v175, v176
  v_mfma_f32_16x16x32_bf16 a[112:115], v[44:47], v[212:215], a[112:115]
  s_add_u32 m0, s29, s46
  ds_read_b64_tr_b16 v[42:43], v6 offset:11264
  v_max3_f32 v14, v14, v177, v178
  v_mfma_f32_16x16x32_bf16 a[116:119], v[44:47], v[216:219], a[116:119]
  s_waitcnt lgkmcnt(4)
  buffer_load_dwordx4 v8, s[4:7], s26 offen offset:0 nt lds
  v_mfma_f32_16x16x32_bf16 a[120:123], v[48:51], v[208:211], a[120:123]
  s_add_u32 s32, s32, 16384
  ds_read_b64_tr_b16 v[44:45], v7 offset:3072
  v_max3_f32 v14, v14, v179, v180
  v_mfma_f32_16x16x32_bf16 a[124:127], v[48:51], v[212:215], a[124:127]
  ds_read_b64_tr_b16 v[46:47], v7 offset:11264
  v_max3_f32 v14, v14, v181, v182
  v_mfma_f32_16x16x32_bf16 a[128:131], v[48:51], v[216:219], a[128:131]
  s_waitcnt lgkmcnt(4)
  v_max_f32 v14, v14, v183
  v_cmp_lt_f32 vcc, s44, v14
  v_mfma_f32_16x16x32_bf16 a[132:135], v[52:55], v[208:211], a[132:135]
  s_cmp_eq_u32 s32, 114688
  s_cselect_b32 s32, 65536, s32
  ds_read_b64_tr_b16 v[48:49], v6 offset:3584
  v_mfma_f32_16x16x32_bf16 a[136:139], v[52:55], v[212:215], a[136:139]
  ds_read_b64_tr_b16 v[50:51], v6 offset:11776
  v_add_f32 v16, v16, v196
  v_mfma_f32_16x16x32_bf16 a[140:143], v[52:55], v[216:219], a[140:143]
  s_waitcnt lgkmcnt(4)
  v_add_f32 v16, v16, v197
  v_add_f32 v16, v16, v198
  v_mfma_f32_16x16x32_bf16 a[144:147], v[40:43], v[208:211], a[144:147]
  ds_read_b64_tr_b16 v[52:53], v7 offset:3584
  v_add_f32 v16, v16, v199
  v_mfma_f32_16x16x32_bf16 a[148:151], v[40:43], v[212:215], a[148:151]
  ds_read_b64_tr_b16 v[54:55], v7 offset:11776
  v_add_u32 v5, s32, v2
  v_mfma_f32_16x16x32_bf16 a[152:155], v[40:43], v[216:219], a[152:155]
  s_waitcnt lgkmcnt(4)
  v_add_f32 v17, v17, v188
  v_add_f32 v17, v17, v189
  v_mfma_f32_16x16x32_bf16 a[156:159], v[44:47], v[208:211], a[156:159]
  ds_read_b128 v[24:27], v5 offset:0
  v_add_f32 v17, v17, v190
  v_mfma_f32_16x16x32_bf16 a[160:163], v[44:47], v[212:215], a[160:163]
  s_add_u32 m0, s29, s47
  v_add_f32 v17, v17, v191
  v_add_f32 v17, v17, v200
  v_mfma_f32_16x16x32_bf16 a[164:167], v[44:47], v[216:219], a[164:167]
  s_waitcnt lgkmcnt(3)
  buffer_load_dwordx4 v8, s[4:7], s26 offen offset:256 nt lds
  v_mfma_f32_16x16x32_bf16 a[168:171], v[48:51], v[208:211], a[168:171]
  ds_read_b128 v[28:31], v5 offset:256
  v_add_f32 v17, v17, v201
  v_mfma_f32_16x16x32_bf16 a[172:175], v[48:51], v[212:215], a[172:175]
  v_add_f32 v17, v17, v202
  v_add_f32 v17, v17, v203
  v_mfma_f32_16x16x32_bf16 a[176:179], v[48:51], v[216:219], a[176:179]
  s_waitcnt lgkmcnt(2)
  v_add_f32 v18, v18, v192
  v_add_f32 v18, v18, v193
  v_mfma_f32_16x16x32_bf16 a[180:183], v[52:55], v[208:211], a[180:183]
  ds_read_b128 v[32:35], v5 offset:512
  v_add_f32 v18, v18, v194
  v_mfma_f32_16x16x32_bf16 a[184:187], v[52:55], v[212:215], a[184:187]
  v_add_f32 v18, v18, v195
  v_add_f32 v18, v18, v204
  v_mfma_f32_16x16x32_bf16 a[188:191], v[52:55], v[216:219], a[188:191]
  s_waitcnt lgkmcnt(2)
  v_add_f32 v18, v18, v205
  v_add_f32 v18, v18, v206
  v_add_f32 v18, v18, v207
  s_cbranch_vccnz L_k1_rare0
L_k1_ret0:
  v_mfma_f32_16x16x32_bf16 v[184:187], v[24:27], v[64:67], v[220:223]
  ds_read_b128 v[36:39], v5 offset:768
  v_mfma_f32_16x16x32_bf16 v[188:191], v[24:27], v[68:71], v[224:227]
  v_exp_f32 v160, v160
  v_mfma_f32_16x16x32_bf16 v[192:195], v[24:27], v[72:75], v[228:231]
  s_waitcnt lgkmcnt(2)
  v_exp_f32 v161, v161
  v_mfma_f32_16x16x32_bf16 v[184:187], v[28:31], v[76:79], v[184:187]
  ds_read_b128 v[24:27], v5 offset:1024
  v_cvt_pk_bf16_f32 v208, v160, v161
  v_mfma_f32_16x16x32_bf16 v[188:191], v[28:31], v[80:83], v[188:191]
  s_add_u32 m0, s29, s48
  v_exp_f32 v162, v162
  v_mfma_f32_16x16x32_bf16 v[192:195], v[28:31], v[84:87], v[192:195]
  s_waitcnt lgkmcnt(2)
  buffer_load_dwordx4 v9, s[4:7], s26 offen offset:0 nt lds
  v_mfma_f32_16x16x32_bf16 v[184:187], v[32:35], v[88:91], v[184:187]
  ds_read_b128 v[28:31], v5 offset:1280
  v_add_f32 v16, v16, v160
  v_mfma_f32_16x16x32_bf16 v[188:191], v[32:35], v[92:95], v[188:191]
  v_exp_f32 v163, v163
  v_mfma_f32_16x16x32_bf16 v[192:195], v[32:35], v[96:99], v[192:195]
  s_waitcnt lgkmcnt(2)
  v_exp_f32 v172, v172
  v_mfma_f32_16x16x32_bf16 v[184:187], v[36:39], v[100:103], v[184:187]
  ds_read_b128 v[32:35], v5 offset:1536
  v_cvt_pk_bf16_f32 v209, v162, v163
  v_mfma_f32_16x16x32_bf16 v[188:191], v[36:39], v[104:107], v[188:191]
  v_exp_f32 v173, v173
  v_mfma_f32_16x16x32_bf16 v[192:195], v[36:39], v[108:111], v[192:195]
  s_waitcnt lgkmcnt(2)
  v_exp_f32 v174, v174
  v_mfma_f32_16x16x32_bf16 v[184:187], v[24:27], v[112:115], v[184:187]
  ds_read_b128 v[36:39], v5 offset:1792
  v_cvt_pk_bf16_f32 v210, v172, v173
  v_mfma_f32_16x16x32_bf16 v[188:191], v[24:27], v[116:119], v[188:191]
  v_exp_f32 v175, v175
  v_mfma_f32_16x16x32_bf16 v[192:195], v[24:27], v[120:123], v[192:195]
  s_waitcnt lgkmcnt(2)
  v_exp_f32 v164, v164
  v_mfma_f32_16x16x32_bf16 v[184:187], v[28:31], v[124:127], v[184:187]
  ds_read_b128 v[24:27], v5 offset:8192
  v_cvt_pk_bf16_f32 v211, v174, v175
  v_mfma_f32_16x16x32_bf16 v[188:191], v[28:31], v[128:131], v[188:191]
  s_add_u32 m0, s29, s49
  v_exp_f32 v165, v165
  v_mfma_f32_16x16x32_bf16 v[192:195], v[28:31], v[132:135], v[192:195]
  s_waitcnt lgkmcnt(2)
  buffer_load_dwordx4 v9, s[4:7], s26 offen offset:256 nt lds
  v_mfma_f32_16x16x32_bf16 v[184:187], v[32:35], v[136:139], v[184:187]
  s_add_u32 s27, s27, 16384
  ds_read_b128 v[28:31], v5 offset:8448
  v_cvt_pk_bf16_f32 v212, v164, v165
  v_mfma_f32_16x16x32_bf16 v[188:191], v[32:35], v[140:143], v[188:191]
  s_add_u32 s30, s30, 16384
  v_exp_f32 v166, v166
  v_mfma_f32_16x16x32_bf16 v[192:195], v[32:35], v[144:147], v[192:195]
  s_waitcnt lgkmcnt(2)
  v_exp_f32 v167, v167
  v_mfma_f32_16x16x32_bf16 v[184:187], v[36:39], v[148:151], v[184:187]
  s_cmp_eq_u32 s30, 163840
  s_cselect_b32 s30, 114688, s30
  ds_read_b128 v[32:35], v5 offset:8704
  v_mfma_f32_16x16x32_bf16 v[188:191], v[36:39], v[152:155], v[188:191]
  v_exp_f32 v176, v176
  v_mfma_f32_16x16x32_bf16 v[192:195], v[36:39], v[156:159], v[192:195]
  s_waitcnt lgkmcnt(2)
  v_exp_f32 v177, v177
  v_mfma_f32_16x16x32_bf16 v[196:199], v[24:27], v[64:67], v[220:223]
  s_waitcnt vmcnt(12)
  ds_read_b128 v[36:39], v5 offset:8960
  v_cvt_pk_bf16_f32 v213, v166, v167
  v_mfma_f32_16x16x32_bf16 v[200:203], v[24:27], v[68:71], v[224:227]
  s_barrier
  v_exp_f32 v178, v178
  v_mfma_f32_16x16x32_bf16 v[204:207], v[24:27], v[72:75], v[228:231]
  s_waitcnt lgkmcnt(2)
  v_exp_f32 v179, v179
  v_mfma_f32_16x16x32_bf16 v[196:199], v[28:31], v[76:79], v[196:199]
  s_add_u32 s33, s33, 16384
  ds_read_b128 v[24:27], v5 offset:9216
  v_cvt_pk_bf16_f32 v214, v176, v177
  v_mfma_f32_16x16x32_bf16 v[200:203], v[28:31], v[80:83], v[200:203]
  s_add_u32 m0, s30, s50
  v_exp_f32 v168, v168
  v_mfma_f32_16x16x32_bf16 v[204:207], v[28:31], v[84:87], v[204:207]
  s_waitcnt lgkmcnt(2)
  buffer_load_dwordx4 v10, s[8:11], s27 offen offset:0 nt lds
  v_mfma_f32_16x16x32_bf16 v[196:199], v[32:35], v[88:91], v[196:199]
  s_cmp_eq_u32 s33, 163840
  s_cselect_b32 s33, 114688, s33
  ds_read_b128 v[28:31], v5 offset:9472
  v_mfma_f32_16x16x32_bf16 v[200:203], v[32:35], v[92:95], v[200:203]
  v_exp_f32 v169, v169
  v_mfma_f32_16x16x32_bf16 v[204:207], v[32:35], v[96:99], v[204:207]
  s_waitcnt lgkmcnt(2)
  v_exp_f32 v170, v170
  v_mfma_f32_16x16x32_bf16 v[196:199], v[36:39], v[100:103], v[196:199]
  ds_read_b128 v[32:35], v5 offset:9728
  v_add_u32 v6, s33, v3
  v_mfma_f32_16x16x32_bf16 v[200:203], v[36:39], v[104:107], v[200:203]
  v_exp_f32 v171, v171
  v_mfma_f32_16x16x32_bf16 v[204:207], v[36:39], v[108:111], v[204:207]
  s_waitcnt lgkmcnt(2)
  v_exp_f32 v180, v180
  v_mfma_f32_16x16x32_bf16 v[196:199], v[24:27], v[112:115], v[196:199]
  ds_read_b128 v[36:39], v5 offset:9984
  v_add_u32 v7, s33, v4
  v_mfma_f32_16x16x32_bf16 v[200:203], v[24:27], v[116:119], v[200:203]
  v_exp_f32 v181, v181
  v_mfma_f32_16x16x32_bf16 v[204:207], v[24:27], v[120:123], v[204:207]
  s_waitcnt lgkmcnt(2)
  v_exp_f32 v182, v182
  v_mfma_f32_16x16x32_bf16 v[196:199], v[28:31], v[124:127], v[196:199]
  ds_read_b64_tr_b16 v[40:41], v6 offset:0
  v_cvt_pk_bf16_f32 v215, v178, v179
  v_mfma_f32_16x16x32_bf16 v[200:203], v[28:31], v[128:131], v[200:203]
  s_add_u32 m0, s30, s51
  ds_read_b64_tr_b16 v[42:43], v6 offset:8192
  v_cvt_pk_bf16_f32 v216, v168, v169
  v_mfma_f32_16x16x32_bf16 v[204:207], v[28:31], v[132:135], v[204:207]
  s_waitcnt lgkmcnt(3)
  buffer_load_dwordx4 v10, s[8:11], s27 offen offset:128 nt lds
  v_mfma_f32_16x16x32_bf16 v[196:199], v[32:35], v[136:139], v[196:199]
  ds_read_b64_tr_b16 v[44:45], v7 offset:0
  v_cvt_pk_bf16_f32 v217, v170, v171
  v_mfma_f32_16x16x32_bf16 v[200:203], v[32:35], v[140:143], v[200:203]
  ds_read_b64_tr_b16 v[46:47], v7 offset:8192
  v_cvt_pk_bf16_f32 v218, v180, v181
  v_mfma_f32_16x16x32_bf16 v[204:207], v[32:35], v[144:147], v[204:207]
  s_waitcnt lgkmcnt(4)
  v_exp_f32 v183, v183
  v_mfma_f32_16x16x32_bf16 v[196:199], v[36:39], v[148:151], v[196:199]
  ds_read_b64_tr_b16 v[48:49], v6 offset:512
  v_cvt_pk_bf16_f32 v219, v182, v183
  v_mfma_f32_16x16x32_bf16 v[200:203], v[36:39], v[152:155], v[200:203]
  ds_read_b64_tr_b16 v[50:51], v6 offset:8704
  v_add_f32 v16, v16, v161
  v_mfma_f32_16x16x32_bf16 v[204:207], v[36:39], v[156:159], v[204:207]
  s_waitcnt lgkmcnt(4)
  v_add_f32 v16, v16, v162
  v_add_f32 v16, v16, v163
  v_mfma_f32_16x16x32_bf16 a[0:3], v[40:43], v[208:211], a[0:3]
  ds_read_b64_tr_b16 v[52:53], v7 offset:512
  v_mul_f32 v184, s42, v184
  v_mfma_f32_16x16x32_bf16 a[4:7], v[40:43], v[212:215], a[4:7]
  ds_read_b64_tr_b16 v[54:55], v7 offset:8704
  v_mul_f32 v185, s42, v185
  v_mfma_f32_16x16x32_bf16 a[8:11], v[40:43], v[216:219], a[8:11]
  s_waitcnt lgkmcnt(4)
  v_mul_f32 v186, s42, v186
  v_mul_f32 v187, s42, v187
  v_mfma_f32_16x16x32_bf16 a[12:15], v[44:47], v[208:211], a[12:15]
  ds_read_b64_tr_b16 v[40:41], v6 offset:1024
  v_mul_f32 v188, s42, v188
  v_mfma_f32_16x16x32_bf16 a[16:19], v[44:47], v[212:215], a[16:19]
  s_add_u32 m0, s30, s52
  ds_read_b64_tr_b16 v[42:43], v6 offset:9216
  v_mul_f32 v189, s42, v189
  v_mfma_f32_16x16x32_bf16 a[20:23], v[44:47], v[216:219], a[20:23]
  s_waitcnt lgkmcnt(4)
  buffer_load_dwordx4 v10, s[8:11], s27 offen offset:256 nt lds
  v_mfma_f32_16x16x32_bf16 a[24:27], v[48:51], v[208:211], a[24:27]
  ds_read_b64_tr_b16 v[44:45], v7 offset:1024
  v_mul_f32 v190, s42, v190
  v_mfma_f32_16x16x32_bf16 a[28:31], v[48:51], v[212:215], a[28:31]
  ds_read_b64_tr_b16 v[46:47], v7 offset:9216
  v_mul_f32 v191, s42, v191
  v_mfma_f32_16x16x32_bf16 a[32:35], v[48:51], v[216:219], a[32:35]
  s_waitcnt lgkmcnt(4)
  v_mul_f32 v192, s42, v192
  v_mul_f32 v193, s42, v193
  v_mfma_f32_16x16x32_bf16 a[36:39], v[52:55], v[208:211], a[36:39]
  ds_read_b64_tr_b16 v[48:49], v6 offset:1536
  v_mul_f32 v194, s42, v194
  v_mfma_f32_16x16x32_bf16 a[40:43], v[52:55], v[212:215], a[40:43]
  ds_read_b64_tr_b16 v[50:51], v6 offset:9728
  v_mul_f32 v195, s42, v195
  v_mfma_f32_16x16x32_bf16 a[44:47], v[52:55], v[216:219], a[44:47]
  s_waitcnt lgkmcnt(4)
  v_mul_f32 v196, s42, v196
  v_mul_f32 v197, s42, v197
  v_mfma_f32_16x16x32_bf16 a[48:51], v[40:43], v[208:211], a[48:51]
  ds_read_b64_tr_b16 v[52:53], v7 offset:1536
  v_mul_f32 v198, s42, v198
  v_mfma_f32_16x16x32_bf16 a[52:55], v[40:43], v[212:215], a[52:55]
  ds_read_b64_tr_b16 v[54:55], v7 offset:9728
  v_mul_f32 v199, s42, v199
  v_mfma_f32_16x16x32_bf16 a[56:59], v[40:43], v[216:219], a[56:59]
  s_waitcnt lgkmcnt(4)
  v_mul_f32 v200, s42, v200
  v_mul_f32 v201, s42, v201
  v_mfma_f32_16x16x32_bf16 a[60:63], v[44:47], v[208:211], a[60:63]
  ds_read_b64_tr_b16 v[40:41], v6 offset:2048
  v_mul_f32 v202, s42, v202
  v_mfma_f32_16x16x32_bf16 a[64:67], v[44:47], v[212:215], a[64:67]
  s_add_u32 m0, s30, s53
  ds_read_b64_tr_b16 v[42:43], v6 offset:10240
  v_mul_f32 v203, s42, v203
  v_mfma_f32_16x16x32_bf16 a[68:71], v[44:47], v[216:219], a[68:71]
  s_waitcnt lgkmcnt(4)
  buffer_load_dwordx4 v10, s[8:11], s27 offen offset:384 nt lds
  v_mfma_f32_16x16x32_bf16 a[72:75], v[48:51], v[208:211], a[72:75]
  s_add_u32 s26, s26, 16384
  ds_read_b64_tr_b16 v[44:45], v7 offset:2048
  v_mul_f32 v204, s42, v204
  v_mfma_f32_16x16x32_bf16 a[76:79], v[48:51], v[212:215], a[76:79]
  s_add_u32 s29, s29, 16384
  ds_read_b64_tr_b16 v[46:47], v7 offset:10240
  v_mul_f32 v205, s42, v205
  v_mfma_f32_16x16x32_bf16 a[80:83], v[48:51], v[216:219], a[80:83]
  s_waitcnt lgkmcnt(4)
  v_mul_f32 v206, s42, v206
  v_mul_f32 v207, s42, v207
  v_mfma_f32_16x16x32_bf16 a[84:87], v[52:55], v[208:211], a[84:87]
  s_cmp_eq_u32 s29, 114688
  s_cselect_b32 s29, 65536, s29
  ds_read_b64_tr_b16 v[48:49], v6 offset:2560
  v_mfma_f32_16x16x32_bf16 a[88:91], v[52:55], v[212:215], a[88:91]
  ds_read_b64_tr_b16 v[50:51], v6 offset:10752
  v_max3_f32 v14, v184, v185, v186
  v_mfma_f32_16x16x32_bf16 a[92:95], v[52:55], v[216:219], a[92:95]
  s_waitcnt lgkmcnt(4)
  v_max3_f32 v14, v14, v187, v188
  v_max3_f32 v14, v14, v189, v190
  v_mfma_f32_16x16x32_bf16 a[96:99], v[40:43], v[208:211], a[96:99]
  s_waitcnt vmcnt(12)
  ds_read_b64_tr_b16 v[52:53], v7 offset:2560
  v_max3_f32 v14, v14, v191, v192
  v_mfma_f32_16x16x32_bf16 a[100:103], v[40:43], v[212:215], a[100:103]
  s_barrier
  ds_read_b64_tr_b16 v[54:55], v7 offset:10752
  v_max3_f32 v14, v14, v193, v194
  v_mfma_f32_16x16x32_bf16 a[104:107], v[40:43], v[216:219], a[104:107]
  s_waitcnt lgkmcnt(4)
  v_max3_f32 v14, v14, v195, v196
  v_max3_f32 v14, v14, v197, v198
  v_mfma_f32_16x16x32_bf16 a[108:111], v[44:47], v[208:211], a[108:111]
  ds_read_b64_tr_b16 v[40:41], v6 offset:3072
  v_max3_f32 v14, v14, v199, v200
  v_mfma_f32_16x16x32_bf16 a[112:115], v[44:47], v[212:215], a[112:115]
  s_add_u32 m0, s29, s46
  ds_read_b64_tr_b16 v[42:43], v6 offset:11264
  v_max3_f32 v14, v14, v201, v202
  v_mfma_f32_16x16x32_bf16 a[116:119], v[44:47], v[216:219], a[116:119]
  s_waitcnt lgkmcnt(4)
  buffer_load_dwordx4 v8, s[4:7], s26 offen offset:0 nt lds
  v_mfma_f32_16x16x32_bf16 a[120:123], v[48:51], v[208:211], a[120:123]
  s_add_u32 s32, s32, 16384
  ds_read_b64_tr_b16 v[44:45], v7 offset:3072
  v_max3_f32 v14, v14, v203, v204
  v_mfma_f32_16x16x32_bf16 a[124:127], v[48:51], v[212:215], a[124:127]
  ds_read_b64_tr_b16 v[46:47], v7 offset:11264
  v_max3_f32 v14, v14, v205, v206
  v_mfma_f32_16x16x32_bf16 a[128:131], v[48:51], v[216:219], a[128:131]
  s_waitcnt lgkmcnt(4)
  v_max_f32 v14, v14, v207
  v_cmp_lt_f32 vcc, s44, v14
  v_mfma_f32_16x16x32_bf16 a[132:135], v[52:55], v[208:211], a[132:135]
  s_cmp_eq_u32 s32, 114688
  s_cselect_b32 s32, 65536, s32
  ds_read_b64_tr_b16 v[48:49], v6 offset:3584
  v_mfma_f32_16x16x32_bf16 a[136:139], v[52:55], v[212:215], a[136:139]
  ds_read_b64_tr_b16 v[50:51], v6 offset:11776
  v_add_f32 v16, v16, v172
  v_mfma_f32_16x16x32_bf16 a[140:143], v[52:55], v[216:219], a[140:143]
  s_waitcnt lgkmcnt(4)
  v_add_f32 v16, v16, v173
  v_add_f32 v16, v16, v174
  v_mfma_f32_16x16x32_bf16 a[144:147], v[40:43], v[208:211], a[144:147]
  ds_read_b64_tr_b16 v[52:53], v7 offset:3584
  v_add_f32 v16, v16, v175
  v_mfma_f32_16x16x32_bf16 a[148:151], v[40:43], v[212:215], a[148:151]
  ds_read_b64_tr_b16 v[54:55], v7 offset:11776
  v_add_u32 v5, s32, v2
  v_mfma_f32_16x16x32_bf16 a[152:155], v[40:43], v[216:219], a[152:155]
  s_waitcnt lgkmcnt(4)
  v_add_f32 v17, v17, v164
  v_add_f32 v17, v17, v165
  v_mfma_f32_16x16x32_bf16 a[156:159], v[44:47], v[208:211], a[156:159]
  ds_read_b128 v[24:27], v5 offset:0
  v_add_f32 v17, v17, v166
  v_mfma_f32_16x16x32_bf16 a[160:163], v[44:47], v[212:215], a[160:163]
  s_add_u32 m0, s29, s47
  v_add_f32 v17, v17, v167
  v_add_f32 v17, v17, v176
  v_mfma_f32_16x16x32_bf16 a[164:167], v[44:47], v[216:219], a[164:167]
  s_waitcnt lgkmcnt(3)
  buffer_load_dwordx4 v8, s[4:7], s26 offen offset:256 nt lds
  v_mfma_f32_16x16x32_bf16 a[168:171], v[48:51], v[208:211], a[168:171]
  ds_read_b128 v[28:31], v5 offset:256
  v_add_f32 v17, v17, v177
  v_mfma_f32_16x16x32_bf16 a[172:175], v[48:51], v[212:215], a[172:175]
  v_add_f32 v17, v17, v178
  v_add_f32 v17, v17, v179
  v_mfma_f32_16x16x32_bf16 a[176:179], v[48:51], v[216:219], a[176:179]
  s_waitcnt lgkmcnt(2)
  v_add_f32 v18, v18, v168
  v_add_f32 v18, v18, v169
  v_mfma_f32_16x16x32_bf16 a[180:183], v[52:55], v[208:211], a[180:183]
  ds_read_b128 v[32:35], v5 offset:512
  v_add_f32 v18, v18, v170
  v_mfma_f32_16x16x32_bf16 a[184:187], v[52:55], v[212:215], a[184:187]
  v_add_f32 v18, v18, v171
  v_add_f32 v18, v18, v180
  v_mfma_f32_16x16x32_bf16 a[188:191], v[52:55], v[216:219], a[188:191]
  s_waitcnt lgkmcnt(2)
  v_add_f32 v18, v18, v181
  v_add_f32 v18, v18, v182
  v_add_f32 v18, v18, v183
  s_cbranch_vccnz L_k1_rare1
L_k1_ret1:
  s_sub_u32 s37, s37, 1
  s_cmp_lg_u32 s37, 0
  s_cbranch_scc1 L_k1_loop
  s_waitcnt lgkmcnt(0)
  s_waitcnt vmcnt(10)
  s_barrier
  s_add_u32 m0, s29, s48
  s_nop 0
  buffer_load_dwordx4 v9, s[4:7], s26 offen offset:0 nt lds
  s_add_u32 m0, s29, s49
  s_nop 0
  buffer_load_dwordx4 v9, s[4:7], s26 offen offset:256 nt lds
  s_cmp_eq_u32 s25, 1
  s_cbranch_scc0 L_k1_nop4
  v_add_u32 v24, 0, v22
  v_add_u32 v25, 28672, v22
  v_add_u32 v26, 57344, v22
  v_add_u32 v27, 86016, v22
  s_mov_b32 s31, 49152
  s_add_u32 s45, s41, 128
  s_cmp_eq_u32 s45, 896
  s_cselect_b32 s45, 0, s45
  s_add_u32 s54, s45, 0
  s_add_u32 s31, s31, 16384
  s_and_b32 s31, s31, 131071
  s_add_u32 m0, s31, s62
  s_nop 0
  buffer_load_dwordx4 v24, s[56:59], s54 offen offset:0 lds
  s_add_u32 m0, s31, s63
  s_nop 0
  buffer_load_dwordx4 v25, s[56:59], s54 offen offset:0 lds
  s_add_u32 m0, s31, s64
  s_nop 0
  buffer_load_dwordx4 v26, s[56:59], s54 offen offset:0 lds
  s_add_u32 m0, s31, s65
  s_nop 0
  buffer_load_dwordx4 v27, s[56:59], s54 offen offset:0 lds
  s_add_u32 s54, s45, 114688
  s_add_u32 s31, s31, 16384
  s_and_b32 s31, s31, 131071
  s_add_u32 m0, s31, s62
  s_nop 0
  buffer_load_dwordx4 v24, s[56:59], s54 offen offset:0 lds
  s_add_u32 m0, s31, s63
  s_nop 0
  buffer_load_dwordx4 v25, s[56:59], s54 offen offset:0 lds
  s_add_u32 m0, s31, s64
  s_nop 0
  buffer_load_dwordx4 v26, s[56:59], s54 offen offset:0 lds
  s_add_u32 m0, s31, s65
  s_nop 0
  buffer_load_dwordx4 v27, s[56:59], s54 offen offset:0 lds
  s_add_u32 s54, s45, 229376
  s_add_u32 s31, s31, 16384
  s_and_b32 s31, s31, 131071
  s_add_u32 m0, s31, s62
  s_nop 0
  buffer_load_dwordx4 v24, s[56:59], s54 offen offset:0 lds
  s_add_u32 m0, s31, s63
  s_nop 0
  buffer_load_dwordx4 v25, s[56:59], s54 offen offset:0 lds
  s_add_u32 m0, s31, s64
  s_nop 0
  buffer_load_dwordx4 v26, s[56:59], s54 offen offset:0 lds
  s_add_u32 m0, s31, s65
  s_nop 0
  buffer_load_dwordx4 v27, s[56:59], s54 offen offset:0 lds
L_k1_nop4:
  s_add_u32 s33, s33, 16384
  s_cmp_eq_u32 s33, 163840
  s_cselect_b32 s33, 114688, s33
  v_add_u32 v6, s33, v3
  v_add_u32 v7, s33, v4
  ds_read_b64_tr_b16 v[40:41], v6 offset:0
  ds_read_b64_tr_b16 v[42:43], v6 offset:8192
  ds_read_b64_tr_b16 v[44:45], v7 offset:0
  ds_read_b64_tr_b16 v[46:47], v7 offset:8192
  ds_read_b64_tr_b16 v[48:49], v6 offset:512
  ds_read_b64_tr_b16 v[50:51], v6 offset:8704
  v_exp_f32 v184, v184
  v_exp_f32 v185, v185
  v_exp_f32 v186, v186
  v_exp_f32 v187, v187
  v_exp_f32 v196, v196
  v_exp_f32 v197, v197
  v_exp_f32 v198, v198
  v_exp_f32 v199, v199
  v_cvt_pk_bf16_f32 v208, v184, v185
  v_cvt_pk_bf16_f32 v209, v186, v187
  v_cvt_pk_bf16_f32 v210, v196, v197
  v_cvt_pk_bf16_f32 v211, v198, v199
  v_exp_f32 v188, v188
  v_exp_f32 v189, v189
  v_exp_f32 v190, v190
  v_exp_f32 v191, v191
  v_exp_f32 v200, v200
  v_exp_f32 v201, v201
  v_exp_f32 v202, v202
  v_exp_f32 v203, v203
  v_cvt_pk_bf16_f32 v212, v188, v189
  v_cvt_pk_bf16_f32 v213, v190, v191
  v_cvt_pk_bf16_f32 v214, v200, v201
  v_cvt_pk_bf16_f32 v215, v202, v203
  v_exp_f32 v192, v192
  v_exp_f32 v193, v193
  v_exp_f32 v194, v194
  v_exp_f32 v195, v195
  v_exp_f32 v204, v204
  v_exp_f32 v205, v205
  v_exp_f32 v206, v206
  v_exp_f32 v207, v207
  v_cvt_pk_bf16_f32 v216, v192, v193
  v_cvt_pk_bf16_f32 v217, v194, v195
  v_cvt_pk_bf16_f32 v218, v204, v205
  v_cvt_pk_bf16_f32 v219, v206, v207
  s_waitcnt lgkmcnt(4)
  v_mfma_f32_16x16x32_bf16 a[0:3], v[40:43], v[208:211], a[0:3]
  s_add_u32 s27, s27, 16384
  ds_read_b64_tr_b16 v[52:53], v7 offset:512
  v_add_f32 v16, v16, v184
  v_mfma_f32_16x16x32_bf16 a[4:7], v[40:43], v[212:215], a[4:7]
  s_add_u32 s30, s30, 16384
  ds_read_b64_tr_b16 v[54:55], v7 offset:8704
  v_add_f32 v17, v17, v188
  v_mfma_f32_16x16x32_bf16 a[8:11], v[40:43], v[216:219], a[8:11]
  s_waitcnt lgkmcnt(4)
  v_add_f32 v18, v18, v192
  v_add_f32 v16, v16, v185
  v_mfma_f32_16x16x32_bf16 a[12:15], v[44:47], v[208:211], a[12:15]
  s_cmp_eq_u32 s30, 163840
  s_cselect_b32 s30, 114688, s30
  ds_read_b64_tr_b16 v[40:41], v6 offset:1024
  v_mfma_f32_16x16x32_bf16 a[16:19], v[44:47], v[212:215], a[16:19]
  s_add_u32 m0, s30, s50
  ds_read_b64_tr_b16 v[42:43], v6 offset:9216
  v_add_f32 v17, v17, v189
  v_mfma_f32_16x16x32_bf16 a[20:23], v[44:47], v[216:219], a[20:23]
  s_waitcnt lgkmcnt(4)
  buffer_load_dwordx4 v10, s[8:11], s27 offen offset:0 nt lds
  v_mfma_f32_16x16x32_bf16 a[24:27], v[48:51], v[208:211], a[24:27]
  ds_read_b64_tr_b16 v[44:45], v7 offset:1024
  v_add_f32 v18, v18, v193
  v_mfma_f32_16x16x32_bf16 a[28:31], v[48:51], v[212:215], a[28:31]
  ds_read_b64_tr_b16 v[46:47], v7 offset:9216
  v_add_f32 v16, v16, v186
  v_mfma_f32_16x16x32_bf16 a[32:35], v[48:51], v[216:219], a[32:35]
  s_waitcnt lgkmcnt(4)
  v_add_f32 v17, v17, v190
  v_add_f32 v18, v18, v194
  v_mfma_f32_16x16x32_bf16 a[36:39], v[52:55], v[208:211], a[36:39]
  ds_read_b64_tr_b16 v[48:49], v6 offset:1536
  v_add_f32 v16, v16, v187
  v_mfma_f32_16x16x32_bf16 a[40:43], v[52:55], v[212:215], a[40:43]
  s_add_u32 m0, s30, s51
  ds_read_b64_tr_b16 v[50:51], v6 offset:9728
  v_add_f32 v17, v17, v191
  v_mfma_f32_16x16x32_bf16 a[44:47], v[52:55], v[216:219], a[44:47]
  s_waitcnt lgkmcnt(4)
  buffer_load_dwordx4 v10, s[8:11], s27 offen offset:128 nt lds
  v_mfma_f32_16x16x32_bf16 a[48:51], v[40:43], v[208:211], a[48:51]
  ds_read_b64_tr_b16 v[52:53], v7 offset:1536
  v_add_f32 v18, v18, v195
  v_mfma_f32_16x16x32_bf16 a[52:55], v[40:43], v[212:215], a[52:55]
  ds_read_b64_tr_b16 v[54:55], v7 offset:9728
  v_add_f32 v16, v16, v196
  v_mfma_f32_16x16x32_bf16 a[56:59], v[40:43], v[216:219], a[56:59]
  s_waitcnt lgkmcnt(4)
  v_add_f32 v17, v17, v200
  v_add_f32 v18, v18, v204
  v_mfma_f32_16x16x32_bf16 a[60:63], v[44:47], v[208:211], a[60:63]
  ds_read_b64_tr_b16 v[40:41], v6 offset:2048
  v_add_f32 v16, v16, v197
  v_mfma_f32_16x16x32_bf16 a[64:67], v[44:47], v[212:215], a[64:67]
  s_add_u32 m0, s30, s52
  ds_read_b64_tr_b16 v[42:43], v6 offset:10240
  v_add_f32 v17, v17, v201
  v_mfma_f32_16x16x32_bf16 a[68:71], v[44:47], v[216:219], a[68:71]
  s_waitcnt lgkmcnt(4)
  buffer_load_dwordx4 v10, s[8:11], s27 offen offset:256 nt lds
  v_mfma_f32_16x16x32_bf16 a[72:75], v[48:51], v[208:211], a[72:75]
  ds_read_b64_tr_b16 v[44:45], v7 offset:2048
  v_add_f32 v18, v18, v205
  v_mfma_f32_16x16x32_bf16 a[76:79], v[48:51], v[212:215], a[76:79]
  ds_read_b64_tr_b16 v[46:47], v7 offset:10240
  v_add_f32 v16, v16, v198
  v_mfma_f32_16x16x32_bf16 a[80:83], v[48:51], v[216:219], a[80:83]
  s_waitcnt lgkmcnt(4)
  v_add_f32 v17, v17, v202
  v_add_f32 v18, v18, v206
  v_mfma_f32_16x16x32_bf16 a[84:87], v[52:55], v[208:211], a[84:87]
  ds_read_b64_tr_b16 v[48:49], v6 offset:2560
  v_add_f32 v16, v16, v199
  v_mfma_f32_16x16x32_bf16 a[88:91], v[52:55], v[212:215], a[88:91]
  s_add_u32 m0, s30, s53
  ds_read_b64_tr_b16 v[50:51], v6 offset:10752
  v_add_f32 v17, v17, v203
  v_mfma_f32_16x16x32_bf16 a[92:95], v[52:55], v[216:219], a[92:95]
  s_waitcnt lgkmcnt(4)
  buffer_load_dwordx4 v10, s[8:11], s27 offen offset:384 nt lds
  v_mfma_f32_16x16x32_bf16 a[96:99], v[40:43], v[208:211], a[96:99]
  ds_read_b64_tr_b16 v[52:53], v7 offset:2560
  v_add_f32 v18, v18, v207
  v_mfma_f32_16x16x32_bf16 a[100:103], v[40:43], v[212:215], a[100:103]
  ds_read_b64_tr_b16 v[54:55], v7 offset:10752
  v_mfma_f32_16x16x32_bf16 a[104:107], v[40:43], v[216:219], a[104:107]
  s_waitcnt lgkmcnt(4)
  v_mfma_f32_16x16x32_bf16 a[108:111], v[44:47], v[208:211], a[108:111]
  ds_read_b64_tr_b16 v[40:41], v6 offset:3072
  v_mfma_f32_16x16x32_bf16 a[112:115], v[44:47], v[212:215], a[112:115]
  ds_read_b64_tr_b16 v[42:43], v6 offset:11264
  v_mfma_f32_16x16x32_bf16 a[116:119], v[44:47], v[216:219], a[116:119]
  s_waitcnt lgkmcnt(4)
  v_mfma_f32_16x16x32_bf16 a[120:123], v[48:51], v[208:211], a[120:123]
  ds_read_b64_tr_b16 v[44:45], v7 offset:3072
  v_mfma_f32_16x16x32_bf16 a[124:127], v[48:51], v[212:215], a[124:127]
  ds_read_b64_tr_b16 v[46:47], v7 offset:11264
  v_mfma_f32_16x16x32_bf16 a[128:131], v[48:51], v[216:219], a[128:131]
  s_waitcnt lgkmcnt(4)
  v_mfma_f32_16x16x32_bf16 a[132:135], v[52:55], v[208:211], a[132:135]
  ds_read_b64_tr_b16 v[48:49], v6 offset:3584
  v_mfma_f32_16x16x32_bf16 a[136:139], v[52:55], v[212:215], a[136:139]
  ds_read_b64_tr_b16 v[50:51], v6 offset:11776
  v_mfma_f32_16x16x32_bf16 a[140:143], v[52:55], v[216:219], a[140:143]
  s_waitcnt lgkmcnt(4)
  v_mfma_f32_16x16x32_bf16 a[144:147], v[40:43], v[208:211], a[144:147]
  ds_read_b64_tr_b16 v[52:53], v7 offset:3584
  v_mfma_f32_16x16x32_bf16 a[148:151], v[40:43], v[212:215], a[148:151]
  ds_read_b64_tr_b16 v[54:55], v7 offset:11776
  v_mfma_f32_16x16x32_bf16 a[152:155], v[40:43], v[216:219], a[152:155]
  s_waitcnt lgkmcnt(4)
  v_mfma_f32_16x16x32_bf16 a[156:159], v[44:47], v[208:211], a[156:159]
  v_mfma_f32_16x16x32_bf16 a[160:163], v[44:47], v[212:215], a[160:163]
  v_mfma_f32_16x16x32_bf16 a[164:167], v[44:47], v[216:219], a[164:167]
  s_waitcnt lgkmcnt(2)
  v_mfma_f32_16x16x32_bf16 a[168:171], v[48:51], v[208:211], a[168:171]
  v_mfma_f32_16x16x32_bf16 a[172:175], v[48:51], v[212:215], a[172:175]
  v_mfma_f32_16x16x32_bf16 a[176:179], v[48:51], v[216:219], a[176:179]
  s_waitcnt lgkmcnt(0)
  v_mfma_f32_16x16x32_bf16 a[180:183], v[52:55], v[208:211], a[180:183]
  v_mfma_f32_16x16x32_bf16 a[184:187], v[52:55], v[212:215], a[184:187]
  v_mfma_f32_16x16x32_bf16 a[188:191], v[52:55], v[216:219], a[188:191]
  v_mov_b32 v208, v16
  v_mov_b32 v209, v17
  v_mov_b32 v210, v18
  v_permlane32_swap_b32 v16, v208
  v_permlane32_swap_b32 v17, v209
  v_permlane32_swap_b32 v18, v210
  v_add_f32 v16, v16, v208
  v_add_f32 v17, v17, v209
  v_add_f32 v18, v18, v210
  v_mov_b32 v208, v16
  v_mov_b32 v209, v17
  v_mov_b32 v210, v18
  v_permlane16_swap_b32 v16, v208
  v_permlane16_swap_b32 v17, v209
  v_permlane16_swap_b32 v18, v210
  v_add_f32 v16, v16, v208
  v_add_f32 v17, v17, v209
  v_add_f32 v18, v18, v210
  s_cmp_eq_u32 s25, 1
  s_cbranch_scc1 L_k1_epi1
  v_rcp_f32 v56, v16
  v_rcp_f32 v58, v17
  v_rcp_f32 v60, v18
  s_mov_b32 s25, 1
  s_mov_b32 s45, 1
  s_add_u32 s40, s40, 128
  s_cmp_eq_u32 s40, 896
  s_cselect_b32 s40, 0, s40
  s_waitcnt vmcnt(63)
  s_barrier
  s_branch L_k1_unit
L_k1_epi1:
  v_rcp_f32 v220, v16
  v_rcp_f32 v222, v17
  v_rcp_f32 v224, v18
  v_mov_b32 v221, v220
  v_mov_b32 v223, v222
  v_mov_b32 v225, v224
  v_accvgpr_read_b32 v160, a0
  v_accvgpr_read_b32 v161, a1
  v_accvgpr_read_b32 v162, a2
  v_accvgpr_read_b32 v163, a3
  v_accvgpr_read_b32 v164, a12
  v_accvgpr_read_b32 v165, a13
  v_accvgpr_read_b32 v166, a14
  v_accvgpr_read_b32 v167, a15
  v_pk_mul_f32 v[160:161], v[160:161], v[220:221]
  v_pk_mul_f32 v[162:163], v[162:163], v[220:221]
  v_pk_mul_f32 v[164:165], v[164:165], v[220:221]
  v_pk_mul_f32 v[166:167], v[166:167], v[220:221]
  v_cvt_pk_bf16_f32 v64, v160, v161
  v_cvt_pk_bf16_f32 v65, v162, v163
  v_cvt_pk_bf16_f32 v66, v164, v165
  v_cvt_pk_bf16_f32 v67, v166, v167
  v_accvgpr_read_b32 v168, a4
  v_accvgpr_read_b32 v169, a5
  v_accvgpr_read_b32 v170, a6
  v_accvgpr_read_b32 v171, a7
  v_accvgpr_read_b32 v172, a16
  v_accvgpr_read_b32 v173, a17
  v_accvgpr_read_b32 v174, a18
  v_accvgpr_read_b32 v175, a19
  v_pk_mul_f32 v[168:169], v[168:169], v[222:223]
  v_pk_mul_f32 v[170:171], v[170:171], v[222:223]
  v_pk_mul_f32 v[172:173], v[172:173], v[222:223]
  v_pk_mul_f32 v[174:175], v[174:175], v[222:223]
  v_cvt_pk_bf16_f32 v68, v168, v169
  v_cvt_pk_bf16_f32 v69, v170, v171
  v_cvt_pk_bf16_f32 v70, v172, v173
  v_cvt_pk_bf16_f32 v71, v174, v175
  v_accvgpr_read_b32 v176, a8
  v_accvgpr_read_b32 v177, a9
  v_accvgpr_read_b32 v178, a10
  v_accvgpr_read_b32 v179, a11
  v_accvgpr_read_b32 v180, a20
  v_accvgpr_read_b32 v181, a21
  v_accvgpr_read_b32 v182, a22
  v_accvgpr_read_b32 v183, a23
  v_pk_mul_f32 v[176:177], v[176:177], v[224:225]
  v_pk_mul_f32 v[178:179], v[178:179], v[224:225]
  v_pk_mul_f32 v[180:181], v[180:181], v[224:225]
  v_pk_mul_f32 v[182:183], v[182:183], v[224:225]
  v_cvt_pk_bf16_f32 v72, v176, v177
  v_cvt_pk_bf16_f32 v73, v178, v179
  v_cvt_pk_bf16_f32 v74, v180, v181
  v_cvt_pk_bf16_f32 v75, v182, v183
  v_accvgpr_read_b32 v184, a24
  v_accvgpr_read_b32 v185, a25
  v_accvgpr_read_b32 v186, a26
  v_accvgpr_read_b32 v187, a27
  v_accvgpr_read_b32 v188, a36
  v_accvgpr_read_b32 v189, a37
  v_accvgpr_read_b32 v190, a38
  v_accvgpr_read_b32 v191, a39
  v_pk_mul_f32 v[184:185], v[184:185], v[220:221]
  v_pk_mul_f32 v[186:187], v[186:187], v[220:221]
  v_pk_mul_f32 v[188:189], v[188:189], v[220:221]
  v_pk_mul_f32 v[190:191], v[190:191], v[220:221]
  v_cvt_pk_bf16_f32 v76, v184, v185
  v_cvt_pk_bf16_f32 v77, v186, v187
  v_cvt_pk_bf16_f32 v78, v188, v189
  v_cvt_pk_bf16_f32 v79, v190, v191
  v_accvgpr_read_b32 v192, a28
  v_accvgpr_read_b32 v193, a29
  v_accvgpr_read_b32 v194, a30
  v_accvgpr_read_b32 v195, a31
  v_accvgpr_read_b32 v196, a40
  v_accvgpr_read_b32 v197, a41
  v_accvgpr_read_b32 v198, a42
  v_accvgpr_read_b32 v199, a43
  v_pk_mul_f32 v[192:193], v[192:193], v[222:223]
  v_pk_mul_f32 v[194:195], v[194:195], v[222:223]
  v_pk_mul_f32 v[196:197], v[196:197], v[222:223]
  v_pk_mul_f32 v[198:199], v[198:199], v[222:223]
  v_cvt_pk_bf16_f32 v80, v192, v193
  v_cvt_pk_bf16_f32 v81, v194, v195
  v_cvt_pk_bf16_f32 v82, v196, v197
  v_cvt_pk_bf16_f32 v83, v198, v199
  v_accvgpr_read_b32 v200, a32
  v_accvgpr_read_b32 v201, a33
  v_accvgpr_read_b32 v202, a34
  v_accvgpr_read_b32 v203, a35
  v_accvgpr_read_b32 v204, a44
  v_accvgpr_read_b32 v205, a45
  v_accvgpr_read_b32 v206, a46
  v_accvgpr_read_b32 v207, a47
  v_pk_mul_f32 v[200:201], v[200:201], v[224:225]
  v_pk_mul_f32 v[202:203], v[202:203], v[224:225]
  v_pk_mul_f32 v[204:205], v[204:205], v[224:225]
  v_pk_mul_f32 v[206:207], v[206:207], v[224:225]
  v_cvt_pk_bf16_f32 v84, v200, v201
  v_cvt_pk_bf16_f32 v85, v202, v203
  v_cvt_pk_bf16_f32 v86, v204, v205
  v_cvt_pk_bf16_f32 v87, v206, v207
  v_accvgpr_read_b32 v160, a48
  v_accvgpr_read_b32 v161, a49
  v_accvgpr_read_b32 v162, a50
  v_accvgpr_read_b32 v163, a51
  v_accvgpr_read_b32 v164, a60
  v_accvgpr_read_b32 v165, a61
  v_accvgpr_read_b32 v166, a62
  v_accvgpr_read_b32 v167, a63
  v_pk_mul_f32 v[160:161], v[160:161], v[220:221]
  v_pk_mul_f32 v[162:163], v[162:163], v[220:221]
  v_pk_mul_f32 v[164:165], v[164:165], v[220:221]
  v_pk_mul_f32 v[166:167], v[166:167], v[220:221]
  v_cvt_pk_bf16_f32 v88, v160, v161
  v_cvt_pk_bf16_f32 v89, v162, v163
  v_cvt_pk_bf16_f32 v90, v164, v165
  v_cvt_pk_bf16_f32 v91, v166, v167
  v_accvgpr_read_b32 v168, a52
  v_accvgpr_read_b32 v169, a53
  v_accvgpr_read_b32 v170, a54
  v_accvgpr_read_b32 v171, a55
  v_accvgpr_read_b32 v172, a64
  v_accvgpr_read_b32 v173, a65
  v_accvgpr_read_b32 v174, a66
  v_accvgpr_read_b32 v175, a67
  v_pk_mul_f32 v[168:169], v[168:169], v[222:223]
  v_pk_mul_f32 v[170:171], v[170:171], v[222:223]
  v_pk_mul_f32 v[172:173], v[172:173], v[222:223]
  v_pk_mul_f32 v[174:175], v[174:175], v[222:223]
  v_cvt_pk_bf16_f32 v92, v168, v169
  v_cvt_pk_bf16_f32 v93, v170, v171
  v_cvt_pk_bf16_f32 v94, v172, v173
  v_cvt_pk_bf16_f32 v95, v174, v175
  v_accvgpr_read_b32 v176, a56
  v_accvgpr_read_b32 v177, a57
  v_accvgpr_read_b32 v178, a58
  v_accvgpr_read_b32 v179, a59
  v_accvgpr_read_b32 v180, a68
  v_accvgpr_read_b32 v181, a69
  v_accvgpr_read_b32 v182, a70
  v_accvgpr_read_b32 v183, a71
  v_pk_mul_f32 v[176:177], v[176:177], v[224:225]
  v_pk_mul_f32 v[178:179], v[178:179], v[224:225]
  v_pk_mul_f32 v[180:181], v[180:181], v[224:225]
  v_pk_mul_f32 v[182:183], v[182:183], v[224:225]
  v_cvt_pk_bf16_f32 v96, v176, v177
  v_cvt_pk_bf16_f32 v97, v178, v179
  v_cvt_pk_bf16_f32 v98, v180, v181
  v_cvt_pk_bf16_f32 v99, v182, v183
  v_accvgpr_read_b32 v184, a72
  v_accvgpr_read_b32 v185, a73
  v_accvgpr_read_b32 v186, a74
  v_accvgpr_read_b32 v187, a75
  v_accvgpr_read_b32 v188, a84
  v_accvgpr_read_b32 v189, a85
  v_accvgpr_read_b32 v190, a86
  v_accvgpr_read_b32 v191, a87
  v_pk_mul_f32 v[184:185], v[184:185], v[220:221]
  v_pk_mul_f32 v[186:187], v[186:187], v[220:221]
  v_pk_mul_f32 v[188:189], v[188:189], v[220:221]
  v_pk_mul_f32 v[190:191], v[190:191], v[220:221]
  v_cvt_pk_bf16_f32 v100, v184, v185
  v_cvt_pk_bf16_f32 v101, v186, v187
  v_cvt_pk_bf16_f32 v102, v188, v189
  v_cvt_pk_bf16_f32 v103, v190, v191
  v_accvgpr_read_b32 v192, a76
  v_accvgpr_read_b32 v193, a77
  v_accvgpr_read_b32 v194, a78
  v_accvgpr_read_b32 v195, a79
  v_accvgpr_read_b32 v196, a88
  v_accvgpr_read_b32 v197, a89
  v_accvgpr_read_b32 v198, a90
  v_accvgpr_read_b32 v199, a91
  v_pk_mul_f32 v[192:193], v[192:193], v[222:223]
  v_pk_mul_f32 v[194:195], v[194:195], v[222:223]
  v_pk_mul_f32 v[196:197], v[196:197], v[222:223]
  v_pk_mul_f32 v[198:199], v[198:199], v[222:223]
  v_cvt_pk_bf16_f32 v104, v192, v193
  v_cvt_pk_bf16_f32 v105, v194, v195
  v_cvt_pk_bf16_f32 v106, v196, v197
  v_cvt_pk_bf16_f32 v107, v198, v199
  v_accvgpr_read_b32 v200, a80
  v_accvgpr_read_b32 v201, a81
  v_accvgpr_read_b32 v202, a82
  v_accvgpr_read_b32 v203, a83
  v_accvgpr_read_b32 v204, a92
  v_accvgpr_read_b32 v205, a93
  v_accvgpr_read_b32 v206, a94
  v_accvgpr_read_b32 v207, a95
  v_pk_mul_f32 v[200:201], v[200:201], v[224:225]
  v_pk_mul_f32 v[202:203], v[202:203], v[224:225]
  v_pk_mul_f32 v[204:205], v[204:205], v[224:225]
  v_pk_mul_f32 v[206:207], v[206:207], v[224:225]
  v_cvt_pk_bf16_f32 v108, v200, v201
  v_cvt_pk_bf16_f32 v109, v202, v203
  v_cvt_pk_bf16_f32 v110, v204, v205
  v_cvt_pk_bf16_f32 v111, v206, v207
  v_accvgpr_read_b32 v160, a96
  v_accvgpr_read_b32 v161, a97
  v_accvgpr_read_b32 v162, a98
  v_accvgpr_read_b32 v163, a99
  v_accvgpr_read_b32 v164, a108
  v_accvgpr_read_b32 v165, a109
  v_accvgpr_read_b32 v166, a110
  v_accvgpr_read_b32 v167, a111
  v_pk_mul_f32 v[160:161], v[160:161], v[220:221]
  v_pk_mul_f32 v[162:163], v[162:163], v[220:221]
  v_pk_mul_f32 v[164:165], v[164:165], v[220:221]
  v_pk_mul_f32 v[166:167], v[166:167], v[220:221]
  v_cvt_pk_bf16_f32 v112, v160, v161
  v_cvt_pk_bf16_f32 v113, v162, v163
  v_cvt_pk_bf16_f32 v114, v164, v165
  v_cvt_pk_bf16_f32 v115, v166, v167
  v_accvgpr_read_b32 v168, a100
  v_accvgpr_read_b32 v169, a101
  v_accvgpr_read_b32 v170, a102
  v_accvgpr_read_b32 v171, a103
  v_accvgpr_read_b32 v172, a112
  v_accvgpr_read_b32 v173, a113
  v_accvgpr_read_b32 v174, a114
  v_accvgpr_read_b32 v175, a115
  v_pk_mul_f32 v[168:169], v[168:169], v[222:223]
  v_pk_mul_f32 v[170:171], v[170:171], v[222:223]
  v_pk_mul_f32 v[172:173], v[172:173], v[222:223]
  v_pk_mul_f32 v[174:175], v[174:175], v[222:223]
  v_cvt_pk_bf16_f32 v116, v168, v169
  v_cvt_pk_bf16_f32 v117, v170, v171
  v_cvt_pk_bf16_f32 v118, v172, v173
  v_cvt_pk_bf16_f32 v119, v174, v175
  v_accvgpr_read_b32 v176, a104
  v_accvgpr_read_b32 v177, a105
  v_accvgpr_read_b32 v178, a106
  v_accvgpr_read_b32 v179, a107
  v_accvgpr_read_b32 v180, a116
  v_accvgpr_read_b32 v181, a117
  v_accvgpr_read_b32 v182, a118
  v_accvgpr_read_b32 v183, a119
  v_pk_mul_f32 v[176:177], v[176:177], v[224:225]
  v_pk_mul_f32 v[178:179], v[178:179], v[224:225]
  v_pk_mul_f32 v[180:181], v[180:181], v[224:225]
  v_pk_mul_f32 v[182:183], v[182:183], v[224:225]
  v_cvt_pk_bf16_f32 v120, v176, v177
  v_cvt_pk_bf16_f32 v121, v178, v179
  v_cvt_pk_bf16_f32 v122, v180, v181
  v_cvt_pk_bf16_f32 v123, v182, v183
  v_accvgpr_read_b32 v184, a120
  v_accvgpr_read_b32 v185, a121
  v_accvgpr_read_b32 v186, a122
  v_accvgpr_read_b32 v187, a123
  v_accvgpr_read_b32 v188, a132
  v_accvgpr_read_b32 v189, a133
  v_accvgpr_read_b32 v190, a134
  v_accvgpr_read_b32 v191, a135
  v_pk_mul_f32 v[184:185], v[184:185], v[220:221]
  v_pk_mul_f32 v[186:187], v[186:187], v[220:221]
  v_pk_mul_f32 v[188:189], v[188:189], v[220:221]
  v_pk_mul_f32 v[190:191], v[190:191], v[220:221]
  v_cvt_pk_bf16_f32 v124, v184, v185
  v_cvt_pk_bf16_f32 v125, v186, v187
  v_cvt_pk_bf16_f32 v126, v188, v189
  v_cvt_pk_bf16_f32 v127, v190, v191
  v_accvgpr_read_b32 v192, a124
  v_accvgpr_read_b32 v193, a125
  v_accvgpr_read_b32 v194, a126
  v_accvgpr_read_b32 v195, a127
  v_accvgpr_read_b32 v196, a136
  v_accvgpr_read_b32 v197, a137
  v_accvgpr_read_b32 v198, a138
  v_accvgpr_read_b32 v199, a139
  v_pk_mul_f32 v[192:193], v[192:193], v[222:223]
  v_pk_mul_f32 v[194:195], v[194:195], v[222:223]
  v_pk_mul_f32 v[196:197], v[196:197], v[222:223]
  v_pk_mul_f32 v[198:199], v[198:199], v[222:223]
  v_cvt_pk_bf16_f32 v128, v192, v193
  v_cvt_pk_bf16_f32 v129, v194, v195
  v_cvt_pk_bf16_f32 v130, v196, v197
  v_cvt_pk_bf16_f32 v131, v198, v199
  v_accvgpr_read_b32 v200, a128
  v_accvgpr_read_b32 v201, a129
  v_accvgpr_read_b32 v202, a130
  v_accvgpr_read_b32 v203, a131
  v_accvgpr_read_b32 v204, a140
  v_accvgpr_read_b32 v205, a141
  v_accvgpr_read_b32 v206, a142
  v_accvgpr_read_b32 v207, a143
  v_pk_mul_f32 v[200:201], v[200:201], v[224:225]
  v_pk_mul_f32 v[202:203], v[202:203], v[224:225]
  v_pk_mul_f32 v[204:205], v[204:205], v[224:225]
  v_pk_mul_f32 v[206:207], v[206:207], v[224:225]
  v_cvt_pk_bf16_f32 v132, v200, v201
  v_cvt_pk_bf16_f32 v133, v202, v203
  v_cvt_pk_bf16_f32 v134, v204, v205
  v_cvt_pk_bf16_f32 v135, v206, v207
  v_accvgpr_read_b32 v160, a144
  v_accvgpr_read_b32 v161, a145
  v_accvgpr_read_b32 v162, a146
  v_accvgpr_read_b32 v163, a147
  v_accvgpr_read_b32 v164, a156
  v_accvgpr_read_b32 v165, a157
  v_accvgpr_read_b32 v166, a158
  v_accvgpr_read_b32 v167, a159
  v_pk_mul_f32 v[160:161], v[160:161], v[220:221]
  v_pk_mul_f32 v[162:163], v[162:163], v[220:221]
  v_pk_mul_f32 v[164:165], v[164:165], v[220:221]
  v_pk_mul_f32 v[166:167], v[166:167], v[220:221]
  v_cvt_pk_bf16_f32 v136, v160, v161
  v_cvt_pk_bf16_f32 v137, v162, v163
  v_cvt_pk_bf16_f32 v138, v164, v165
  v_cvt_pk_bf16_f32 v139, v166, v167
  v_accvgpr_read_b32 v168, a148
  v_accvgpr_read_b32 v169, a149
  v_accvgpr_read_b32 v170, a150
  v_accvgpr_read_b32 v171, a151
  v_accvgpr_read_b32 v172, a160
  v_accvgpr_read_b32 v173, a161
  v_accvgpr_read_b32 v174, a162
  v_accvgpr_read_b32 v175, a163
  v_pk_mul_f32 v[168:169], v[168:169], v[222:223]
  v_pk_mul_f32 v[170:171], v[170:171], v[222:223]
  v_pk_mul_f32 v[172:173], v[172:173], v[222:223]
  v_pk_mul_f32 v[174:175], v[174:175], v[222:223]
  v_cvt_pk_bf16_f32 v140, v168, v169
  v_cvt_pk_bf16_f32 v141, v170, v171
  v_cvt_pk_bf16_f32 v142, v172, v173
  v_cvt_pk_bf16_f32 v143, v174, v175
  v_accvgpr_read_b32 v176, a152
  v_accvgpr_read_b32 v177, a153
  v_accvgpr_read_b32 v178, a154
  v_accvgpr_read_b32 v179, a155
  v_accvgpr_read_b32 v180, a164
  v_accvgpr_read_b32 v181, a165
  v_accvgpr_read_b32 v182, a166
  v_accvgpr_read_b32 v183, a167
  v_pk_mul_f32 v[176:177], v[176:177], v[224:225]
  v_pk_mul_f32 v[178:179], v[178:179], v[224:225]
  v_pk_mul_f32 v[180:181], v[180:181], v[224:225]
  v_pk_mul_f32 v[182:183], v[182:183], v[224:225]
  v_cvt_pk_bf16_f32 v144, v176, v177
  v_cvt_pk_bf16_f32 v145, v178, v179
  v_cvt_pk_bf16_f32 v146, v180, v181
  v_cvt_pk_bf16_f32 v147, v182, v183
  v_accvgpr_read_b32 v184, a168
  v_accvgpr_read_b32 v185, a169
  v_accvgpr_read_b32 v186, a170
  v_accvgpr_read_b32 v187, a171
  v_accvgpr_read_b32 v188, a180
  v_accvgpr_read_b32 v189, a181
  v_accvgpr_read_b32 v190, a182
  v_accvgpr_read_b32 v191, a183
  v_pk_mul_f32 v[184:185], v[184:185], v[220:221]
  v_pk_mul_f32 v[186:187], v[186:187], v[220:221]
  v_pk_mul_f32 v[188:189], v[188:189], v[220:221]
  v_pk_mul_f32 v[190:191], v[190:191], v[220:221]
  v_cvt_pk_bf16_f32 v148, v184, v185
  v_cvt_pk_bf16_f32 v149, v186, v187
  v_cvt_pk_bf16_f32 v150, v188, v189
  v_cvt_pk_bf16_f32 v151, v190, v191
  v_accvgpr_read_b32 v192, a172
  v_accvgpr_read_b32 v193, a173
  v_accvgpr_read_b32 v194, a174
  v_accvgpr_read_b32 v195, a175
  v_accvgpr_read_b32 v196, a184
  v_accvgpr_read_b32 v197, a185
  v_accvgpr_read_b32 v198, a186
  v_accvgpr_read_b32 v199, a187
  v_pk_mul_f32 v[192:193], v[192:193], v[222:223]
  v_pk_mul_f32 v[194:195], v[194:195], v[222:223]
  v_pk_mul_f32 v[196:197], v[196:197], v[222:223]
  v_pk_mul_f32 v[198:199], v[198:199], v[222:223]
  v_cvt_pk_bf16_f32 v152, v192, v193
  v_cvt_pk_bf16_f32 v153, v194, v195
  v_cvt_pk_bf16_f32 v154, v196, v197
  v_cvt_pk_bf16_f32 v155, v198, v199
  v_accvgpr_read_b32 v200, a176
  v_accvgpr_read_b32 v201, a177
  v_accvgpr_read_b32 v202, a178
  v_accvgpr_read_b32 v203, a179
  v_accvgpr_read_b32 v204, a188
  v_accvgpr_read_b32 v205, a189
  v_accvgpr_read_b32 v206, a190
  v_accvgpr_read_b32 v207, a191
  v_pk_mul_f32 v[200:201], v[200:201], v[224:225]
  v_pk_mul_f32 v[202:203], v[202:203], v[224:225]
  v_pk_mul_f32 v[204:205], v[204:205], v[224:225]
  v_pk_mul_f32 v[206:207], v[206:207], v[224:225]
  v_cvt_pk_bf16_f32 v156, v200, v201
  v_cvt_pk_bf16_f32 v157, v202, v203
  v_cvt_pk_bf16_f32 v158, v204, v205
  v_cvt_pk_bf16_f32 v159, v206, v207
  s_mov_b32 s34, 114688
  s_add_u32 s53, s45, 128
  s_cmp_eq_u32 s53, 896
  s_cselect_b32 s53, 0, s53
  s_waitcnt vmcnt(63)
  s_barrier
  s_add_u32 s34, s34, 16384
  s_and_b32 s34, s34, 131071
  v_add_u32 v6, s34, v3
  v_add_u32 v7, s34, v4
  ds_read_b64_tr_b16 v[40:41], v6 offset:0
  ds_read_b64_tr_b16 v[42:43], v6 offset:8192
  ds_read_b64_tr_b16 v[44:45], v7 offset:0
  ds_read_b64_tr_b16 v[46:47], v7 offset:8192
  ds_read_b64_tr_b16 v[48:49], v6 offset:512
  ds_read_b64_tr_b16 v[50:51], v6 offset:8704
  s_waitcnt lgkmcnt(4)
  s_mov_b32 s37, 7
  s_mov_b32 s55, 0x40000000
  s_mov_b32 s60, 0x40000000
L_k1_oploop:
  v_mfma_f32_16x16x32_bf16 v[160:163], v[40:43], a[192:195], 0
  s_add_u32 s54, s45, 344064
  ds_read_b64_tr_b16 v[52:53], v7 offset:512
  v_cvt_pk_bf16_f32 v222, v196, v197
  v_mfma_f32_16x16x32_bf16 v[164:167], v[40:43], a[196:199], 0
  s_add_u32 s31, s31, 16384
  s_and_b32 s31, s31, 131071
  ds_read_b64_tr_b16 v[54:55], v7 offset:8704
  v_mfma_f32_16x16x32_bf16 v[168:171], v[40:43], a[200:203], 0
  s_waitcnt lgkmcnt(4)
  v_cvt_pk_bf16_f32 v223, v198, v199
  v_cvt_pk_bf16_f32 v226, v200, v201
  v_mfma_f32_16x16x32_bf16 v[172:175], v[44:47], a[192:195], 0
  ds_read_b64_tr_b16 v[40:41], v6 offset:1024
  v_cvt_pk_bf16_f32 v227, v202, v203
  v_mfma_f32_16x16x32_bf16 v[176:179], v[44:47], a[196:199], 0
  ds_read_b64_tr_b16 v[42:43], v6 offset:9216
  v_cvt_pk_bf16_f32 v230, v204, v205
  v_mfma_f32_16x16x32_bf16 v[180:183], v[44:47], a[200:203], 0
  s_waitcnt lgkmcnt(4)
  v_cvt_pk_bf16_f32 v231, v206, v207
  v_mfma_f32_16x16x32_bf16 v[184:187], v[48:51], a[192:195], 0
  ds_read_b64_tr_b16 v[44:45], v7 offset:1024
  v_mfma_f32_16x16x32_bf16 v[188:191], v[48:51], a[196:199], 0
  ds_read_b64_tr_b16 v[46:47], v7 offset:9216
  v_mfma_f32_16x16x32_bf16 v[192:195], v[48:51], a[200:203], 0
  s_waitcnt lgkmcnt(4)
  v_mfma_f32_16x16x32_bf16 v[196:199], v[52:55], a[192:195], 0
  ds_read_b64_tr_b16 v[48:49], v6 offset:1536
  v_mfma_f32_16x16x32_bf16 v[200:203], v[52:55], a[196:199], 0
  ds_read_b64_tr_b16 v[50:51], v6 offset:9728
  v_mfma_f32_16x16x32_bf16 v[204:207], v[52:55], a[200:203], 0
  s_waitcnt lgkmcnt(4)
  buffer_store_dwordx4 v[220:223], v13, s[20:23], s55 offen offset:1024 sc1
  v_mfma_f32_16x16x32_bf16 v[160:163], v[40:43], a[204:207], v[160:163]
  ds_read_b64_tr_b16 v[52:53], v7 offset:1536
  v_mfma_f32_16x16x32_bf16 v[164:167], v[40:43], a[208:211], v[164:167]
  ds_read_b64_tr_b16 v[54:55], v7 offset:9728
  v_mfma_f32_16x16x32_bf16 v[168:171], v[40:43], a[212:215], v[168:171]
  s_waitcnt lgkmcnt(4)
  v_mfma_f32_16x16x32_bf16 v[172:175], v[44:47], a[204:207], v[172:175]
  ds_read_b64_tr_b16 v[40:41], v6 offset:2048
  v_mfma_f32_16x16x32_bf16 v[176:179], v[44:47], a[208:211], v[176:179]
  ds_read_b64_tr_b16 v[42:43], v6 offset:10240
  v_mfma_f32_16x16x32_bf16 v[180:183], v[44:47], a[212:215], v[180:183]
  s_waitcnt lgkmcnt(4)
  buffer_store_dwordx4 v[224:227], v13, s[20:23], s55 offen offset:3072 sc1
  v_mfma_f32_16x16x32_bf16 v[184:187], v[48:51], a[204:207], v[184:187]
  ds_read_b64_tr_b16 v[44:45], v7 offset:2048
  v_mfma_f32_16x16x32_bf16 v[188:191], v[48:51], a[208:211], v[188:191]
  ds_read_b64_tr_b16 v[46:47], v7 offset:10240
  v_mfma_f32_16x16x32_bf16 v[192:195], v[48:51], a[212:215], v[192:195]
  s_waitcnt lgkmcnt(4)
  v_mfma_f32_16x16x32_bf16 v[196:199], v[52:55], a[204:207], v[196:199]
  ds_read_b64_tr_b16 v[48:49], v6 offset:2560
  v_mfma_f32_16x16x32_bf16 v[200:203], v[52:55], a[208:211], v[200:203]
  ds_read_b64_tr_b16 v[50:51], v6 offset:10752
  v_mfma_f32_16x16x32_bf16 v[204:207], v[52:55], a[212:215], v[204:207]
  s_waitcnt lgkmcnt(4)
  buffer_store_dwordx4 v[228:231], v13, s[20:23], s60 offen offset:1024 sc1
  v_mfma_f32_16x16x32_bf16 v[160:163], v[40:43], a[216:219], v[160:163]
  s_waitcnt vmcnt(36)
  ds_read_b64_tr_b16 v[52:53], v7 offset:2560
  v_mfma_f32_16x16x32_bf16 v[164:167], v[40:43], a[220:223], v[164:167]
  s_barrier
  ds_read_b64_tr_b16 v[54:55], v7 offset:10752
  v_mfma_f32_16x16x32_bf16 v[168:171], v[40:43], a[224:227], v[168:171]
  s_waitcnt lgkmcnt(4)
  v_mfma_f32_16x16x32_bf16 v[172:175], v[44:47], a[216:219], v[172:175]
  ds_read_b64_tr_b16 v[40:41], v6 offset:3072
  v_mfma_f32_16x16x32_bf16 v[176:179], v[44:47], a[220:223], v[176:179]
  s_add_u32 m0, s31, s62
  ds_read_b64_tr_b16 v[42:43], v6 offset:11264
  v_mfma_f32_16x16x32_bf16 v[180:183], v[44:47], a[224:227], v[180:183]
  s_waitcnt lgkmcnt(4)
  buffer_load_dwordx4 v24, s[56:59], s54 offen offset:0 lds
  v_mfma_f32_16x16x32_bf16 v[184:187], v[48:51], a[216:219], v[184:187]
  s_add_u32 s34, s34, 16384
  ds_read_b64_tr_b16 v[44:45], v7 offset:3072
  v_mfma_f32_16x16x32_bf16 v[188:191], v[48:51], a[220:223], v[188:191]
  ds_read_b64_tr_b16 v[46:47], v7 offset:11264
  v_mfma_f32_16x16x32_bf16 v[192:195], v[48:51], a[224:227], v[192:195]
  s_waitcnt lgkmcnt(4)
  v_mfma_f32_16x16x32_bf16 v[196:199], v[52:55], a[216:219], v[196:199]
  s_and_b32 s34, s34, 131071
  ds_read_b64_tr_b16 v[48:49], v6 offset:3584
  v_mfma_f32_16x16x32_bf16 v[200:203], v[52:55], a[220:223], v[200:203]
  s_add_u32 m0, s31, s63
  ds_read_b64_tr_b16 v[50:51], v6 offset:11776
  v_mfma_f32_16x16x32_bf16 v[204:207], v[52:55], a[224:227], v[204:207]
  s_waitcnt lgkmcnt(4)
  buffer_load_dwordx4 v25, s[56:59], s54 offen offset:0 lds
  v_mfma_f32_16x16x32_bf16 v[160:163], v[40:43], a[228:231], v[160:163]
  ds_read_b64_tr_b16 v[52:53], v7 offset:3584
  v_add_u32 v6, s34, v3
  v_mfma_f32_16x16x32_bf16 v[164:167], v[40:43], a[232:235], v[164:167]
  ds_read_b64_tr_b16 v[54:55], v7 offset:11776
  v_add_u32 v7, s34, v4
  v_mfma_f32_16x16x32_bf16 v[168:171], v[40:43], a[236:239], v[168:171]
  s_waitcnt lgkmcnt(4)
  v_mfma_f32_16x16x32_bf16 v[172:175], v[44:47], a[228:231], v[172:175]
  ds_read_b64_tr_b16 v[40:41], v6 offset:0
  v_mfma_f32_16x16x32_bf16 v[176:179], v[44:47], a[232:235], v[176:179]
  s_add_u32 m0, s31, s64
  ds_read_b64_tr_b16 v[42:43], v6 offset:8192
  v_mfma_f32_16x16x32_bf16 v[180:183], v[44:47], a[236:239], v[180:183]
  s_waitcnt lgkmcnt(4)
  buffer_load_dwordx4 v26, s[56:59], s54 offen offset:0 lds
  v_mfma_f32_16x16x32_bf16 v[184:187], v[48:51], a[228:231], v[184:187]
  ds_read_b64_tr_b16 v[44:45], v7 offset:0
  v_mfma_f32_16x16x32_bf16 v[188:191], v[48:51], a[232:235], v[188:191]
  ds_read_b64_tr_b16 v[46:47], v7 offset:8192
  v_mfma_f32_16x16x32_bf16 v[192:195], v[48:51], a[236:239], v[192:195]
  s_waitcnt lgkmcnt(4)
  v_mfma_f32_16x16x32_bf16 v[196:199], v[52:55], a[228:231], v[196:199]
  ds_read_b64_tr_b16 v[48:49], v6 offset:512
  v_mfma_f32_16x16x32_bf16 v[200:203], v[52:55], a[232:235], v[200:203]
  s_add_u32 m0, s31, s65
  ds_read_b64_tr_b16 v[50:51], v6 offset:8704
  v_mfma_f32_16x16x32_bf16 v[204:207], v[52:55], a[236:239], v[204:207]
  s_waitcnt lgkmcnt(4)
  buffer_load_dwordx4 v27, s[56:59], s54 offen offset:0 lds
  v_mfma_f32_16x16x32_bf16 v[160:163], v[40:43], a[240:243], v[160:163]
  s_add_u32 s54, s53, 0
  ds_read_b64_tr_b16 v[52:53], v7 offset:512
  v_mfma_f32_16x16x32_bf16 v[164:167], v[40:43], a[244:247], v[164:167]
  s_add_u32 s31, s31, 16384
  s_and_b32 s31, s31, 131071
  ds_read_b64_tr_b16 v[54:55], v7 offset:8704
  v_mfma_f32_16x16x32_bf16 v[168:171], v[40:43], a[248:251], v[168:171]
  s_waitcnt lgkmcnt(4)
  v_mfma_f32_16x16x32_bf16 v[172:175], v[44:47], a[240:243], v[172:175]
  ds_read_b64_tr_b16 v[40:41], v6 offset:1024
  v_mfma_f32_16x16x32_bf16 v[176:179], v[44:47], a[244:247], v[176:179]
  ds_read_b64_tr_b16 v[42:43], v6 offset:9216
  v_mfma_f32_16x16x32_bf16 v[180:183], v[44:47], a[248:251], v[180:183]
  s_waitcnt lgkmcnt(4)
  v_mfma_f32_16x16x32_bf16 v[184:187], v[48:51], a[240:243], v[184:187]
  ds_read_b64_tr_b16 v[44:45], v7 offset:1024
  v_mfma_f32_16x16x32_bf16 v[188:191], v[48:51], a[244:247], v[188:191]
  ds_read_b64_tr_b16 v[46:47], v7 offset:9216
  v_mfma_f32_16x16x32_bf16 v[192:195], v[48:51], a[248:251], v[192:195]
  s_waitcnt lgkmcnt(4)
  v_mfma_f32_16x16x32_bf16 v[196:199], v[52:55], a[240:243], v[196:199]
  ds_read_b64_tr_b16 v[48:49], v6 offset:1536
  v_mfma_f32_16x16x32_bf16 v[200:203], v[52:55], a[244:247], v[200:203]
  ds_read_b64_tr_b16 v[50:51], v6 offset:9728
  v_mfma_f32_16x16x32_bf16 v[204:207], v[52:55], a[248:251], v[204:207]
  s_waitcnt lgkmcnt(4)
  v_mfma_f32_16x16x32_bf16 v[160:163], v[40:43], a[252:255], v[160:163]
  s_cmp_eq_u32 s37, 2
  s_cselect_b32 s58, 0, s58
  ds_read_b64_tr_b16 v[52:53], v7 offset:1536
  v_mfma_f32_16x16x32_bf16 v[164:167], v[40:43], v[232:235], v[164:167]
  s_mul_i32 s55, s41, 48
  ds_read_b64_tr_b16 v[54:55], v7 offset:9728
  v_mfma_f32_16x16x32_bf16 v[168:171], v[40:43], v[236:239], v[168:171]
  s_waitcnt lgkmcnt(4)
  v_mfma_f32_16x16x32_bf16 v[172:175], v[44:47], a[252:255], v[172:175]
  s_add_u32 s60, s55, 4096
  ds_read_b64_tr_b16 v[40:41], v6 offset:2048
  v_mfma_f32_16x16x32_bf16 v[176:179], v[44:47], v[232:235], v[176:179]
  ds_read_b64_tr_b16 v[42:43], v6 offset:10240
  v_mfma_f32_16x16x32_bf16 v[180:183], v[44:47], v[236:239], v[180:183]
  s_waitcnt lgkmcnt(4)
  v_mfma_f32_16x16x32_bf16 v[184:187], v[48:51], a[252:255], v[184:187]
  ds_read_b64_tr_b16 v[44:45], v7 offset:2048
  v_mfma_f32_16x16x32_bf16 v[188:191], v[48:51], v[232:235], v[188:191]
  ds_read_b64_tr_b16 v[46:47], v7 offset:10240
  v_mfma_f32_16x16x32_bf16 v[192:195], v[48:51], v[236:239], v[192:195]
  s_waitcnt lgkmcnt(4)
  v_mfma_f32_16x16x32_bf16 v[196:199], v[52:55], a[252:255], v[196:199]
  ds_read_b64_tr_b16 v[48:49], v6 offset:2560
  v_mfma_f32_16x16x32_bf16 v[200:203], v[52:55], v[232:235], v[200:203]
  ds_read_b64_tr_b16 v[50:51], v6 offset:10752
  v_mfma_f32_16x16x32_bf16 v[204:207], v[52:55], v[236:239], v[204:207]
  s_waitcnt lgkmcnt(4)
  v_mfma_f32_16x16x32_bf16 v[160:163], v[40:43], v[240:243], v[160:163]
  s_waitcnt vmcnt(35)
  ds_read_b64_tr_b16 v[52:53], v7 offset:2560
  v_mfma_f32_16x16x32_bf16 v[164:167], v[40:43], v[244:247], v[164:167]
  s_barrier
  ds_read_b64_tr_b16 v[54:55], v7 offset:10752
  v_mfma_f32_16x16x32_bf16 v[168:171], v[40:43], v[248:251], v[168:171]
  s_waitcnt lgkmcnt(4)
  v_mfma_f32_16x16x32_bf16 v[172:175], v[44:47], v[240:243], v[172:175]
  ds_read_b64_tr_b16 v[40:41], v6 offset:3072
  v_mfma_f32_16x16x32_bf16 v[176:179], v[44:47], v[244:247], v[176:179]
  s_add_u32 m0, s31, s62
  ds_read_b64_tr_b16 v[42:43], v6 offset:11264
  v_mfma_f32_16x16x32_bf16 v[180:183], v[44:47], v[248:251], v[180:183]
  s_waitcnt lgkmcnt(4)
  buffer_load_dwordx4 v24, s[56:59], s54 offen offset:0 lds
  v_mfma_f32_16x16x32_bf16 v[184:187], v[48:51], v[240:243], v[184:187]
  s_add_u32 s34, s34, 16384
  ds_read_b64_tr_b16 v[44:45], v7 offset:3072
  v_mfma_f32_16x16x32_bf16 v[188:191], v[48:51], v[244:247], v[188:191]
  ds_read_b64_tr_b16 v[46:47], v7 offset:11264
  v_mfma_f32_16x16x32_bf16 v[192:195], v[48:51], v[248:251], v[192:195]
  s_waitcnt lgkmcnt(4)
  v_mfma_f32_16x16x32_bf16 v[196:199], v[52:55], v[240:243], v[196:199]
  s_and_b32 s34, s34, 131071
  ds_read_b64_tr_b16 v[48:49], v6 offset:3584
  v_mfma_f32_16x16x32_bf16 v[200:203], v[52:55], v[244:247], v[200:203]
  s_add_u32 m0, s31, s63
  ds_read_b64_tr_b16 v[50:51], v6 offset:11776
  v_mfma_f32_16x16x32_bf16 v[204:207], v[52:55], v[248:251], v[204:207]
  s_waitcnt lgkmcnt(4)
  buffer_load_dwordx4 v25, s[56:59], s54 offen offset:0 lds
  v_mfma_f32_16x16x32_bf16 v[160:163], v[40:43], v[252:255], v[160:163]
  ds_read_b64_tr_b16 v[52:53], v7 offset:3584
  v_add_u32 v6, s34, v3
  v_mfma_f32_16x16x32_bf16 v[164:167], v[40:43], v[56:59], v[164:167]
  ds_read_b64_tr_b16 v[54:55], v7 offset:11776
  v_add_u32 v7, s34, v4
  v_mfma_f32_16x16x32_bf16 v[168:171], v[40:43], v[60:63], v[168:171]
  s_waitcnt lgkmcnt(4)
  v_mfma_f32_16x16x32_bf16 v[172:175], v[44:47], v[252:255], v[172:175]
  ds_read_b64_tr_b16 v[40:41], v6 offset:0
  v_mfma_f32_16x16x32_bf16 v[176:179], v[44:47], v[56:59], v[176:179]
  s_add_u32 m0, s31, s64
  ds_read_b64_tr_b16 v[42:43], v6 offset:8192
  v_mfma_f32_16x16x32_bf16 v[180:183], v[44:47], v[60:63], v[180:183]
  s_waitcnt lgkmcnt(4)
  buffer_load_dwordx4 v26, s[56:59], s54 offen offset:0 lds
  v_mfma_f32_16x16x32_bf16 v[184:187], v[48:51], v[252:255], v[184:187]
  ds_read_b64_tr_b16 v[44:45], v7 offset:0
  v_mfma_f32_16x16x32_bf16 v[188:191], v[48:51], v[56:59], v[188:191]
  ds_read_b64_tr_b16 v[46:47], v7 offset:8192
  v_mfma_f32_16x16x32_bf16 v[192:195], v[48:51], v[60:63], v[192:195]
  s_waitcnt lgkmcnt(4)
  v_mfma_f32_16x16x32_bf16 v[196:199], v[52:55], v[252:255], v[196:199]
  ds_read_b64_tr_b16 v[48:49], v6 offset:512
  v_mfma_f32_16x16x32_bf16 v[200:203], v[52:55], v[56:59], v[200:203]
  s_add_u32 m0, s31, s65
  ds_read_b64_tr_b16 v[50:51], v6 offset:8704
  v_mfma_f32_16x16x32_bf16 v[204:207], v[52:55], v[60:63], v[204:207]
  s_waitcnt lgkmcnt(4)
  buffer_load_dwordx4 v27, s[56:59], s54 offen offset:0 lds
  v_mfma_f32_16x16x32_bf16 v[160:163], v[40:43], v[64:67], v[160:163]
  s_add_u32 s54, s53, 114688
  ds_read_b64_tr_b16 v[52:53], v7 offset:512
  v_mfma_f32_16x16x32_bf16 v[164:167], v[40:43], v[68:71], v[164:167]
  s_add_u32 s31, s31, 16384
  s_and_b32 s31, s31, 131071
  ds_read_b64_tr_b16 v[54:55], v7 offset:8704
  v_mfma_f32_16x16x32_bf16 v[168:171], v[40:43], v[72:75], v[168:171]
  s_waitcnt lgkmcnt(4)
  v_mfma_f32_16x16x32_bf16 v[172:175], v[44:47], v[64:67], v[172:175]
  ds_read_b64_tr_b16 v[40:41], v6 offset:1024
  v_mfma_f32_16x16x32_bf16 v[176:179], v[44:47], v[68:71], v[176:179]
  ds_read_b64_tr_b16 v[42:43], v6 offset:9216
  v_mfma_f32_16x16x32_bf16 v[180:183], v[44:47], v[72:75], v[180:183]
  s_waitcnt lgkmcnt(4)
  v_mfma_f32_16x16x32_bf16 v[184:187], v[48:51], v[64:67], v[184:187]
  ds_read_b64_tr_b16 v[44:45], v7 offset:1024
  v_mfma_f32_16x16x32_bf16 v[188:191], v[48:51], v[68:71], v[188:191]
  ds_read_b64_tr_b16 v[46:47], v7 offset:9216
  v_mfma_f32_16x16x32_bf16 v[192:195], v[48:51], v[72:75], v[192:195]
  s_waitcnt lgkmcnt(4)
  v_mfma_f32_16x16x32_bf16 v[196:199], v[52:55], v[64:67], v[196:199]
  ds_read_b64_tr_b16 v[48:49], v6 offset:1536
  v_mfma_f32_16x16x32_bf16 v[200:203], v[52:55], v[68:71], v[200:203]
  ds_read_b64_tr_b16 v[50:51], v6 offset:9728
  v_mfma_f32_16x16x32_bf16 v[204:207], v[52:55], v[72:75], v[204:207]
  s_waitcnt lgkmcnt(4)
  v_mfma_f32_16x16x32_bf16 v[160:163], v[40:43], v[76:79], v[160:163]
  ds_read_b64_tr_b16 v[52:53], v7 offset:1536
  v_mfma_f32_16x16x32_bf16 v[164:167], v[40:43], v[80:83], v[164:167]
  ds_read_b64_tr_b16 v[54:55], v7 offset:9728
  v_mfma_f32_16x16x32_bf16 v[168:171], v[40:43], v[84:87], v[168:171]
  s_waitcnt lgkmcnt(4)
  v_mfma_f32_16x16x32_bf16 v[172:175], v[44:47], v[76:79], v[172:175]
  ds_read_b64_tr_b16 v[40:41], v6 offset:2048
  v_mfma_f32_16x16x32_bf16 v[176:179], v[44:47], v[80:83], v[176:179]
  ds_read_b64_tr_b16 v[42:43], v6 offset:10240
  v_mfma_f32_16x16x32_bf16 v[180:183], v[44:47], v[84:87], v[180:183]
  s_waitcnt lgkmcnt(4)
  v_mfma_f32_16x16x32_bf16 v[184:187], v[48:51], v[76:79], v[184:187]
  ds_read_b64_tr_b16 v[44:45], v7 offset:2048
  v_mfma_f32_16x16x32_bf16 v[188:191], v[48:51], v[80:83], v[188:191]
  ds_read_b64_tr_b16 v[46:47], v7 offset:10240
  v_mfma_f32_16x16x32_bf16 v[192:195], v[48:51], v[84:87], v[192:195]
  s_waitcnt lgkmcnt(4)
  v_mfma_f32_16x16x32_bf16 v[196:199], v[52:55], v[76:79], v[196:199]
  ds_read_b64_tr_b16 v[48:49], v6 offset:2560
  v_mfma_f32_16x16x32_bf16 v[200:203], v[52:55], v[80:83], v[200:203]
  ds_read_b64_tr_b16 v[50:51], v6 offset:10752
  v_mfma_f32_16x16x32_bf16 v[204:207], v[52:55], v[84:87], v[204:207]
  s_waitcnt lgkmcnt(4)
  v_mfma_f32_16x16x32_bf16 v[160:163], v[40:43], v[88:91], v[160:163]
  s_waitcnt vmcnt(29)
  ds_read_b64_tr_b16 v[52:53], v7 offset:2560
  v_mfma_f32_16x16x32_bf16 v[164:167], v[40:43], v[92:95], v[164:167]
  s_barrier
  ds_read_b64_tr_b16 v[54:55], v7 offset:10752
  v_mfma_f32_16x16x32_bf16 v[168:171], v[40:43], v[96:99], v[168:171]
  s_waitcnt lgkmcnt(4)
  v_mfma_f32_16x16x32_bf16 v[172:175], v[44:47], v[88:91], v[172:175]
  ds_read_b64_tr_b16 v[40:41], v6 offset:3072
  v_mfma_f32_16x16x32_bf16 v[176:179], v[44:47], v[92:95], v[176:179]
  s_add_u32 m0, s31, s62
  ds_read_b64_tr_b16 v[42:43], v6 offset:11264
  v_mfma_f32_16x16x32_bf16 v[180:183], v[44:47], v[96:99], v[180:183]
  s_waitcnt lgkmcnt(4)
  buffer_load_dwordx4 v24, s[56:59], s54 offen offset:0 lds
  v_mfma_f32_16x16x32_bf16 v[184:187], v[48:51], v[88:91], v[184:187]
  s_add_u32 s34, s34, 16384
  ds_read_b64_tr_b16 v[44:45], v7 offset:3072
  v_mfma_f32_16x16x32_bf16 v[188:191], v[48:51], v[92:95], v[188:191]
  ds_read_b64_tr_b16 v[46:47], v7 offset:11264
  v_mfma_f32_16x16x32_bf16 v[192:195], v[48:51], v[96:99], v[192:195]
  s_waitcnt lgkmcnt(4)
  v_mfma_f32_16x16x32_bf16 v[196:199], v[52:55], v[88:91], v[196:199]
  s_and_b32 s34, s34, 131071
  ds_read_b64_tr_b16 v[48:49], v6 offset:3584
  v_mfma_f32_16x16x32_bf16 v[200:203], v[52:55], v[92:95], v[200:203]
  s_add_u32 m0, s31, s63
  ds_read_b64_tr_b16 v[50:51], v6 offset:11776
  v_mfma_f32_16x16x32_bf16 v[204:207], v[52:55], v[96:99], v[204:207]
  s_waitcnt lgkmcnt(4)
  buffer_load_dwordx4 v25, s[56:59], s54 offen offset:0 lds
  v_mfma_f32_16x16x32_bf16 v[160:163], v[40:43], v[100:103], v[160:163]
  ds_read_b64_tr_b16 v[52:53], v7 offset:3584
  v_add_u32 v6, s34, v3
  v_mfma_f32_16x16x32_bf16 v[164:167], v[40:43], v[104:107], v[164:167]
  ds_read_b64_tr_b16 v[54:55], v7 offset:11776
  v_add_u32 v7, s34, v4
  v_mfma_f32_16x16x32_bf16 v[168:171], v[40:43], v[108:111], v[168:171]
  s_waitcnt lgkmcnt(4)
  v_mfma_f32_16x16x32_bf16 v[172:175], v[44:47], v[100:103], v[172:175]
  ds_read_b64_tr_b16 v[40:41], v6 offset:0
  v_mfma_f32_16x16x32_bf16 v[176:179], v[44:47], v[104:107], v[176:179]
  s_add_u32 m0, s31, s64
  ds_read_b64_tr_b16 v[42:43], v6 offset:8192
  v_mfma_f32_16x16x32_bf16 v[180:183], v[44:47], v[108:111], v[180:183]
  s_waitcnt lgkmcnt(4)
  buffer_load_dwordx4 v26, s[56:59], s54 offen offset:0 lds
  v_mfma_f32_16x16x32_bf16 v[184:187], v[48:51], v[100:103], v[184:187]
  ds_read_b64_tr_b16 v[44:45], v6 offset:1024
  v_mfma_f32_16x16x32_bf16 v[188:191], v[48:51], v[104:107], v[188:191]
  ds_read_b64_tr_b16 v[46:47], v6 offset:9216
  v_mfma_f32_16x16x32_bf16 v[192:195], v[48:51], v[108:111], v[192:195]
  s_waitcnt lgkmcnt(4)
  v_mfma_f32_16x16x32_bf16 v[196:199], v[52:55], v[100:103], v[196:199]
  ds_read_b64_tr_b16 v[48:49], v6 offset:2048
  v_mfma_f32_16x16x32_bf16 v[200:203], v[52:55], v[104:107], v[200:203]
  s_add_u32 m0, s31, s65
  ds_read_b64_tr_b16 v[50:51], v6 offset:10240
  v_mfma_f32_16x16x32_bf16 v[204:207], v[52:55], v[108:111], v[204:207]
  s_waitcnt lgkmcnt(4)
  buffer_load_dwordx4 v27, s[56:59], s54 offen offset:0 lds
  v_mfma_f32_16x16x32_bf16 v[160:163], v[40:43], v[112:115], v[160:163]
  s_add_u32 s54, s53, 229376
  ds_read_b64_tr_b16 v[52:53], v6 offset:3072
  v_mfma_f32_16x16x32_bf16 v[164:167], v[40:43], v[116:119], v[164:167]
  s_add_u32 s31, s31, 16384
  s_and_b32 s31, s31, 131071
  ds_read_b64_tr_b16 v[54:55], v6 offset:11264
  v_mfma_f32_16x16x32_bf16 v[168:171], v[40:43], v[120:123], v[168:171]
  s_waitcnt lgkmcnt(4)
  v_mfma_f32_16x16x32_bf16 v[160:163], v[44:47], v[124:127], v[160:163]
  ds_read_b64_tr_b16 v[40:41], v7 offset:0
  v_mfma_f32_16x16x32_bf16 v[164:167], v[44:47], v[128:131], v[164:167]
  ds_read_b64_tr_b16 v[42:43], v7 offset:8192
  v_mfma_f32_16x16x32_bf16 v[168:171], v[44:47], v[132:135], v[168:171]
  s_waitcnt lgkmcnt(4)
  v_mfma_f32_16x16x32_bf16 v[160:163], v[48:51], v[136:139], v[160:163]
  ds_read_b64_tr_b16 v[44:45], v7 offset:1024
  v_mfma_f32_16x16x32_bf16 v[164:167], v[48:51], v[140:143], v[164:167]
  ds_read_b64_tr_b16 v[46:47], v7 offset:9216
  v_mfma_f32_16x16x32_bf16 v[168:171], v[48:51], v[144:147], v[168:171]
  s_waitcnt lgkmcnt(4)
  v_mfma_f32_16x16x32_bf16 v[160:163], v[52:55], v[148:151], v[160:163]
  ds_read_b64_tr_b16 v[48:49], v7 offset:2048
  v_mfma_f32_16x16x32_bf16 v[164:167], v[52:55], v[152:155], v[164:167]
  ds_read_b64_tr_b16 v[50:51], v7 offset:10240
  v_mfma_f32_16x16x32_bf16 v[168:171], v[52:55], v[156:159], v[168:171]
  s_waitcnt lgkmcnt(4)
  v_mfma_f32_16x16x32_bf16 v[172:175], v[40:43], v[112:115], v[172:175]
  ds_read_b64_tr_b16 v[52:53], v7 offset:3072
  v_mfma_f32_16x16x32_bf16 v[176:179], v[40:43], v[116:119], v[176:179]
  ds_read_b64_tr_b16 v[54:55], v7 offset:11264
  v_mfma_f32_16x16x32_bf16 v[180:183], v[40:43], v[120:123], v[180:183]
  s_waitcnt lgkmcnt(4)
  v_mfma_f32_16x16x32_bf16 v[172:175], v[44:47], v[124:127], v[172:175]
  ds_read_b64_tr_b16 v[40:41], v6 offset:512
  v_mfma_f32_16x16x32_bf16 v[176:179], v[44:47], v[128:131], v[176:179]
  ds_read_b64_tr_b16 v[42:43], v6 offset:8704
  v_mfma_f32_16x16x32_bf16 v[180:183], v[44:47], v[132:135], v[180:183]
  s_waitcnt lgkmcnt(4)
  v_mfma_f32_16x16x32_bf16 v[172:175], v[48:51], v[136:139], v[172:175]
  ds_read_b64_tr_b16 v[44:45], v6 offset:1536
  v_mfma_f32_16x16x32_bf16 v[176:179], v[48:51], v[140:143], v[176:179]
  ds_read_b64_tr_b16 v[46:47], v6 offset:9728
  v_mfma_f32_16x16x32_bf16 v[180:183], v[48:51], v[144:147], v[180:183]
  s_waitcnt lgkmcnt(4)
  v_mfma_f32_16x16x32_bf16 v[172:175], v[52:55], v[148:151], v[172:175]
  ds_read_b64_tr_b16 v[48:49], v6 offset:2560
  v_cvt_pk_bf16_f32 v208, v160, v161
  v_mfma_f32_16x16x32_bf16 v[176:179], v[52:55], v[152:155], v[176:179]
  ds_read_b64_tr_b16 v[50:51], v6 offset:10752
  v_cvt_pk_bf16_f32 v209, v162, v163
  v_mfma_f32_16x16x32_bf16 v[180:183], v[52:55], v[156:159], v[180:183]
  s_waitcnt lgkmcnt(4)
  v_mfma_f32_16x16x32_bf16 v[184:187], v[40:43], v[112:115], v[184:187]
  s_waitcnt vmcnt(27)
  ds_read_b64_tr_b16 v[52:53], v6 offset:3584
  v_cvt_pk_bf16_f32 v210, v172, v173
  v_mfma_f32_16x16x32_bf16 v[188:191], v[40:43], v[116:119], v[188:191]
  s_barrier
  ds_read_b64_tr_b16 v[54:55], v6 offset:11776
  v_cvt_pk_bf16_f32 v211, v174, v175
  v_mfma_f32_16x16x32_bf16 v[192:195], v[40:43], v[120:123], v[192:195]
  s_waitcnt lgkmcnt(4)
  v_cvt_pk_bf16_f32 v212, v164, v165
  v_cvt_pk_bf16_f32 v213, v166, v167
  v_mfma_f32_16x16x32_bf16 v[184:187], v[44:47], v[124:127], v[184:187]
  ds_read_b64_tr_b16 v[40:41], v7 offset:512
  v_cvt_pk_bf16_f32 v214, v176, v177
  v_mfma_f32_16x16x32_bf16 v[188:191], v[44:47], v[128:131], v[188:191]
  s_add_u32 m0, s31, s62
  ds_read_b64_tr_b16 v[42:43], v7 offset:8704
  v_cvt_pk_bf16_f32 v215, v178, v179
  v_mfma_f32_16x16x32_bf16 v[192:195], v[44:47], v[132:135], v[192:195]
  s_waitcnt lgkmcnt(4)
  buffer_load_dwordx4 v24, s[56:59], s54 offen offset:0 lds
  v_mfma_f32_16x16x32_bf16 v[184:187], v[48:51], v[136:139], v[184:187]
  s_add_u32 s34, s34, 16384
  ds_read_b64_tr_b16 v[44:45], v7 offset:1536
  v_cvt_pk_bf16_f32 v216, v168, v169
  v_mfma_f32_16x16x32_bf16 v[188:191], v[48:51], v[140:143], v[188:191]
  s_add_u32 m0, s31, s63
  ds_read_b64_tr_b16 v[46:47], v7 offset:9728
  v_cvt_pk_bf16_f32 v217, v170, v171
  v_mfma_f32_16x16x32_bf16 v[192:195], v[48:51], v[144:147], v[192:195]
  s_waitcnt lgkmcnt(4)
  buffer_load_dwordx4 v25, s[56:59], s54 offen offset:0 lds
  v_mfma_f32_16x16x32_bf16 v[184:187], v[52:55], v[148:151], v[184:187]
  s_and_b32 s34, s34, 131071
  ds_read_b64_tr_b16 v[48:49], v7 offset:2560
  v_cvt_pk_bf16_f32 v218, v180, v181
  v_mfma_f32_16x16x32_bf16 v[188:191], v[52:55], v[152:155], v[188:191]
  s_add_u32 m0, s31, s64
  ds_read_b64_tr_b16 v[50:51], v7 offset:10752
  v_cvt_pk_bf16_f32 v219, v182, v183
  v_mfma_f32_16x16x32_bf16 v[192:195], v[52:55], v[156:159], v[192:195]
  s_waitcnt lgkmcnt(4)
  buffer_load_dwordx4 v26, s[56:59], s54 offen offset:0 lds
  v_mfma_f32_16x16x32_bf16 v[196:199], v[40:43], v[112:115], v[196:199]
  ds_read_b64_tr_b16 v[52:53], v7 offset:3584
  v_add_u32 v6, s34, v3
  v_mfma_f32_16x16x32_bf16 v[200:203], v[40:43], v[116:119], v[200:203]
  ds_read_b64_tr_b16 v[54:55], v7 offset:11776
  v_add_u32 v7, s34, v4
  v_mfma_f32_16x16x32_bf16 v[204:207], v[40:43], v[120:123], v[204:207]
  s_waitcnt lgkmcnt(4)
  buffer_store_dwordx4 v[208:211], v13, s[20:23], s55 offen offset:0 sc1
  v_mfma_f32_16x16x32_bf16 v[196:199], v[44:47], v[124:127], v[196:199]
  ds_read_b64_tr_b16 v[40:41], v6 offset:0
  v_cvt_pk_bf16_f32 v220, v184, v185
  v_mfma_f32_16x16x32_bf16 v[200:203], v[44:47], v[128:131], v[200:203]
  ds_read_b64_tr_b16 v[42:43], v6 offset:8192
  v_cvt_pk_bf16_f32 v221, v186, v187
  v_mfma_f32_16x16x32_bf16 v[204:207], v[44:47], v[132:135], v[204:207]
  s_waitcnt lgkmcnt(4)
  buffer_store_dwordx4 v[212:215], v13, s[20:23], s55 offen offset:2048 sc1
  v_mfma_f32_16x16x32_bf16 v[196:199], v[48:51], v[136:139], v[196:199]
  s_mov_b32 s41, s45
  s_mov_b32 s45, s53
  ds_read_b64_tr_b16 v[44:45], v7 offset:0
  v_mfma_f32_16x16x32_bf16 v[200:203], v[48:51], v[140:143], v[200:203]
  s_add_u32 s53, s53, 128
  ds_read_b64_tr_b16 v[46:47], v7 offset:8192
  v_cvt_pk_bf16_f32 v224, v188, v189
  v_mfma_f32_16x16x32_bf16 v[204:207], v[48:51], v[144:147], v[204:207]
  s_waitcnt lgkmcnt(4)
  buffer_store_dwordx4 v[216:219], v13, s[20:23], s60 offen offset:0 sc1
  v_mfma_f32_16x16x32_bf16 v[196:199], v[52:55], v[148:151], v[196:199]
  s_cmp_eq_u32 s53, 896
  s_cselect_b32 s53, 0, s53
  ds_read_b64_tr_b16 v[48:49], v6 offset:512
  v_mfma_f32_16x16x32_bf16 v[200:203], v[52:55], v[152:155], v[200:203]
  s_add_u32 m0, s31, s65
  ds_read_b64_tr_b16 v[50:51], v6 offset:8704
  v_cvt_pk_bf16_f32 v225, v190, v191
  v_mfma_f32_16x16x32_bf16 v[204:207], v[52:55], v[156:159], v[204:207]
  s_waitcnt lgkmcnt(4)
  buffer_load_dwordx4 v27, s[56:59], s54 offen offset:0 lds
  v_cvt_pk_bf16_f32 v228, v192, v193
  v_cvt_pk_bf16_f32 v229, v194, v195
  s_sub_u32 s37, s37, 1
  s_cmp_lg_u32 s37, 0
  s_cbranch_scc1 L_k1_oploop
  v_cvt_pk_bf16_f32 v222, v196, v197
  v_cvt_pk_bf16_f32 v223, v198, v199
  v_cvt_pk_bf16_f32 v226, v200, v201
  v_cvt_pk_bf16_f32 v227, v202, v203
  v_cvt_pk_bf16_f32 v230, v204, v205
  v_cvt_pk_bf16_f32 v231, v206, v207
  buffer_store_dwordx4 v[220:223], v13, s[20:23], s55 offen offset:1024 sc1
  buffer_store_dwordx4 v[224:227], v13, s[20:23], s55 offen offset:3072 sc1
  buffer_store_dwordx4 v[228:231], v13, s[20:23], s60 offen offset:1024 sc1
  s_branch L_k1_end
L_k1_rareF:
  s_nop 7
  s_nop 3
  v_max3_f32 v208, v184, v185, v186
  v_max3_f32 v208, v208, v187, v196
  v_max3_f32 v208, v208, v197, v198
  v_max_f32 v208, v208, v199
  v_max3_f32 v209, v188, v189, v190
  v_max3_f32 v209, v209, v191, v200
  v_max3_f32 v209, v209, v201, v202
  v_max_f32 v209, v209, v203
  v_max3_f32 v210, v192, v193, v194
  v_max3_f32 v210, v210, v195, v204
  v_max3_f32 v210, v210, v205, v206
  v_max_f32 v210, v210, v207
  v_mov_b32 v211, v208
  v_mov_b32 v212, v209
  v_mov_b32 v213, v210
  v_permlane32_swap_b32 v208, v211
  v_permlane32_swap_b32 v209, v212
  v_permlane32_swap_b32 v210, v213
  v_max_f32 v208, v208, v211
  v_max_f32 v209, v209, v212
  v_max_f32 v210, v210, v213
  v_mov_b32 v211, v208
  v_mov_b32 v212, v209
  v_mov_b32 v213, v210
  v_permlane16_swap_b32 v208, v211
  v_permlane16_swap_b32 v209, v212
  v_permlane16_swap_b32 v210, v213
  v_max_f32 v208, v208, v211
  v_max_f32 v209, v209, v212
  v_max_f32 v210, v210, v213
  v_max_f32 v208, 0, v208
  v_max_f32 v209, 0, v209
  v_max_f32 v210, 0, v210
  v_sub_f32 v184, v184, v208
  v_sub_f32 v185, v185, v208
  v_sub_f32 v186, v186, v208
  v_sub_f32 v187, v187, v208
  v_sub_f32 v196, v196, v208
  v_sub_f32 v197, v197, v208
  v_sub_f32 v198, v198, v208
  v_sub_f32 v199, v199, v208
  v_fma_f32 v220, -v208, s43, v220
  v_fma_f32 v221, -v208, s43, v221
  v_fma_f32 v222, -v208, s43, v222
  v_fma_f32 v223, -v208, s43, v223
  v_exp_f32_e64 v214, -v208
  v_sub_f32 v188, v188, v209
  v_sub_f32 v189, v189, v209
  v_sub_f32 v190, v190, v209
  v_sub_f32 v191, v191, v209
  v_sub_f32 v200, v200, v209
  v_sub_f32 v201, v201, v209
  v_sub_f32 v202, v202, v209
  v_sub_f32 v203, v203, v209
  v_fma_f32 v224, -v209, s43, v224
  v_fma_f32 v225, -v209, s43, v225
  v_fma_f32 v226, -v209, s43, v226
  v_fma_f32 v227, -v209, s43, v227
  v_exp_f32_e64 v215, -v209
  v_sub_f32 v192, v192, v210
  v_sub_f32 v193, v193, v210
  v_sub_f32 v194, v194, v210
  v_sub_f32 v195, v195, v210
  v_sub_f32 v204, v204, v210
  v_sub_f32 v205, v205, v210
  v_sub_f32 v206, v206, v210
  v_sub_f32 v207, v207, v210
  v_fma_f32 v228, -v210, s43, v228
  v_fma_f32 v229, -v210, s43, v229
  v_fma_f32 v230, -v210, s43, v230
  v_fma_f32 v231, -v210, s43, v231
  v_exp_f32_e64 v216, -v210
  v_mul_f32 v16, v16, v214
  v_mul_f32 v17, v17, v215
  v_mul_f32 v18, v18, v216
  v_accvgpr_read_b32 v217, a0
  v_accvgpr_read_b32 v218, a1
  v_accvgpr_read_b32 v219, a2
  v_accvgpr_read_b32 v15, a3
  v_mul_f32 v217, v217, v214
  v_mul_f32 v218, v218, v214
  v_mul_f32 v219, v219, v214
  v_mul_f32 v15, v15, v214
  v_accvgpr_write_b32 a0, v217
  v_accvgpr_write_b32 a1, v218
  v_accvgpr_write_b32 a2, v219
  v_accvgpr_write_b32 a3, v15
  v_accvgpr_read_b32 v217, a4
  v_accvgpr_read_b32 v218, a5
  v_accvgpr_read_b32 v219, a6
  v_accvgpr_read_b32 v15, a7
  v_mul_f32 v217, v217, v215
  v_mul_f32 v218, v218, v215
  v_mul_f32 v219, v219, v215
  v_mul_f32 v15, v15, v215
  v_accvgpr_write_b32 a4, v217
  v_accvgpr_write_b32 a5, v218
  v_accvgpr_write_b32 a6, v219
  v_accvgpr_write_b32 a7, v15
  v_accvgpr_read_b32 v217, a8
  v_accvgpr_read_b32 v218, a9
  v_accvgpr_read_b32 v219, a10
  v_accvgpr_read_b32 v15, a11
  v_mul_f32 v217, v217, v216
  v_mul_f32 v218, v218, v216
  v_mul_f32 v219, v219, v216
  v_mul_f32 v15, v15, v216
  v_accvgpr_write_b32 a8, v217
  v_accvgpr_write_b32 a9, v218
  v_accvgpr_write_b32 a10, v219
  v_accvgpr_write_b32 a11, v15
  v_accvgpr_read_b32 v217, a12
  v_accvgpr_read_b32 v218, a13
  v_accvgpr_read_b32 v219, a14
  v_accvgpr_read_b32 v15, a15
  v_mul_f32 v217, v217, v214
  v_mul_f32 v218, v218, v214
  v_mul_f32 v219, v219, v214
  v_mul_f32 v15, v15, v214
  v_accvgpr_write_b32 a12, v217
  v_accvgpr_write_b32 a13, v218
  v_accvgpr_write_b32 a14, v219
  v_accvgpr_write_b32 a15, v15
  v_accvgpr_read_b32 v217, a16
  v_accvgpr_read_b32 v218, a17
  v_accvgpr_read_b32 v219, a18
  v_accvgpr_read_b32 v15, a19
  v_mul_f32 v217, v217, v215
  v_mul_f32 v218, v218, v215
  v_mul_f32 v219, v219, v215
  v_mul_f32 v15, v15, v215
  v_accvgpr_write_b32 a16, v217
  v_accvgpr_write_b32 a17, v218
  v_accvgpr_write_b32 a18, v219
  v_accvgpr_write_b32 a19, v15
  v_accvgpr_read_b32 v217, a20
  v_accvgpr_read_b32 v218, a21
  v_accvgpr_read_b32 v219, a22
  v_accvgpr_read_b32 v15, a23
  v_mul_f32 v217, v217, v216
  v_mul_f32 v218, v218, v216
  v_mul_f32 v219, v219, v216
  v_mul_f32 v15, v15, v216
  v_accvgpr_write_b32 a20, v217
  v_accvgpr_write_b32 a21, v218
  v_accvgpr_write_b32 a22, v219
  v_accvgpr_write_b32 a23, v15
  v_accvgpr_read_b32 v217, a24
  v_accvgpr_read_b32 v218, a25
  v_accvgpr_read_b32 v219, a26
  v_accvgpr_read_b32 v15, a27
  v_mul_f32 v217, v217, v214
  v_mul_f32 v218, v218, v214
  v_mul_f32 v219, v219, v214
  v_mul_f32 v15, v15, v214
  v_accvgpr_write_b32 a24, v217
  v_accvgpr_write_b32 a25, v218
  v_accvgpr_write_b32 a26, v219
  v_accvgpr_write_b32 a27, v15
  v_accvgpr_read_b32 v217, a28
  v_accvgpr_read_b32 v218, a29
  v_accvgpr_read_b32 v219, a30
  v_accvgpr_read_b32 v15, a31
  v_mul_f32 v217, v217, v215
  v_mul_f32 v218, v218, v215
  v_mul_f32 v219, v219, v215
  v_mul_f32 v15, v15, v215
  v_accvgpr_write_b32 a28, v217
  v_accvgpr_write_b32 a29, v218
  v_accvgpr_write_b32 a30, v219
  v_accvgpr_write_b32 a31, v15
  v_accvgpr_read_b32 v217, a32
  v_accvgpr_read_b32 v218, a33
  v_accvgpr_read_b32 v219, a34
  v_accvgpr_read_b32 v15, a35
  v_mul_f32 v217, v217, v216
  v_mul_f32 v218, v218, v216
  v_mul_f32 v219, v219, v216
  v_mul_f32 v15, v15, v216
  v_accvgpr_write_b32 a32, v217
  v_accvgpr_write_b32 a33, v218
  v_accvgpr_write_b32 a34, v219
  v_accvgpr_write_b32 a35, v15
  v_accvgpr_read_b32 v217, a36
  v_accvgpr_read_b32 v218, a37
  v_accvgpr_read_b32 v219, a38
  v_accvgpr_read_b32 v15, a39
  v_mul_f32 v217, v217, v214
  v_mul_f32 v218, v218, v214
  v_mul_f32 v219, v219, v214
  v_mul_f32 v15, v15, v214
  v_accvgpr_write_b32 a36, v217
  v_accvgpr_write_b32 a37, v218
  v_accvgpr_write_b32 a38, v219
  v_accvgpr_write_b32 a39, v15
  v_accvgpr_read_b32 v217, a40
  v_accvgpr_read_b32 v218, a41
  v_accvgpr_read_b32 v219, a42
  v_accvgpr_read_b32 v15, a43
  v_mul_f32 v217, v217, v215
  v_mul_f32 v218, v218, v215
  v_mul_f32 v219, v219, v215
  v_mul_f32 v15, v15, v215
  v_accvgpr_write_b32 a40, v217
  v_accvgpr_write_b32 a41, v218
  v_accvgpr_write_b32 a42, v219
  v_accvgpr_write_b32 a43, v15
  v_accvgpr_read_b32 v217, a44
  v_accvgpr_read_b32 v218, a45
  v_accvgpr_read_b32 v219, a46
  v_accvgpr_read_b32 v15, a47
  v_mul_f32 v217, v217, v216
  v_mul_f32 v218, v218, v216
  v_mul_f32 v219, v219, v216
  v_mul_f32 v15, v15, v216
  v_accvgpr_write_b32 a44, v217
  v_accvgpr_write_b32 a45, v218
  v_accvgpr_write_b32 a46, v219
  v_accvgpr_write_b32 a47, v15
  v_accvgpr_read_b32 v217, a48
  v_accvgpr_read_b32 v218, a49
  v_accvgpr_read_b32 v219, a50
  v_accvgpr_read_b32 v15, a51
  v_mul_f32 v217, v217, v214
  v_mul_f32 v218, v218, v214
  v_mul_f32 v219, v219, v214
  v_mul_f32 v15, v15, v214
  v_accvgpr_write_b32 a48, v217
  v_accvgpr_write_b32 a49, v218
  v_accvgpr_write_b32 a50, v219
  v_accvgpr_write_b32 a51, v15
  v_accvgpr_read_b32 v217, a52
  v_accvgpr_read_b32 v218, a53
  v_accvgpr_read_b32 v219, a54
  v_accvgpr_read_b32 v15, a55
  v_mul_f32 v217, v217, v215
  v_mul_f32 v218, v218, v215
  v_mul_f32 v219, v219, v215
  v_mul_f32 v15, v15, v215
  v_accvgpr_write_b32 a52, v217
  v_accvgpr_write_b32 a53, v218
  v_accvgpr_write_b32 a54, v219
  v_accvgpr_write_b32 a55, v15
  v_accvgpr_read_b32 v217, a56
  v_accvgpr_read_b32 v218, a57
  v_accvgpr_read_b32 v219, a58
  v_accvgpr_read_b32 v15, a59
  v_mul_f32 v217, v217, v216
  v_mul_f32 v218, v218, v216
  v_mul_f32 v219, v219, v216
  v_mul_f32 v15, v15, v216
  v_accvgpr_write_b32 a56, v217
  v_accvgpr_write_b32 a57, v218
  v_accvgpr_write_b32 a58, v219
  v_accvgpr_write_b32 a59, v15
  v_accvgpr_read_b32 v217, a60
  v_accvgpr_read_b32 v218, a61
  v_accvgpr_read_b32 v219, a62
  v_accvgpr_read_b32 v15, a63
  v_mul_f32 v217, v217, v214
  v_mul_f32 v218, v218, v214
  v_mul_f32 v219, v219, v214
  v_mul_f32 v15, v15, v214
  v_accvgpr_write_b32 a60, v217
  v_accvgpr_write_b32 a61, v218
  v_accvgpr_write_b32 a62, v219
  v_accvgpr_write_b32 a63, v15
  v_accvgpr_read_b32 v217, a64
  v_accvgpr_read_b32 v218, a65
  v_accvgpr_read_b32 v219, a66
  v_accvgpr_read_b32 v15, a67
  v_mul_f32 v217, v217, v215
  v_mul_f32 v218, v218, v215
  v_mul_f32 v219, v219, v215
  v_mul_f32 v15, v15, v215
  v_accvgpr_write_b32 a64, v217
  v_accvgpr_write_b32 a65, v218
  v_accvgpr_write_b32 a66, v219
  v_accvgpr_write_b32 a67, v15
  v_accvgpr_read_b32 v217, a68
  v_accvgpr_read_b32 v218, a69
  v_accvgpr_read_b32 v219, a70
  v_accvgpr_read_b32 v15, a71
  v_mul_f32 v217, v217, v216
  v_mul_f32 v218, v218, v216
  v_mul_f32 v219, v219, v216
  v_mul_f32 v15, v15, v216
  v_accvgpr_write_b32 a68, v217
  v_accvgpr_write_b32 a69, v218
  v_accvgpr_write_b32 a70, v219
  v_accvgpr_write_b32 a71, v15
  v_accvgpr_read_b32 v217, a72
  v_accvgpr_read_b32 v218, a73
  v_accvgpr_read_b32 v219, a74
  v_accvgpr_read_b32 v15, a75
  v_mul_f32 v217, v217, v214
  v_mul_f32 v218, v218, v214
  v_mul_f32 v219, v219, v214
  v_mul_f32 v15, v15, v214
  v_accvgpr_write_b32 a72, v217
  v_accvgpr_write_b32 a73, v218
  v_accvgpr_write_b32 a74, v219
  v_accvgpr_write_b32 a75, v15
  v_accvgpr_read_b32 v217, a76
  v_accvgpr_read_b32 v218, a77
  v_accvgpr_read_b32 v219, a78
  v_accvgpr_read_b32 v15, a79
  v_mul_f32 v217, v217, v215
  v_mul_f32 v218, v218, v215
  v_mul_f32 v219, v219, v215
  v_mul_f32 v15, v15, v215
  v_accvgpr_write_b32 a76, v217
  v_accvgpr_write_b32 a77, v218
  v_accvgpr_write_b32 a78, v219
  v_accvgpr_write_b32 a79, v15
  v_accvgpr_read_b32 v217, a80
  v_accvgpr_read_b32 v218, a81
  v_accvgpr_read_b32 v219, a82
  v_accvgpr_read_b32 v15, a83
  v_mul_f32 v217, v217, v216
  v_mul_f32 v218, v218, v216
  v_mul_f32 v219, v219, v216
  v_mul_f32 v15, v15, v216
  v_accvgpr_write_b32 a80, v217
  v_accvgpr_write_b32 a81, v218
  v_accvgpr_write_b32 a82, v219
  v_accvgpr_write_b32 a83, v15
  v_accvgpr_read_b32 v217, a84
  v_accvgpr_read_b32 v218, a85
  v_accvgpr_read_b32 v219, a86
  v_accvgpr_read_b32 v15, a87
  v_mul_f32 v217, v217, v214
  v_mul_f32 v218, v218, v214
  v_mul_f32 v219, v219, v214
  v_mul_f32 v15, v15, v214
  v_accvgpr_write_b32 a84, v217
  v_accvgpr_write_b32 a85, v218
  v_accvgpr_write_b32 a86, v219
  v_accvgpr_write_b32 a87, v15
  v_accvgpr_read_b32 v217, a88
  v_accvgpr_read_b32 v218, a89
  v_accvgpr_read_b32 v219, a90
  v_accvgpr_read_b32 v15, a91
  v_mul_f32 v217, v217, v215
  v_mul_f32 v218, v218, v215
  v_mul_f32 v219, v219, v215
  v_mul_f32 v15, v15, v215
  v_accvgpr_write_b32 a88, v217
  v_accvgpr_write_b32 a89, v218
  v_accvgpr_write_b32 a90, v219
  v_accvgpr_write_b32 a91, v15
  v_accvgpr_read_b32 v217, a92
  v_accvgpr_read_b32 v218, a93
  v_accvgpr_read_b32 v219, a94
  v_accvgpr_read_b32 v15, a95
  v_mul_f32 v217, v217, v216
  v_mul_f32 v218, v218, v216
  v_mul_f32 v219, v219, v216
  v_mul_f32 v15, v15, v216
  v_accvgpr_write_b32 a92, v217
  v_accvgpr_write_b32 a93, v218
  v_accvgpr_write_b32 a94, v219
  v_accvgpr_write_b32 a95, v15
  v_accvgpr_read_b32 v217, a96
  v_accvgpr_read_b32 v218, a97
  v_accvgpr_read_b32 v219, a98
  v_accvgpr_read_b32 v15, a99
  v_mul_f32 v217, v217, v214
  v_mul_f32 v218, v218, v214
  v_mul_f32 v219, v219, v214
  v_mul_f32 v15, v15, v214
  v_accvgpr_write_b32 a96, v217
  v_accvgpr_write_b32 a97, v218
  v_accvgpr_write_b32 a98, v219
  v_accvgpr_write_b32 a99, v15
  v_accvgpr_read_b32 v217, a100
  v_accvgpr_read_b32 v218, a101
  v_accvgpr_read_b32 v219, a102
  v_accvgpr_read_b32 v15, a103
  v_mul_f32 v217, v217, v215
  v_mul_f32 v218, v218, v215
  v_mul_f32 v219, v219, v215
  v_mul_f32 v15, v15, v215
  v_accvgpr_write_b32 a100, v217
  v_accvgpr_write_b32 a101, v218
  v_accvgpr_write_b32 a102, v219
  v_accvgpr_write_b32 a103, v15
  v_accvgpr_read_b32 v217, a104
  v_accvgpr_read_b32 v218, a105
  v_accvgpr_read_b32 v219, a106
  v_accvgpr_read_b32 v15, a107
  v_mul_f32 v217, v217, v216
  v_mul_f32 v218, v218, v216
  v_mul_f32 v219, v219, v216
  v_mul_f32 v15, v15, v216
  v_accvgpr_write_b32 a104, v217
  v_accvgpr_write_b32 a105, v218
  v_accvgpr_write_b32 a106, v219
  v_accvgpr_write_b32 a107, v15
  v_accvgpr_read_b32 v217, a108
  v_accvgpr_read_b32 v218, a109
  v_accvgpr_read_b32 v219, a110
  v_accvgpr_read_b32 v15, a111
  v_mul_f32 v217, v217, v214
  v_mul_f32 v218, v218, v214
  v_mul_f32 v219, v219, v214
  v_mul_f32 v15, v15, v214
  v_accvgpr_write_b32 a108, v217
  v_accvgpr_write_b32 a109, v218
  v_accvgpr_write_b32 a110, v219
  v_accvgpr_write_b32 a111, v15
  v_accvgpr_read_b32 v217, a112
  v_accvgpr_read_b32 v218, a113
  v_accvgpr_read_b32 v219, a114
  v_accvgpr_read_b32 v15, a115
  v_mul_f32 v217, v217, v215
  v_mul_f32 v218, v218, v215
  v_mul_f32 v219, v219, v215
  v_mul_f32 v15, v15, v215
  v_accvgpr_write_b32 a112, v217
  v_accvgpr_write_b32 a113, v218
  v_accvgpr_write_b32 a114, v219
  v_accvgpr_write_b32 a115, v15
  v_accvgpr_read_b32 v217, a116
  v_accvgpr_read_b32 v218, a117
  v_accvgpr_read_b32 v219, a118
  v_accvgpr_read_b32 v15, a119
  v_mul_f32 v217, v217, v216
  v_mul_f32 v218, v218, v216
  v_mul_f32 v219, v219, v216
  v_mul_f32 v15, v15, v216
  v_accvgpr_write_b32 a116, v217
  v_accvgpr_write_b32 a117, v218
  v_accvgpr_write_b32 a118, v219
  v_accvgpr_write_b32 a119, v15
  v_accvgpr_read_b32 v217, a120
  v_accvgpr_read_b32 v218, a121
  v_accvgpr_read_b32 v219, a122
  v_accvgpr_read_b32 v15, a123
  v_mul_f32 v217, v217, v214
  v_mul_f32 v218, v218, v214
  v_mul_f32 v219, v219, v214
  v_mul_f32 v15, v15, v214
  v_accvgpr_write_b32 a120, v217
  v_accvgpr_write_b32 a121, v218
  v_accvgpr_write_b32 a122, v219
  v_accvgpr_write_b32 a123, v15
  v_accvgpr_read_b32 v217, a124
  v_accvgpr_read_b32 v218, a125
  v_accvgpr_read_b32 v219, a126
  v_accvgpr_read_b32 v15, a127
  v_mul_f32 v217, v217, v215
  v_mul_f32 v218, v218, v215
  v_mul_f32 v219, v219, v215
  v_mul_f32 v15, v15, v215
  v_accvgpr_write_b32 a124, v217
  v_accvgpr_write_b32 a125, v218
  v_accvgpr_write_b32 a126, v219
  v_accvgpr_write_b32 a127, v15
  v_accvgpr_read_b32 v217, a128
  v_accvgpr_read_b32 v218, a129
  v_accvgpr_read_b32 v219, a130
  v_accvgpr_read_b32 v15, a131
  v_mul_f32 v217, v217, v216
  v_mul_f32 v218, v218, v216
  v_mul_f32 v219, v219, v216
  v_mul_f32 v15, v15, v216
  v_accvgpr_write_b32 a128, v217
  v_accvgpr_write_b32 a129, v218
  v_accvgpr_write_b32 a130, v219
  v_accvgpr_write_b32 a131, v15
  v_accvgpr_read_b32 v217, a132
  v_accvgpr_read_b32 v218, a133
  v_accvgpr_read_b32 v219, a134
  v_accvgpr_read_b32 v15, a135
  v_mul_f32 v217, v217, v214
  v_mul_f32 v218, v218, v214
  v_mul_f32 v219, v219, v214
  v_mul_f32 v15, v15, v214
  v_accvgpr_write_b32 a132, v217
  v_accvgpr_write_b32 a133, v218
  v_accvgpr_write_b32 a134, v219
  v_accvgpr_write_b32 a135, v15
  v_accvgpr_read_b32 v217, a136
  v_accvgpr_read_b32 v218, a137
  v_accvgpr_read_b32 v219, a138
  v_accvgpr_read_b32 v15, a139
  v_mul_f32 v217, v217, v215
  v_mul_f32 v218, v218, v215
  v_mul_f32 v219, v219, v215
  v_mul_f32 v15, v15, v215
  v_accvgpr_write_b32 a136, v217
  v_accvgpr_write_b32 a137, v218
  v_accvgpr_write_b32 a138, v219
  v_accvgpr_write_b32 a139, v15
  v_accvgpr_read_b32 v217, a140
  v_accvgpr_read_b32 v218, a141
  v_accvgpr_read_b32 v219, a142
  v_accvgpr_read_b32 v15, a143
  v_mul_f32 v217, v217, v216
  v_mul_f32 v218, v218, v216
  v_mul_f32 v219, v219, v216
  v_mul_f32 v15, v15, v216
  v_accvgpr_write_b32 a140, v217
  v_accvgpr_write_b32 a141, v218
  v_accvgpr_write_b32 a142, v219
  v_accvgpr_write_b32 a143, v15
  v_accvgpr_read_b32 v217, a144
  v_accvgpr_read_b32 v218, a145
  v_accvgpr_read_b32 v219, a146
  v_accvgpr_read_b32 v15, a147
  v_mul_f32 v217, v217, v214
  v_mul_f32 v218, v218, v214
  v_mul_f32 v219, v219, v214
  v_mul_f32 v15, v15, v214
  v_accvgpr_write_b32 a144, v217
  v_accvgpr_write_b32 a145, v218
  v_accvgpr_write_b32 a146, v219
  v_accvgpr_write_b32 a147, v15
  v_accvgpr_read_b32 v217, a148
  v_accvgpr_read_b32 v218, a149
  v_accvgpr_read_b32 v219, a150
  v_accvgpr_read_b32 v15, a151
  v_mul_f32 v217, v217, v215
  v_mul_f32 v218, v218, v215
  v_mul_f32 v219, v219, v215
  v_mul_f32 v15, v15, v215
  v_accvgpr_write_b32 a148, v217
  v_accvgpr_write_b32 a149, v218
  v_accvgpr_write_b32 a150, v219
  v_accvgpr_write_b32 a151, v15
  v_accvgpr_read_b32 v217, a152
  v_accvgpr_read_b32 v218, a153
  v_accvgpr_read_b32 v219, a154
  v_accvgpr_read_b32 v15, a155
  v_mul_f32 v217, v217, v216
  v_mul_f32 v218, v218, v216
  v_mul_f32 v219, v219, v216
  v_mul_f32 v15, v15, v216
  v_accvgpr_write_b32 a152, v217
  v_accvgpr_write_b32 a153, v218
  v_accvgpr_write_b32 a154, v219
  v_accvgpr_write_b32 a155, v15
  v_accvgpr_read_b32 v217, a156
  v_accvgpr_read_b32 v218, a157
  v_accvgpr_read_b32 v219, a158
  v_accvgpr_read_b32 v15, a159
  v_mul_f32 v217, v217, v214
  v_mul_f32 v218, v218, v214
  v_mul_f32 v219, v219, v214
  v_mul_f32 v15, v15, v214
  v_accvgpr_write_b32 a156, v217
  v_accvgpr_write_b32 a157, v218
  v_accvgpr_write_b32 a158, v219
  v_accvgpr_write_b32 a159, v15
  v_accvgpr_read_b32 v217, a160
  v_accvgpr_read_b32 v218, a161
  v_accvgpr_read_b32 v219, a162
  v_accvgpr_read_b32 v15, a163
  v_mul_f32 v217, v217, v215
  v_mul_f32 v218, v218, v215
  v_mul_f32 v219, v219, v215
  v_mul_f32 v15, v15, v215
  v_accvgpr_write_b32 a160, v217
  v_accvgpr_write_b32 a161, v218
  v_accvgpr_write_b32 a162, v219
  v_accvgpr_write_b32 a163, v15
  v_accvgpr_read_b32 v217, a164
  v_accvgpr_read_b32 v218, a165
  v_accvgpr_read_b32 v219, a166
  v_accvgpr_read_b32 v15, a167
  v_mul_f32 v217, v217, v216
  v_mul_f32 v218, v218, v216
  v_mul_f32 v219, v219, v216
  v_mul_f32 v15, v15, v216
  v_accvgpr_write_b32 a164, v217
  v_accvgpr_write_b32 a165, v218
  v_accvgpr_write_b32 a166, v219
  v_accvgpr_write_b32 a167, v15
  v_accvgpr_read_b32 v217, a168
  v_accvgpr_read_b32 v218, a169
  v_accvgpr_read_b32 v219, a170
  v_accvgpr_read_b32 v15, a171
  v_mul_f32 v217, v217, v214
  v_mul_f32 v218, v218, v214
  v_mul_f32 v219, v219, v214
  v_mul_f32 v15, v15, v214
  v_accvgpr_write_b32 a168, v217
  v_accvgpr_write_b32 a169, v218
  v_accvgpr_write_b32 a170, v219
  v_accvgpr_write_b32 a171, v15
  v_accvgpr_read_b32 v217, a172
  v_accvgpr_read_b32 v218, a173
  v_accvgpr_read_b32 v219, a174
  v_accvgpr_read_b32 v15, a175
  v_mul_f32 v217, v217, v215
  v_mul_f32 v218, v218, v215
  v_mul_f32 v219, v219, v215
  v_mul_f32 v15, v15, v215
  v_accvgpr_write_b32 a172, v217
  v_accvgpr_write_b32 a173, v218
  v_accvgpr_write_b32 a174, v219
  v_accvgpr_write_b32 a175, v15
  v_accvgpr_read_b32 v217, a176
  v_accvgpr_read_b32 v218, a177
  v_accvgpr_read_b32 v219, a178
  v_accvgpr_read_b32 v15, a179
  v_mul_f32 v217, v217, v216
  v_mul_f32 v218, v218, v216
  v_mul_f32 v219, v219, v216
  v_mul_f32 v15, v15, v216
  v_accvgpr_write_b32 a176, v217
  v_accvgpr_write_b32 a177, v218
  v_accvgpr_write_b32 a178, v219
  v_accvgpr_write_b32 a179, v15
  v_accvgpr_read_b32 v217, a180
  v_accvgpr_read_b32 v218, a181
  v_accvgpr_read_b32 v219, a182
  v_accvgpr_read_b32 v15, a183
  v_mul_f32 v217, v217, v214
  v_mul_f32 v218, v218, v214
  v_mul_f32 v219, v219, v214
  v_mul_f32 v15, v15, v214
  v_accvgpr_write_b32 a180, v217
  v_accvgpr_write_b32 a181, v218
  v_accvgpr_write_b32 a182, v219
  v_accvgpr_write_b32 a183, v15
  v_accvgpr_read_b32 v217, a184
  v_accvgpr_read_b32 v218, a185
  v_accvgpr_read_b32 v219, a186
  v_accvgpr_read_b32 v15, a187
  v_mul_f32 v217, v217, v215
  v_mul_f32 v218, v218, v215
  v_mul_f32 v219, v219, v215
  v_mul_f32 v15, v15, v215
  v_accvgpr_write_b32 a184, v217
  v_accvgpr_write_b32 a185, v218
  v_accvgpr_write_b32 a186, v219
  v_accvgpr_write_b32 a187, v15
  v_accvgpr_read_b32 v217, a188
  v_accvgpr_read_b32 v218, a189
  v_accvgpr_read_b32 v219, a190
  v_accvgpr_read_b32 v15, a191
  v_mul_f32 v217, v217, v216
  v_mul_f32 v218, v218, v216
  v_mul_f32 v219, v219, v216
  v_mul_f32 v15, v15, v216
  v_accvgpr_write_b32 a188, v217
  v_accvgpr_write_b32 a189, v218
  v_accvgpr_write_b32 a190, v219
  v_accvgpr_write_b32 a191, v15
  s_nop 3
  s_branch L_k1_retF
L_k1_rare0:
  s_nop 7
  s_nop 3
  v_max3_f32 v208, v160, v161, v162
  v_max3_f32 v208, v208, v163, v172
  v_max3_f32 v208, v208, v173, v174
  v_max_f32 v208, v208, v175
  v_max3_f32 v209, v164, v165, v166
  v_max3_f32 v209, v209, v167, v176
  v_max3_f32 v209, v209, v177, v178
  v_max_f32 v209, v209, v179
  v_max3_f32 v210, v168, v169, v170
  v_max3_f32 v210, v210, v171, v180
  v_max3_f32 v210, v210, v181, v182
  v_max_f32 v210, v210, v183
  v_mov_b32 v211, v208
  v_mov_b32 v212, v209
  v_mov_b32 v213, v210
  v_permlane32_swap_b32 v208, v211
  v_permlane32_swap_b32 v209, v212
  v_permlane32_swap_b32 v210, v213
  v_max_f32 v208, v208, v211
  v_max_f32 v209, v209, v212
  v_max_f32 v210, v210, v213
  v_mov_b32 v211, v208
  v_mov_b32 v212, v209
  v_mov_b32 v213, v210
  v_permlane16_swap_b32 v208, v211
  v_permlane16_swap_b32 v209, v212
  v_permlane16_swap_b32 v210, v213
  v_max_f32 v208, v208, v211
  v_max_f32 v209, v209, v212
  v_max_f32 v210, v210, v213
  v_max_f32 v208, 0, v208
  v_max_f32 v209, 0, v209
  v_max_f32 v210, 0, v210
  v_sub_f32 v160, v160, v208
  v_sub_f32 v161, v161, v208
  v_sub_f32 v162, v162, v208
  v_sub_f32 v163, v163, v208
  v_sub_f32 v172, v172, v208
  v_sub_f32 v173, v173, v208
  v_sub_f32 v174, v174, v208
  v_sub_f32 v175, v175, v208
  v_fma_f32 v220, -v208, s43, v220
  v_fma_f32 v221, -v208, s43, v221
  v_fma_f32 v222, -v208, s43, v222
  v_fma_f32 v223, -v208, s43, v223
  v_exp_f32_e64 v214, -v208
  v_sub_f32 v164, v164, v209
  v_sub_f32 v165, v165, v209
  v_sub_f32 v166, v166, v209
  v_sub_f32 v167, v167, v209
  v_sub_f32 v176, v176, v209
  v_sub_f32 v177, v177, v209
  v_sub_f32 v178, v178, v209
  v_sub_f32 v179, v179, v209
  v_fma_f32 v224, -v209, s43, v224
  v_fma_f32 v225, -v209, s43, v225
  v_fma_f32 v226, -v209, s43, v226
  v_fma_f32 v227, -v209, s43, v227
  v_exp_f32_e64 v215, -v209
  v_sub_f32 v168, v168, v210
  v_sub_f32 v169, v169, v210
  v_sub_f32 v170, v170, v210
  v_sub_f32 v171, v171, v210
  v_sub_f32 v180, v180, v210
  v_sub_f32 v181, v181, v210
  v_sub_f32 v182, v182, v210
  v_sub_f32 v183, v183, v210
  v_fma_f32 v228, -v210, s43, v228
  v_fma_f32 v229, -v210, s43, v229
  v_fma_f32 v230, -v210, s43, v230
  v_fma_f32 v231, -v210, s43, v231
  v_exp_f32_e64 v216, -v210
  v_mul_f32 v16, v16, v214
  v_mul_f32 v17, v17, v215
  v_mul_f32 v18, v18, v216
  v_accvgpr_read_b32 v217, a0
  v_accvgpr_read_b32 v218, a1
  v_accvgpr_read_b32 v219, a2
  v_accvgpr_read_b32 v15, a3
  v_mul_f32 v217, v217, v214
  v_mul_f32 v218, v218, v214
  v_mul_f32 v219, v219, v214
  v_mul_f32 v15, v15, v214
  v_accvgpr_write_b32 a0, v217
  v_accvgpr_write_b32 a1, v218
  v_accvgpr_write_b32 a2, v219
  v_accvgpr_write_b32 a3, v15
  v_accvgpr_read_b32 v217, a4
  v_accvgpr_read_b32 v218, a5
  v_accvgpr_read_b32 v219, a6
  v_accvgpr_read_b32 v15, a7
  v_mul_f32 v217, v217, v215
  v_mul_f32 v218, v218, v215
  v_mul_f32 v219, v219, v215
  v_mul_f32 v15, v15, v215
  v_accvgpr_write_b32 a4, v217
  v_accvgpr_write_b32 a5, v218
  v_accvgpr_write_b32 a6, v219
  v_accvgpr_write_b32 a7, v15
  v_accvgpr_read_b32 v217, a8
  v_accvgpr_read_b32 v218, a9
  v_accvgpr_read_b32 v219, a10
  v_accvgpr_read_b32 v15, a11
  v_mul_f32 v217, v217, v216
  v_mul_f32 v218, v218, v216
  v_mul_f32 v219, v219, v216
  v_mul_f32 v15, v15, v216
  v_accvgpr_write_b32 a8, v217
  v_accvgpr_write_b32 a9, v218
  v_accvgpr_write_b32 a10, v219
  v_accvgpr_write_b32 a11, v15
  v_accvgpr_read_b32 v217, a12
  v_accvgpr_read_b32 v218, a13
  v_accvgpr_read_b32 v219, a14
  v_accvgpr_read_b32 v15, a15
  v_mul_f32 v217, v217, v214
  v_mul_f32 v218, v218, v214
  v_mul_f32 v219, v219, v214
  v_mul_f32 v15, v15, v214
  v_accvgpr_write_b32 a12, v217
  v_accvgpr_write_b32 a13, v218
  v_accvgpr_write_b32 a14, v219
  v_accvgpr_write_b32 a15, v15
  v_accvgpr_read_b32 v217, a16
  v_accvgpr_read_b32 v218, a17
  v_accvgpr_read_b32 v219, a18
  v_accvgpr_read_b32 v15, a19
  v_mul_f32 v217, v217, v215
  v_mul_f32 v218, v218, v215
  v_mul_f32 v219, v219, v215
  v_mul_f32 v15, v15, v215
  v_accvgpr_write_b32 a16, v217
  v_accvgpr_write_b32 a17, v218
  v_accvgpr_write_b32 a18, v219
  v_accvgpr_write_b32 a19, v15
  v_accvgpr_read_b32 v217, a20
  v_accvgpr_read_b32 v218, a21
  v_accvgpr_read_b32 v219, a22
  v_accvgpr_read_b32 v15, a23
  v_mul_f32 v217, v217, v216
  v_mul_f32 v218, v218, v216
  v_mul_f32 v219, v219, v216
  v_mul_f32 v15, v15, v216
  v_accvgpr_write_b32 a20, v217
  v_accvgpr_write_b32 a21, v218
  v_accvgpr_write_b32 a22, v219
  v_accvgpr_write_b32 a23, v15
  v_accvgpr_read_b32 v217, a24
  v_accvgpr_read_b32 v218, a25
  v_accvgpr_read_b32 v219, a26
  v_accvgpr_read_b32 v15, a27
  v_mul_f32 v217, v217, v214
  v_mul_f32 v218, v218, v214
  v_mul_f32 v219, v219, v214
  v_mul_f32 v15, v15, v214
  v_accvgpr_write_b32 a24, v217
  v_accvgpr_write_b32 a25, v218
  v_accvgpr_write_b32 a26, v219
  v_accvgpr_write_b32 a27, v15
  v_accvgpr_read_b32 v217, a28
  v_accvgpr_read_b32 v218, a29
  v_accvgpr_read_b32 v219, a30
  v_accvgpr_read_b32 v15, a31
  v_mul_f32 v217, v217, v215
  v_mul_f32 v218, v218, v215
  v_mul_f32 v219, v219, v215
  v_mul_f32 v15, v15, v215
  v_accvgpr_write_b32 a28, v217
  v_accvgpr_write_b32 a29, v218
  v_accvgpr_write_b32 a30, v219
  v_accvgpr_write_b32 a31, v15
  v_accvgpr_read_b32 v217, a32
  v_accvgpr_read_b32 v218, a33
  v_accvgpr_read_b32 v219, a34
  v_accvgpr_read_b32 v15, a35
  v_mul_f32 v217, v217, v216
  v_mul_f32 v218, v218, v216
  v_mul_f32 v219, v219, v216
  v_mul_f32 v15, v15, v216
  v_accvgpr_write_b32 a32, v217
  v_accvgpr_write_b32 a33, v218
  v_accvgpr_write_b32 a34, v219
  v_accvgpr_write_b32 a35, v15
  v_accvgpr_read_b32 v217, a36
  v_accvgpr_read_b32 v218, a37
  v_accvgpr_read_b32 v219, a38
  v_accvgpr_read_b32 v15, a39
  v_mul_f32 v217, v217, v214
  v_mul_f32 v218, v218, v214
  v_mul_f32 v219, v219, v214
  v_mul_f32 v15, v15, v214
  v_accvgpr_write_b32 a36, v217
  v_accvgpr_write_b32 a37, v218
  v_accvgpr_write_b32 a38, v219
  v_accvgpr_write_b32 a39, v15
  v_accvgpr_read_b32 v217, a40
  v_accvgpr_read_b32 v218, a41
  v_accvgpr_read_b32 v219, a42
  v_accvgpr_read_b32 v15, a43
  v_mul_f32 v217, v217, v215
  v_mul_f32 v218, v218, v215
  v_mul_f32 v219, v219, v215
  v_mul_f32 v15, v15, v215
  v_accvgpr_write_b32 a40, v217
  v_accvgpr_write_b32 a41, v218
  v_accvgpr_write_b32 a42, v219
  v_accvgpr_write_b32 a43, v15
  v_accvgpr_read_b32 v217, a44
  v_accvgpr_read_b32 v218, a45
  v_accvgpr_read_b32 v219, a46
  v_accvgpr_read_b32 v15, a47
  v_mul_f32 v217, v217, v216
  v_mul_f32 v218, v218, v216
  v_mul_f32 v219, v219, v216
  v_mul_f32 v15, v15, v216
  v_accvgpr_write_b32 a44, v217
  v_accvgpr_write_b32 a45, v218
  v_accvgpr_write_b32 a46, v219
  v_accvgpr_write_b32 a47, v15
  v_accvgpr_read_b32 v217, a48
  v_accvgpr_read_b32 v218, a49
  v_accvgpr_read_b32 v219, a50
  v_accvgpr_read_b32 v15, a51
  v_mul_f32 v217, v217, v214
  v_mul_f32 v218, v218, v214
  v_mul_f32 v219, v219, v214
  v_mul_f32 v15, v15, v214
  v_accvgpr_write_b32 a48, v217
  v_accvgpr_write_b32 a49, v218
  v_accvgpr_write_b32 a50, v219
  v_accvgpr_write_b32 a51, v15
  v_accvgpr_read_b32 v217, a52
  v_accvgpr_read_b32 v218, a53
  v_accvgpr_read_b32 v219, a54
  v_accvgpr_read_b32 v15, a55
  v_mul_f32 v217, v217, v215
  v_mul_f32 v218, v218, v215
  v_mul_f32 v219, v219, v215
  v_mul_f32 v15, v15, v215
  v_accvgpr_write_b32 a52, v217
  v_accvgpr_write_b32 a53, v218
  v_accvgpr_write_b32 a54, v219
  v_accvgpr_write_b32 a55, v15
  v_accvgpr_read_b32 v217, a56
  v_accvgpr_read_b32 v218, a57
  v_accvgpr_read_b32 v219, a58
  v_accvgpr_read_b32 v15, a59
  v_mul_f32 v217, v217, v216
  v_mul_f32 v218, v218, v216
  v_mul_f32 v219, v219, v216
  v_mul_f32 v15, v15, v216
  v_accvgpr_write_b32 a56, v217
  v_accvgpr_write_b32 a57, v218
  v_accvgpr_write_b32 a58, v219
  v_accvgpr_write_b32 a59, v15
  v_accvgpr_read_b32 v217, a60
  v_accvgpr_read_b32 v218, a61
  v_accvgpr_read_b32 v219, a62
  v_accvgpr_read_b32 v15, a63
  v_mul_f32 v217, v217, v214
  v_mul_f32 v218, v218, v214
  v_mul_f32 v219, v219, v214
  v_mul_f32 v15, v15, v214
  v_accvgpr_write_b32 a60, v217
  v_accvgpr_write_b32 a61, v218
  v_accvgpr_write_b32 a62, v219
  v_accvgpr_write_b32 a63, v15
  v_accvgpr_read_b32 v217, a64
  v_accvgpr_read_b32 v218, a65
  v_accvgpr_read_b32 v219, a66
  v_accvgpr_read_b32 v15, a67
  v_mul_f32 v217, v217, v215
  v_mul_f32 v218, v218, v215
  v_mul_f32 v219, v219, v215
  v_mul_f32 v15, v15, v215
  v_accvgpr_write_b32 a64, v217
  v_accvgpr_write_b32 a65, v218
  v_accvgpr_write_b32 a66, v219
  v_accvgpr_write_b32 a67, v15
  v_accvgpr_read_b32 v217, a68
  v_accvgpr_read_b32 v218, a69
  v_accvgpr_read_b32 v219, a70
  v_accvgpr_read_b32 v15, a71
  v_mul_f32 v217, v217, v216
  v_mul_f32 v218, v218, v216
  v_mul_f32 v219, v219, v216
  v_mul_f32 v15, v15, v216
  v_accvgpr_write_b32 a68, v217
  v_accvgpr_write_b32 a69, v218
  v_accvgpr_write_b32 a70, v219
  v_accvgpr_write_b32 a71, v15
  v_accvgpr_read_b32 v217, a72
  v_accvgpr_read_b32 v218, a73
  v_accvgpr_read_b32 v219, a74
  v_accvgpr_read_b32 v15, a75
  v_mul_f32 v217, v217, v214
  v_mul_f32 v218, v218, v214
  v_mul_f32 v219, v219, v214
  v_mul_f32 v15, v15, v214
  v_accvgpr_write_b32 a72, v217
  v_accvgpr_write_b32 a73, v218
  v_accvgpr_write_b32 a74, v219
  v_accvgpr_write_b32 a75, v15
  v_accvgpr_read_b32 v217, a76
  v_accvgpr_read_b32 v218, a77
  v_accvgpr_read_b32 v219, a78
  v_accvgpr_read_b32 v15, a79
  v_mul_f32 v217, v217, v215
  v_mul_f32 v218, v218, v215
  v_mul_f32 v219, v219, v215
  v_mul_f32 v15, v15, v215
  v_accvgpr_write_b32 a76, v217
  v_accvgpr_write_b32 a77, v218
  v_accvgpr_write_b32 a78, v219
  v_accvgpr_write_b32 a79, v15
  v_accvgpr_read_b32 v217, a80
  v_accvgpr_read_b32 v218, a81
  v_accvgpr_read_b32 v219, a82
  v_accvgpr_read_b32 v15, a83
  v_mul_f32 v217, v217, v216
  v_mul_f32 v218, v218, v216
  v_mul_f32 v219, v219, v216
  v_mul_f32 v15, v15, v216
  v_accvgpr_write_b32 a80, v217
  v_accvgpr_write_b32 a81, v218
  v_accvgpr_write_b32 a82, v219
  v_accvgpr_write_b32 a83, v15
  v_accvgpr_read_b32 v217, a84
  v_accvgpr_read_b32 v218, a85
  v_accvgpr_read_b32 v219, a86
  v_accvgpr_read_b32 v15, a87
  v_mul_f32 v217, v217, v214
  v_mul_f32 v218, v218, v214
  v_mul_f32 v219, v219, v214
  v_mul_f32 v15, v15, v214
  v_accvgpr_write_b32 a84, v217
  v_accvgpr_write_b32 a85, v218
  v_accvgpr_write_b32 a86, v219
  v_accvgpr_write_b32 a87, v15
  v_accvgpr_read_b32 v217, a88
  v_accvgpr_read_b32 v218, a89
  v_accvgpr_read_b32 v219, a90
  v_accvgpr_read_b32 v15, a91
  v_mul_f32 v217, v217, v215
  v_mul_f32 v218, v218, v215
  v_mul_f32 v219, v219, v215
  v_mul_f32 v15, v15, v215
  v_accvgpr_write_b32 a88, v217
  v_accvgpr_write_b32 a89, v218
  v_accvgpr_write_b32 a90, v219
  v_accvgpr_write_b32 a91, v15
  v_accvgpr_read_b32 v217, a92
  v_accvgpr_read_b32 v218, a93
  v_accvgpr_read_b32 v219, a94
  v_accvgpr_read_b32 v15, a95
  v_mul_f32 v217, v217, v216
  v_mul_f32 v218, v218, v216
  v_mul_f32 v219, v219, v216
  v_mul_f32 v15, v15, v216
  v_accvgpr_write_b32 a92, v217
  v_accvgpr_write_b32 a93, v218
  v_accvgpr_write_b32 a94, v219
  v_accvgpr_write_b32 a95, v15
  v_accvgpr_read_b32 v217, a96
  v_accvgpr_read_b32 v218, a97
  v_accvgpr_read_b32 v219, a98
  v_accvgpr_read_b32 v15, a99
  v_mul_f32 v217, v217, v214
  v_mul_f32 v218, v218, v214
  v_mul_f32 v219, v219, v214
  v_mul_f32 v15, v15, v214
  v_accvgpr_write_b32 a96, v217
  v_accvgpr_write_b32 a97, v218
  v_accvgpr_write_b32 a98, v219
  v_accvgpr_write_b32 a99, v15
  v_accvgpr_read_b32 v217, a100
  v_accvgpr_read_b32 v218, a101
  v_accvgpr_read_b32 v219, a102
  v_accvgpr_read_b32 v15, a103
  v_mul_f32 v217, v217, v215
  v_mul_f32 v218, v218, v215
  v_mul_f32 v219, v219, v215
  v_mul_f32 v15, v15, v215
  v_accvgpr_write_b32 a100, v217
  v_accvgpr_write_b32 a101, v218
  v_accvgpr_write_b32 a102, v219
  v_accvgpr_write_b32 a103, v15
  v_accvgpr_read_b32 v217, a104
  v_accvgpr_read_b32 v218, a105
  v_accvgpr_read_b32 v219, a106
  v_accvgpr_read_b32 v15, a107
  v_mul_f32 v217, v217, v216
  v_mul_f32 v218, v218, v216
  v_mul_f32 v219, v219, v216
  v_mul_f32 v15, v15, v216
  v_accvgpr_write_b32 a104, v217
  v_accvgpr_write_b32 a105, v218
  v_accvgpr_write_b32 a106, v219
  v_accvgpr_write_b32 a107, v15
  v_accvgpr_read_b32 v217, a108
  v_accvgpr_read_b32 v218, a109
  v_accvgpr_read_b32 v219, a110
  v_accvgpr_read_b32 v15, a111
  v_mul_f32 v217, v217, v214
  v_mul_f32 v218, v218, v214
  v_mul_f32 v219, v219, v214
  v_mul_f32 v15, v15, v214
  v_accvgpr_write_b32 a108, v217
  v_accvgpr_write_b32 a109, v218
  v_accvgpr_write_b32 a110, v219
  v_accvgpr_write_b32 a111, v15
  v_accvgpr_read_b32 v217, a112
  v_accvgpr_read_b32 v218, a113
  v_accvgpr_read_b32 v219, a114
  v_accvgpr_read_b32 v15, a115
  v_mul_f32 v217, v217, v215
  v_mul_f32 v218, v218, v215
  v_mul_f32 v219, v219, v215
  v_mul_f32 v15, v15, v215
  v_accvgpr_write_b32 a112, v217
  v_accvgpr_write_b32 a113, v218
  v_accvgpr_write_b32 a114, v219
  v_accvgpr_write_b32 a115, v15
  v_accvgpr_read_b32 v217, a116
  v_accvgpr_read_b32 v218, a117
  v_accvgpr_read_b32 v219, a118
  v_accvgpr_read_b32 v15, a119
  v_mul_f32 v217, v217, v216
  v_mul_f32 v218, v218, v216
  v_mul_f32 v219, v219, v216
  v_mul_f32 v15, v15, v216
  v_accvgpr_write_b32 a116, v217
  v_accvgpr_write_b32 a117, v218
  v_accvgpr_write_b32 a118, v219
  v_accvgpr_write_b32 a119, v15
  v_accvgpr_read_b32 v217, a120
  v_accvgpr_read_b32 v218, a121
  v_accvgpr_read_b32 v219, a122
  v_accvgpr_read_b32 v15, a123
  v_mul_f32 v217, v217, v214
  v_mul_f32 v218, v218, v214
  v_mul_f32 v219, v219, v214
  v_mul_f32 v15, v15, v214
  v_accvgpr_write_b32 a120, v217
  v_accvgpr_write_b32 a121, v218
  v_accvgpr_write_b32 a122, v219
  v_accvgpr_write_b32 a123, v15
  v_accvgpr_read_b32 v217, a124
  v_accvgpr_read_b32 v218, a125
  v_accvgpr_read_b32 v219, a126
  v_accvgpr_read_b32 v15, a127
  v_mul_f32 v217, v217, v215
  v_mul_f32 v218, v218, v215
  v_mul_f32 v219, v219, v215
  v_mul_f32 v15, v15, v215
  v_accvgpr_write_b32 a124, v217
  v_accvgpr_write_b32 a125, v218
  v_accvgpr_write_b32 a126, v219
  v_accvgpr_write_b32 a127, v15
  v_accvgpr_read_b32 v217, a128
  v_accvgpr_read_b32 v218, a129
  v_accvgpr_read_b32 v219, a130
  v_accvgpr_read_b32 v15, a131
  v_mul_f32 v217, v217, v216
  v_mul_f32 v218, v218, v216
  v_mul_f32 v219, v219, v216
  v_mul_f32 v15, v15, v216
  v_accvgpr_write_b32 a128, v217
  v_accvgpr_write_b32 a129, v218
  v_accvgpr_write_b32 a130, v219
  v_accvgpr_write_b32 a131, v15
  v_accvgpr_read_b32 v217, a132
  v_accvgpr_read_b32 v218, a133
  v_accvgpr_read_b32 v219, a134
  v_accvgpr_read_b32 v15, a135
  v_mul_f32 v217, v217, v214
  v_mul_f32 v218, v218, v214
  v_mul_f32 v219, v219, v214
  v_mul_f32 v15, v15, v214
  v_accvgpr_write_b32 a132, v217
  v_accvgpr_write_b32 a133, v218
  v_accvgpr_write_b32 a134, v219
  v_accvgpr_write_b32 a135, v15
  v_accvgpr_read_b32 v217, a136
  v_accvgpr_read_b32 v218, a137
  v_accvgpr_read_b32 v219, a138
  v_accvgpr_read_b32 v15, a139
  v_mul_f32 v217, v217, v215
  v_mul_f32 v218, v218, v215
  v_mul_f32 v219, v219, v215
  v_mul_f32 v15, v15, v215
  v_accvgpr_write_b32 a136, v217
  v_accvgpr_write_b32 a137, v218
  v_accvgpr_write_b32 a138, v219
  v_accvgpr_write_b32 a139, v15
  v_accvgpr_read_b32 v217, a140
  v_accvgpr_read_b32 v218, a141
  v_accvgpr_read_b32 v219, a142
  v_accvgpr_read_b32 v15, a143
  v_mul_f32 v217, v217, v216
  v_mul_f32 v218, v218, v216
  v_mul_f32 v219, v219, v216
  v_mul_f32 v15, v15, v216
  v_accvgpr_write_b32 a140, v217
  v_accvgpr_write_b32 a141, v218
  v_accvgpr_write_b32 a142, v219
  v_accvgpr_write_b32 a143, v15
  v_accvgpr_read_b32 v217, a144
  v_accvgpr_read_b32 v218, a145
  v_accvgpr_read_b32 v219, a146
  v_accvgpr_read_b32 v15, a147
  v_mul_f32 v217, v217, v214
  v_mul_f32 v218, v218, v214
  v_mul_f32 v219, v219, v214
  v_mul_f32 v15, v15, v214
  v_accvgpr_write_b32 a144, v217
  v_accvgpr_write_b32 a145, v218
  v_accvgpr_write_b32 a146, v219
  v_accvgpr_write_b32 a147, v15
  v_accvgpr_read_b32 v217, a148
  v_accvgpr_read_b32 v218, a149
  v_accvgpr_read_b32 v219, a150
  v_accvgpr_read_b32 v15, a151
  v_mul_f32 v217, v217, v215
  v_mul_f32 v218, v218, v215
  v_mul_f32 v219, v219, v215
  v_mul_f32 v15, v15, v215
  v_accvgpr_write_b32 a148, v217
  v_accvgpr_write_b32 a149, v218
  v_accvgpr_write_b32 a150, v219
  v_accvgpr_write_b32 a151, v15
  v_accvgpr_read_b32 v217, a152
  v_accvgpr_read_b32 v218, a153
  v_accvgpr_read_b32 v219, a154
  v_accvgpr_read_b32 v15, a155
  v_mul_f32 v217, v217, v216
  v_mul_f32 v218, v218, v216
  v_mul_f32 v219, v219, v216
  v_mul_f32 v15, v15, v216
  v_accvgpr_write_b32 a152, v217
  v_accvgpr_write_b32 a153, v218
  v_accvgpr_write_b32 a154, v219
  v_accvgpr_write_b32 a155, v15
  v_accvgpr_read_b32 v217, a156
  v_accvgpr_read_b32 v218, a157
  v_accvgpr_read_b32 v219, a158
  v_accvgpr_read_b32 v15, a159
  v_mul_f32 v217, v217, v214
  v_mul_f32 v218, v218, v214
  v_mul_f32 v219, v219, v214
  v_mul_f32 v15, v15, v214
  v_accvgpr_write_b32 a156, v217
  v_accvgpr_write_b32 a157, v218
  v_accvgpr_write_b32 a158, v219
  v_accvgpr_write_b32 a159, v15
  v_accvgpr_read_b32 v217, a160
  v_accvgpr_read_b32 v218, a161
  v_accvgpr_read_b32 v219, a162
  v_accvgpr_read_b32 v15, a163
  v_mul_f32 v217, v217, v215
  v_mul_f32 v218, v218, v215
  v_mul_f32 v219, v219, v215
  v_mul_f32 v15, v15, v215
  v_accvgpr_write_b32 a160, v217
  v_accvgpr_write_b32 a161, v218
  v_accvgpr_write_b32 a162, v219
  v_accvgpr_write_b32 a163, v15
  v_accvgpr_read_b32 v217, a164
  v_accvgpr_read_b32 v218, a165
  v_accvgpr_read_b32 v219, a166
  v_accvgpr_read_b32 v15, a167
  v_mul_f32 v217, v217, v216
  v_mul_f32 v218, v218, v216
  v_mul_f32 v219, v219, v216
  v_mul_f32 v15, v15, v216
  v_accvgpr_write_b32 a164, v217
  v_accvgpr_write_b32 a165, v218
  v_accvgpr_write_b32 a166, v219
  v_accvgpr_write_b32 a167, v15
  v_accvgpr_read_b32 v217, a168
  v_accvgpr_read_b32 v218, a169
  v_accvgpr_read_b32 v219, a170
  v_accvgpr_read_b32 v15, a171
  v_mul_f32 v217, v217, v214
  v_mul_f32 v218, v218, v214
  v_mul_f32 v219, v219, v214
  v_mul_f32 v15, v15, v214
  v_accvgpr_write_b32 a168, v217
  v_accvgpr_write_b32 a169, v218
  v_accvgpr_write_b32 a170, v219
  v_accvgpr_write_b32 a171, v15
  v_accvgpr_read_b32 v217, a172
  v_accvgpr_read_b32 v218, a173
  v_accvgpr_read_b32 v219, a174
  v_accvgpr_read_b32 v15, a175
  v_mul_f32 v217, v217, v215
  v_mul_f32 v218, v218, v215
  v_mul_f32 v219, v219, v215
  v_mul_f32 v15, v15, v215
  v_accvgpr_write_b32 a172, v217
  v_accvgpr_write_b32 a173, v218
  v_accvgpr_write_b32 a174, v219
  v_accvgpr_write_b32 a175, v15
  v_accvgpr_read_b32 v217, a176
  v_accvgpr_read_b32 v218, a177
  v_accvgpr_read_b32 v219, a178
  v_accvgpr_read_b32 v15, a179
  v_mul_f32 v217, v217, v216
  v_mul_f32 v218, v218, v216
  v_mul_f32 v219, v219, v216
  v_mul_f32 v15, v15, v216
  v_accvgpr_write_b32 a176, v217
  v_accvgpr_write_b32 a177, v218
  v_accvgpr_write_b32 a178, v219
  v_accvgpr_write_b32 a179, v15
  v_accvgpr_read_b32 v217, a180
  v_accvgpr_read_b32 v218, a181
  v_accvgpr_read_b32 v219, a182
  v_accvgpr_read_b32 v15, a183
  v_mul_f32 v217, v217, v214
  v_mul_f32 v218, v218, v214
  v_mul_f32 v219, v219, v214
  v_mul_f32 v15, v15, v214
  v_accvgpr_write_b32 a180, v217
  v_accvgpr_write_b32 a181, v218
  v_accvgpr_write_b32 a182, v219
  v_accvgpr_write_b32 a183, v15
  v_accvgpr_read_b32 v217, a184
  v_accvgpr_read_b32 v218, a185
  v_accvgpr_read_b32 v219, a186
  v_accvgpr_read_b32 v15, a187
  v_mul_f32 v217, v217, v215
  v_mul_f32 v218, v218, v215
  v_mul_f32 v219, v219, v215
  v_mul_f32 v15, v15, v215
  v_accvgpr_write_b32 a184, v217
  v_accvgpr_write_b32 a185, v218
  v_accvgpr_write_b32 a186, v219
  v_accvgpr_write_b32 a187, v15
  v_accvgpr_read_b32 v217, a188
  v_accvgpr_read_b32 v218, a189
  v_accvgpr_read_b32 v219, a190
  v_accvgpr_read_b32 v15, a191
  v_mul_f32 v217, v217, v216
  v_mul_f32 v218, v218, v216
  v_mul_f32 v219, v219, v216
  v_mul_f32 v15, v15, v216
  v_accvgpr_write_b32 a188, v217
  v_accvgpr_write_b32 a189, v218
  v_accvgpr_write_b32 a190, v219
  v_accvgpr_write_b32 a191, v15
  s_nop 3
  s_branch L_k1_ret0
L_k1_rare1:
  s_nop 7
  s_nop 3
  v_max3_f32 v208, v184, v185, v186
  v_max3_f32 v208, v208, v187, v196
  v_max3_f32 v208, v208, v197, v198
  v_max_f32 v208, v208, v199
  v_max3_f32 v209, v188, v189, v190
  v_max3_f32 v209, v209, v191, v200
  v_max3_f32 v209, v209, v201, v202
  v_max_f32 v209, v209, v203
  v_max3_f32 v210, v192, v193, v194
  v_max3_f32 v210, v210, v195, v204
  v_max3_f32 v210, v210, v205, v206
  v_max_f32 v210, v210, v207
  v_mov_b32 v211, v208
  v_mov_b32 v212, v209
  v_mov_b32 v213, v210
  v_permlane32_swap_b32 v208, v211
  v_permlane32_swap_b32 v209, v212
  v_permlane32_swap_b32 v210, v213
  v_max_f32 v208, v208, v211
  v_max_f32 v209, v209, v212
  v_max_f32 v210, v210, v213
  v_mov_b32 v211, v208
  v_mov_b32 v212, v209
  v_mov_b32 v213, v210
  v_permlane16_swap_b32 v208, v211
  v_permlane16_swap_b32 v209, v212
  v_permlane16_swap_b32 v210, v213
  v_max_f32 v208, v208, v211
  v_max_f32 v209, v209, v212
  v_max_f32 v210, v210, v213
  v_max_f32 v208, 0, v208
  v_max_f32 v209, 0, v209
  v_max_f32 v210, 0, v210
  v_sub_f32 v184, v184, v208
  v_sub_f32 v185, v185, v208
  v_sub_f32 v186, v186, v208
  v_sub_f32 v187, v187, v208
  v_sub_f32 v196, v196, v208
  v_sub_f32 v197, v197, v208
  v_sub_f32 v198, v198, v208
  v_sub_f32 v199, v199, v208
  v_fma_f32 v220, -v208, s43, v220
  v_fma_f32 v221, -v208, s43, v221
  v_fma_f32 v222, -v208, s43, v222
  v_fma_f32 v223, -v208, s43, v223
  v_exp_f32_e64 v214, -v208
  v_sub_f32 v188, v188, v209
  v_sub_f32 v189, v189, v209
  v_sub_f32 v190, v190, v209
  v_sub_f32 v191, v191, v209
  v_sub_f32 v200, v200, v209
  v_sub_f32 v201, v201, v209
  v_sub_f32 v202, v202, v209
  v_sub_f32 v203, v203, v209
  v_fma_f32 v224, -v209, s43, v224
  v_fma_f32 v225, -v209, s43, v225
  v_fma_f32 v226, -v209, s43, v226
  v_fma_f32 v227, -v209, s43, v227
  v_exp_f32_e64 v215, -v209
  v_sub_f32 v192, v192, v210
  v_sub_f32 v193, v193, v210
  v_sub_f32 v194, v194, v210
  v_sub_f32 v195, v195, v210
  v_sub_f32 v204, v204, v210
  v_sub_f32 v205, v205, v210
  v_sub_f32 v206, v206, v210
  v_sub_f32 v207, v207, v210
  v_fma_f32 v228, -v210, s43, v228
  v_fma_f32 v229, -v210, s43, v229
  v_fma_f32 v230, -v210, s43, v230
  v_fma_f32 v231, -v210, s43, v231
  v_exp_f32_e64 v216, -v210
  v_mul_f32 v16, v16, v214
  v_mul_f32 v17, v17, v215
  v_mul_f32 v18, v18, v216
  v_accvgpr_read_b32 v217, a0
  v_accvgpr_read_b32 v218, a1
  v_accvgpr_read_b32 v219, a2
  v_accvgpr_read_b32 v15, a3
  v_mul_f32 v217, v217, v214
  v_mul_f32 v218, v218, v214
  v_mul_f32 v219, v219, v214
  v_mul_f32 v15, v15, v214
  v_accvgpr_write_b32 a0, v217
  v_accvgpr_write_b32 a1, v218
  v_accvgpr_write_b32 a2, v219
  v_accvgpr_write_b32 a3, v15
  v_accvgpr_read_b32 v217, a4
  v_accvgpr_read_b32 v218, a5
  v_accvgpr_read_b32 v219, a6
  v_accvgpr_read_b32 v15, a7
  v_mul_f32 v217, v217, v215
  v_mul_f32 v218, v218, v215
  v_mul_f32 v219, v219, v215
  v_mul_f32 v15, v15, v215
  v_accvgpr_write_b32 a4, v217
  v_accvgpr_write_b32 a5, v218
  v_accvgpr_write_b32 a6, v219
  v_accvgpr_write_b32 a7, v15
  v_accvgpr_read_b32 v217, a8
  v_accvgpr_read_b32 v218, a9
  v_accvgpr_read_b32 v219, a10
  v_accvgpr_read_b32 v15, a11
  v_mul_f32 v217, v217, v216
  v_mul_f32 v218, v218, v216
  v_mul_f32 v219, v219, v216
  v_mul_f32 v15, v15, v216
  v_accvgpr_write_b32 a8, v217
  v_accvgpr_write_b32 a9, v218
  v_accvgpr_write_b32 a10, v219
  v_accvgpr_write_b32 a11, v15
  v_accvgpr_read_b32 v217, a12
  v_accvgpr_read_b32 v218, a13
  v_accvgpr_read_b32 v219, a14
  v_accvgpr_read_b32 v15, a15
  v_mul_f32 v217, v217, v214
  v_mul_f32 v218, v218, v214
  v_mul_f32 v219, v219, v214
  v_mul_f32 v15, v15, v214
  v_accvgpr_write_b32 a12, v217
  v_accvgpr_write_b32 a13, v218
  v_accvgpr_write_b32 a14, v219
  v_accvgpr_write_b32 a15, v15
  v_accvgpr_read_b32 v217, a16
  v_accvgpr_read_b32 v218, a17
  v_accvgpr_read_b32 v219, a18
  v_accvgpr_read_b32 v15, a19
  v_mul_f32 v217, v217, v215
  v_mul_f32 v218, v218, v215
  v_mul_f32 v219, v219, v215
  v_mul_f32 v15, v15, v215
  v_accvgpr_write_b32 a16, v217
  v_accvgpr_write_b32 a17, v218
  v_accvgpr_write_b32 a18, v219
  v_accvgpr_write_b32 a19, v15
  v_accvgpr_read_b32 v217, a20
  v_accvgpr_read_b32 v218, a21
  v_accvgpr_read_b32 v219, a22
  v_accvgpr_read_b32 v15, a23
  v_mul_f32 v217, v217, v216
  v_mul_f32 v218, v218, v216
  v_mul_f32 v219, v219, v216
  v_mul_f32 v15, v15, v216
  v_accvgpr_write_b32 a20, v217
  v_accvgpr_write_b32 a21, v218
  v_accvgpr_write_b32 a22, v219
  v_accvgpr_write_b32 a23, v15
  v_accvgpr_read_b32 v217, a24
  v_accvgpr_read_b32 v218, a25
  v_accvgpr_read_b32 v219, a26
  v_accvgpr_read_b32 v15, a27
  v_mul_f32 v217, v217, v214
  v_mul_f32 v218, v218, v214
  v_mul_f32 v219, v219, v214
  v_mul_f32 v15, v15, v214
  v_accvgpr_write_b32 a24, v217
  v_accvgpr_write_b32 a25, v218
  v_accvgpr_write_b32 a26, v219
  v_accvgpr_write_b32 a27, v15
  v_accvgpr_read_b32 v217, a28
  v_accvgpr_read_b32 v218, a29
  v_accvgpr_read_b32 v219, a30
  v_accvgpr_read_b32 v15, a31
  v_mul_f32 v217, v217, v215
  v_mul_f32 v218, v218, v215
  v_mul_f32 v219, v219, v215
  v_mul_f32 v15, v15, v215
  v_accvgpr_write_b32 a28, v217
  v_accvgpr_write_b32 a29, v218
  v_accvgpr_write_b32 a30, v219
  v_accvgpr_write_b32 a31, v15
  v_accvgpr_read_b32 v217, a32
  v_accvgpr_read_b32 v218, a33
  v_accvgpr_read_b32 v219, a34
  v_accvgpr_read_b32 v15, a35
  v_mul_f32 v217, v217, v216
  v_mul_f32 v218, v218, v216
  v_mul_f32 v219, v219, v216
  v_mul_f32 v15, v15, v216
  v_accvgpr_write_b32 a32, v217
  v_accvgpr_write_b32 a33, v218
  v_accvgpr_write_b32 a34, v219
  v_accvgpr_write_b32 a35, v15
  v_accvgpr_read_b32 v217, a36
  v_accvgpr_read_b32 v218, a37
  v_accvgpr_read_b32 v219, a38
  v_accvgpr_read_b32 v15, a39
  v_mul_f32 v217, v217, v214
  v_mul_f32 v218, v218, v214
  v_mul_f32 v219, v219, v214
  v_mul_f32 v15, v15, v214
  v_accvgpr_write_b32 a36, v217
  v_accvgpr_write_b32 a37, v218
  v_accvgpr_write_b32 a38, v219
  v_accvgpr_write_b32 a39, v15
  v_accvgpr_read_b32 v217, a40
  v_accvgpr_read_b32 v218, a41
  v_accvgpr_read_b32 v219, a42
  v_accvgpr_read_b32 v15, a43
  v_mul_f32 v217, v217, v215
  v_mul_f32 v218, v218, v215
  v_mul_f32 v219, v219, v215
  v_mul_f32 v15, v15, v215
  v_accvgpr_write_b32 a40, v217
  v_accvgpr_write_b32 a41, v218
  v_accvgpr_write_b32 a42, v219
  v_accvgpr_write_b32 a43, v15
  v_accvgpr_read_b32 v217, a44
  v_accvgpr_read_b32 v218, a45
  v_accvgpr_read_b32 v219, a46
  v_accvgpr_read_b32 v15, a47
  v_mul_f32 v217, v217, v216
  v_mul_f32 v218, v218, v216
  v_mul_f32 v219, v219, v216
  v_mul_f32 v15, v15, v216
  v_accvgpr_write_b32 a44, v217
  v_accvgpr_write_b32 a45, v218
  v_accvgpr_write_b32 a46, v219
  v_accvgpr_write_b32 a47, v15
  v_accvgpr_read_b32 v217, a48
  v_accvgpr_read_b32 v218, a49
  v_accvgpr_read_b32 v219, a50
  v_accvgpr_read_b32 v15, a51
  v_mul_f32 v217, v217, v214
  v_mul_f32 v218, v218, v214
  v_mul_f32 v219, v219, v214
  v_mul_f32 v15, v15, v214
  v_accvgpr_write_b32 a48, v217
  v_accvgpr_write_b32 a49, v218
  v_accvgpr_write_b32 a50, v219
  v_accvgpr_write_b32 a51, v15
  v_accvgpr_read_b32 v217, a52
  v_accvgpr_read_b32 v218, a53
  v_accvgpr_read_b32 v219, a54
  v_accvgpr_read_b32 v15, a55
  v_mul_f32 v217, v217, v215
  v_mul_f32 v218, v218, v215
  v_mul_f32 v219, v219, v215
  v_mul_f32 v15, v15, v215
  v_accvgpr_write_b32 a52, v217
  v_accvgpr_write_b32 a53, v218
  v_accvgpr_write_b32 a54, v219
  v_accvgpr_write_b32 a55, v15
  v_accvgpr_read_b32 v217, a56
  v_accvgpr_read_b32 v218, a57
  v_accvgpr_read_b32 v219, a58
  v_accvgpr_read_b32 v15, a59
  v_mul_f32 v217, v217, v216
  v_mul_f32 v218, v218, v216
  v_mul_f32 v219, v219, v216
  v_mul_f32 v15, v15, v216
  v_accvgpr_write_b32 a56, v217
  v_accvgpr_write_b32 a57, v218
  v_accvgpr_write_b32 a58, v219
  v_accvgpr_write_b32 a59, v15
  v_accvgpr_read_b32 v217, a60
  v_accvgpr_read_b32 v218, a61
  v_accvgpr_read_b32 v219, a62
  v_accvgpr_read_b32 v15, a63
  v_mul_f32 v217, v217, v214
  v_mul_f32 v218, v218, v214
  v_mul_f32 v219, v219, v214
  v_mul_f32 v15, v15, v214
  v_accvgpr_write_b32 a60, v217
  v_accvgpr_write_b32 a61, v218
  v_accvgpr_write_b32 a62, v219
  v_accvgpr_write_b32 a63, v15
  v_accvgpr_read_b32 v217, a64
  v_accvgpr_read_b32 v218, a65
  v_accvgpr_read_b32 v219, a66
  v_accvgpr_read_b32 v15, a67
  v_mul_f32 v217, v217, v215
  v_mul_f32 v218, v218, v215
  v_mul_f32 v219, v219, v215
  v_mul_f32 v15, v15, v215
  v_accvgpr_write_b32 a64, v217
  v_accvgpr_write_b32 a65, v218
  v_accvgpr_write_b32 a66, v219
  v_accvgpr_write_b32 a67, v15
  v_accvgpr_read_b32 v217, a68
  v_accvgpr_read_b32 v218, a69
  v_accvgpr_read_b32 v219, a70
  v_accvgpr_read_b32 v15, a71
  v_mul_f32 v217, v217, v216
  v_mul_f32 v218, v218, v216
  v_mul_f32 v219, v219, v216
  v_mul_f32 v15, v15, v216
  v_accvgpr_write_b32 a68, v217
  v_accvgpr_write_b32 a69, v218
  v_accvgpr_write_b32 a70, v219
  v_accvgpr_write_b32 a71, v15
  v_accvgpr_read_b32 v217, a72
  v_accvgpr_read_b32 v218, a73
  v_accvgpr_read_b32 v219, a74
  v_accvgpr_read_b32 v15, a75
  v_mul_f32 v217, v217, v214
  v_mul_f32 v218, v218, v214
  v_mul_f32 v219, v219, v214
  v_mul_f32 v15, v15, v214
  v_accvgpr_write_b32 a72, v217
  v_accvgpr_write_b32 a73, v218
  v_accvgpr_write_b32 a74, v219
  v_accvgpr_write_b32 a75, v15
  v_accvgpr_read_b32 v217, a76
  v_accvgpr_read_b32 v218, a77
  v_accvgpr_read_b32 v219, a78
  v_accvgpr_read_b32 v15, a79
  v_mul_f32 v217, v217, v215
  v_mul_f32 v218, v218, v215
  v_mul_f32 v219, v219, v215
  v_mul_f32 v15, v15, v215
  v_accvgpr_write_b32 a76, v217
  v_accvgpr_write_b32 a77, v218
  v_accvgpr_write_b32 a78, v219
  v_accvgpr_write_b32 a79, v15
  v_accvgpr_read_b32 v217, a80
  v_accvgpr_read_b32 v218, a81
  v_accvgpr_read_b32 v219, a82
  v_accvgpr_read_b32 v15, a83
  v_mul_f32 v217, v217, v216
  v_mul_f32 v218, v218, v216
  v_mul_f32 v219, v219, v216
  v_mul_f32 v15, v15, v216
  v_accvgpr_write_b32 a80, v217
  v_accvgpr_write_b32 a81, v218
  v_accvgpr_write_b32 a82, v219
  v_accvgpr_write_b32 a83, v15
  v_accvgpr_read_b32 v217, a84
  v_accvgpr_read_b32 v218, a85
  v_accvgpr_read_b32 v219, a86
  v_accvgpr_read_b32 v15, a87
  v_mul_f32 v217, v217, v214
  v_mul_f32 v218, v218, v214
  v_mul_f32 v219, v219, v214
  v_mul_f32 v15, v15, v214
  v_accvgpr_write_b32 a84, v217
  v_accvgpr_write_b32 a85, v218
  v_accvgpr_write_b32 a86, v219
  v_accvgpr_write_b32 a87, v15
  v_accvgpr_read_b32 v217, a88
  v_accvgpr_read_b32 v218, a89
  v_accvgpr_read_b32 v219, a90
  v_accvgpr_read_b32 v15, a91
  v_mul_f32 v217, v217, v215
  v_mul_f32 v218, v218, v215
  v_mul_f32 v219, v219, v215
  v_mul_f32 v15, v15, v215
  v_accvgpr_write_b32 a88, v217
  v_accvgpr_write_b32 a89, v218
  v_accvgpr_write_b32 a90, v219
  v_accvgpr_write_b32 a91, v15
  v_accvgpr_read_b32 v217, a92
  v_accvgpr_read_b32 v218, a93
  v_accvgpr_read_b32 v219, a94
  v_accvgpr_read_b32 v15, a95
  v_mul_f32 v217, v217, v216
  v_mul_f32 v218, v218, v216
  v_mul_f32 v219, v219, v216
  v_mul_f32 v15, v15, v216
  v_accvgpr_write_b32 a92, v217
  v_accvgpr_write_b32 a93, v218
  v_accvgpr_write_b32 a94, v219
  v_accvgpr_write_b32 a95, v15
  v_accvgpr_read_b32 v217, a96
  v_accvgpr_read_b32 v218, a97
  v_accvgpr_read_b32 v219, a98
  v_accvgpr_read_b32 v15, a99
  v_mul_f32 v217, v217, v214
  v_mul_f32 v218, v218, v214
  v_mul_f32 v219, v219, v214
  v_mul_f32 v15, v15, v214
  v_accvgpr_write_b32 a96, v217
  v_accvgpr_write_b32 a97, v218
  v_accvgpr_write_b32 a98, v219
  v_accvgpr_write_b32 a99, v15
  v_accvgpr_read_b32 v217, a100
  v_accvgpr_read_b32 v218, a101
  v_accvgpr_read_b32 v219, a102
  v_accvgpr_read_b32 v15, a103
  v_mul_f32 v217, v217, v215
  v_mul_f32 v218, v218, v215
  v_mul_f32 v219, v219, v215
  v_mul_f32 v15, v15, v215
  v_accvgpr_write_b32 a100, v217
  v_accvgpr_write_b32 a101, v218
  v_accvgpr_write_b32 a102, v219
  v_accvgpr_write_b32 a103, v15
  v_accvgpr_read_b32 v217, a104
  v_accvgpr_read_b32 v218, a105
  v_accvgpr_read_b32 v219, a106
  v_accvgpr_read_b32 v15, a107
  v_mul_f32 v217, v217, v216
  v_mul_f32 v218, v218, v216
  v_mul_f32 v219, v219, v216
  v_mul_f32 v15, v15, v216
  v_accvgpr_write_b32 a104, v217
  v_accvgpr_write_b32 a105, v218
  v_accvgpr_write_b32 a106, v219
  v_accvgpr_write_b32 a107, v15
  v_accvgpr_read_b32 v217, a108
  v_accvgpr_read_b32 v218, a109
  v_accvgpr_read_b32 v219, a110
  v_accvgpr_read_b32 v15, a111
  v_mul_f32 v217, v217, v214
  v_mul_f32 v218, v218, v214
  v_mul_f32 v219, v219, v214
  v_mul_f32 v15, v15, v214
  v_accvgpr_write_b32 a108, v217
  v_accvgpr_write_b32 a109, v218
  v_accvgpr_write_b32 a110, v219
  v_accvgpr_write_b32 a111, v15
  v_accvgpr_read_b32 v217, a112
  v_accvgpr_read_b32 v218, a113
  v_accvgpr_read_b32 v219, a114
  v_accvgpr_read_b32 v15, a115
  v_mul_f32 v217, v217, v215
  v_mul_f32 v218, v218, v215
  v_mul_f32 v219, v219, v215
  v_mul_f32 v15, v15, v215
  v_accvgpr_write_b32 a112, v217
  v_accvgpr_write_b32 a113, v218
  v_accvgpr_write_b32 a114, v219
  v_accvgpr_write_b32 a115, v15
  v_accvgpr_read_b32 v217, a116
  v_accvgpr_read_b32 v218, a117
  v_accvgpr_read_b32 v219, a118
  v_accvgpr_read_b32 v15, a119
  v_mul_f32 v217, v217, v216
  v_mul_f32 v218, v218, v216
  v_mul_f32 v219, v219, v216
  v_mul_f32 v15, v15, v216
  v_accvgpr_write_b32 a116, v217
  v_accvgpr_write_b32 a117, v218
  v_accvgpr_write_b32 a118, v219
  v_accvgpr_write_b32 a119, v15
  v_accvgpr_read_b32 v217, a120
  v_accvgpr_read_b32 v218, a121
  v_accvgpr_read_b32 v219, a122
  v_accvgpr_read_b32 v15, a123
  v_mul_f32 v217, v217, v214
  v_mul_f32 v218, v218, v214
  v_mul_f32 v219, v219, v214
  v_mul_f32 v15, v15, v214
  v_accvgpr_write_b32 a120, v217
  v_accvgpr_write_b32 a121, v218
  v_accvgpr_write_b32 a122, v219
  v_accvgpr_write_b32 a123, v15
  v_accvgpr_read_b32 v217, a124
  v_accvgpr_read_b32 v218, a125
  v_accvgpr_read_b32 v219, a126
  v_accvgpr_read_b32 v15, a127
  v_mul_f32 v217, v217, v215
  v_mul_f32 v218, v218, v215
  v_mul_f32 v219, v219, v215
  v_mul_f32 v15, v15, v215
  v_accvgpr_write_b32 a124, v217
  v_accvgpr_write_b32 a125, v218
  v_accvgpr_write_b32 a126, v219
  v_accvgpr_write_b32 a127, v15
  v_accvgpr_read_b32 v217, a128
  v_accvgpr_read_b32 v218, a129
  v_accvgpr_read_b32 v219, a130
  v_accvgpr_read_b32 v15, a131
  v_mul_f32 v217, v217, v216
  v_mul_f32 v218, v218, v216
  v_mul_f32 v219, v219, v216
  v_mul_f32 v15, v15, v216
  v_accvgpr_write_b32 a128, v217
  v_accvgpr_write_b32 a129, v218
  v_accvgpr_write_b32 a130, v219
  v_accvgpr_write_b32 a131, v15
  v_accvgpr_read_b32 v217, a132
  v_accvgpr_read_b32 v218, a133
  v_accvgpr_read_b32 v219, a134
  v_accvgpr_read_b32 v15, a135
  v_mul_f32 v217, v217, v214
  v_mul_f32 v218, v218, v214
  v_mul_f32 v219, v219, v214
  v_mul_f32 v15, v15, v214
  v_accvgpr_write_b32 a132, v217
  v_accvgpr_write_b32 a133, v218
  v_accvgpr_write_b32 a134, v219
  v_accvgpr_write_b32 a135, v15
  v_accvgpr_read_b32 v217, a136
  v_accvgpr_read_b32 v218, a137
  v_accvgpr_read_b32 v219, a138
  v_accvgpr_read_b32 v15, a139
  v_mul_f32 v217, v217, v215
  v_mul_f32 v218, v218, v215
  v_mul_f32 v219, v219, v215
  v_mul_f32 v15, v15, v215
  v_accvgpr_write_b32 a136, v217
  v_accvgpr_write_b32 a137, v218
  v_accvgpr_write_b32 a138, v219
  v_accvgpr_write_b32 a139, v15
  v_accvgpr_read_b32 v217, a140
  v_accvgpr_read_b32 v218, a141
  v_accvgpr_read_b32 v219, a142
  v_accvgpr_read_b32 v15, a143
  v_mul_f32 v217, v217, v216
  v_mul_f32 v218, v218, v216
  v_mul_f32 v219, v219, v216
  v_mul_f32 v15, v15, v216
  v_accvgpr_write_b32 a140, v217
  v_accvgpr_write_b32 a141, v218
  v_accvgpr_write_b32 a142, v219
  v_accvgpr_write_b32 a143, v15
  v_accvgpr_read_b32 v217, a144
  v_accvgpr_read_b32 v218, a145
  v_accvgpr_read_b32 v219, a146
  v_accvgpr_read_b32 v15, a147
  v_mul_f32 v217, v217, v214
  v_mul_f32 v218, v218, v214
  v_mul_f32 v219, v219, v214
  v_mul_f32 v15, v15, v214
  v_accvgpr_write_b32 a144, v217
  v_accvgpr_write_b32 a145, v218
  v_accvgpr_write_b32 a146, v219
  v_accvgpr_write_b32 a147, v15
  v_accvgpr_read_b32 v217, a148
  v_accvgpr_read_b32 v218, a149
  v_accvgpr_read_b32 v219, a150
  v_accvgpr_read_b32 v15, a151
  v_mul_f32 v217, v217, v215
  v_mul_f32 v218, v218, v215
  v_mul_f32 v219, v219, v215
  v_mul_f32 v15, v15, v215
  v_accvgpr_write_b32 a148, v217
  v_accvgpr_write_b32 a149, v218
  v_accvgpr_write_b32 a150, v219
  v_accvgpr_write_b32 a151, v15
  v_accvgpr_read_b32 v217, a152
  v_accvgpr_read_b32 v218, a153
  v_accvgpr_read_b32 v219, a154
  v_accvgpr_read_b32 v15, a155
  v_mul_f32 v217, v217, v216
  v_mul_f32 v218, v218, v216
  v_mul_f32 v219, v219, v216
  v_mul_f32 v15, v15, v216
  v_accvgpr_write_b32 a152, v217
  v_accvgpr_write_b32 a153, v218
  v_accvgpr_write_b32 a154, v219
  v_accvgpr_write_b32 a155, v15
  v_accvgpr_read_b32 v217, a156
  v_accvgpr_read_b32 v218, a157
  v_accvgpr_read_b32 v219, a158
  v_accvgpr_read_b32 v15, a159
  v_mul_f32 v217, v217, v214
  v_mul_f32 v218, v218, v214
  v_mul_f32 v219, v219, v214
  v_mul_f32 v15, v15, v214
  v_accvgpr_write_b32 a156, v217
  v_accvgpr_write_b32 a157, v218
  v_accvgpr_write_b32 a158, v219
  v_accvgpr_write_b32 a159, v15
  v_accvgpr_read_b32 v217, a160
  v_accvgpr_read_b32 v218, a161
  v_accvgpr_read_b32 v219, a162
  v_accvgpr_read_b32 v15, a163
  v_mul_f32 v217, v217, v215
  v_mul_f32 v218, v218, v215
  v_mul_f32 v219, v219, v215
  v_mul_f32 v15, v15, v215
  v_accvgpr_write_b32 a160, v217
  v_accvgpr_write_b32 a161, v218
  v_accvgpr_write_b32 a162, v219
  v_accvgpr_write_b32 a163, v15
  v_accvgpr_read_b32 v217, a164
  v_accvgpr_read_b32 v218, a165
  v_accvgpr_read_b32 v219, a166
  v_accvgpr_read_b32 v15, a167
  v_mul_f32 v217, v217, v216
  v_mul_f32 v218, v218, v216
  v_mul_f32 v219, v219, v216
  v_mul_f32 v15, v15, v216
  v_accvgpr_write_b32 a164, v217
  v_accvgpr_write_b32 a165, v218
  v_accvgpr_write_b32 a166, v219
  v_accvgpr_write_b32 a167, v15
  v_accvgpr_read_b32 v217, a168
  v_accvgpr_read_b32 v218, a169
  v_accvgpr_read_b32 v219, a170
  v_accvgpr_read_b32 v15, a171
  v_mul_f32 v217, v217, v214
  v_mul_f32 v218, v218, v214
  v_mul_f32 v219, v219, v214
  v_mul_f32 v15, v15, v214
  v_accvgpr_write_b32 a168, v217
  v_accvgpr_write_b32 a169, v218
  v_accvgpr_write_b32 a170, v219
  v_accvgpr_write_b32 a171, v15
  v_accvgpr_read_b32 v217, a172
  v_accvgpr_read_b32 v218, a173
  v_accvgpr_read_b32 v219, a174
  v_accvgpr_read_b32 v15, a175
  v_mul_f32 v217, v217, v215
  v_mul_f32 v218, v218, v215
  v_mul_f32 v219, v219, v215
  v_mul_f32 v15, v15, v215
  v_accvgpr_write_b32 a172, v217
  v_accvgpr_write_b32 a173, v218
  v_accvgpr_write_b32 a174, v219
  v_accvgpr_write_b32 a175, v15
  v_accvgpr_read_b32 v217, a176
  v_accvgpr_read_b32 v218, a177
  v_accvgpr_read_b32 v219, a178
  v_accvgpr_read_b32 v15, a179
  v_mul_f32 v217, v217, v216
  v_mul_f32 v218, v218, v216
  v_mul_f32 v219, v219, v216
  v_mul_f32 v15, v15, v216
  v_accvgpr_write_b32 a176, v217
  v_accvgpr_write_b32 a177, v218
  v_accvgpr_write_b32 a178, v219
  v_accvgpr_write_b32 a179, v15
  v_accvgpr_read_b32 v217, a180
  v_accvgpr_read_b32 v218, a181
  v_accvgpr_read_b32 v219, a182
  v_accvgpr_read_b32 v15, a183
  v_mul_f32 v217, v217, v214
  v_mul_f32 v218, v218, v214
  v_mul_f32 v219, v219, v214
  v_mul_f32 v15, v15, v214
  v_accvgpr_write_b32 a180, v217
  v_accvgpr_write_b32 a181, v218
  v_accvgpr_write_b32 a182, v219
  v_accvgpr_write_b32 a183, v15
  v_accvgpr_read_b32 v217, a184
  v_accvgpr_read_b32 v218, a185
  v_accvgpr_read_b32 v219, a186
  v_accvgpr_read_b32 v15, a187
  v_mul_f32 v217, v217, v215
  v_mul_f32 v218, v218, v215
  v_mul_f32 v219, v219, v215
  v_mul_f32 v15, v15, v215
  v_accvgpr_write_b32 a184, v217
  v_accvgpr_write_b32 a185, v218
  v_accvgpr_write_b32 a186, v219
  v_accvgpr_write_b32 a187, v15
  v_accvgpr_read_b32 v217, a188
  v_accvgpr_read_b32 v218, a189
  v_accvgpr_read_b32 v219, a190
  v_accvgpr_read_b32 v15, a191
  v_mul_f32 v217, v217, v216
  v_mul_f32 v218, v218, v216
  v_mul_f32 v219, v219, v216
  v_mul_f32 v15, v15, v216
  v_accvgpr_write_b32 a188, v217
  v_accvgpr_write_b32 a189, v218
  v_accvgpr_write_b32 a190, v219
  v_accvgpr_write_b32 a191, v15
  s_nop 3
  s_branch L_k1_ret1
L_k1_end:
  s_waitcnt vmcnt(0)
  s_endpgm
.globl reduce_kernel
.p2align 8
.type reduce_kernel,@function
reduce_kernel:
  s_cmp_ge_u32 s2, 224
  s_cbranch_scc1 L_k3_end
  s_load_dwordx2 s[12:13], s[0:1], 80
  s_load_dwordx2 s[14:15], s[0:1], 96
  s_mul_i32 s16, s2, 9363
  s_lshr_b32 s16, s16, 16
  s_mul_i32 s17, s16, 7
  s_sub_u32 s17, s2, s17
  v_lshrrev_b32 v1, 6, v0
  v_and_b32 v2, 63, v0
  v_readfirstlane_b32 s24, v1
  v_and_b32 v3, 15, v2
  v_lshrrev_b32 v4, 4, v2
  s_mul_i32 s18, s17, 6144
  s_mul_i32 s19, s24, 43008
  s_add_u32 s18, s18, s19
  v_lshlrev_b32 v8, 4, v2
  v_add_u32 v5, s18, v8
  v_add_u32 v6, 4096, v5
  s_mov_b32 s33, 172032
  s_mov_b32 s34, 344064
  s_mov_b32 s35, 516096
  s_mov_b32 s36, 688128
  s_mov_b32 s37, 860160
  s_mov_b32 s38, 1032192
  s_mov_b32 s39, 1204224
  s_waitcnt lgkmcnt(0)
  s_mul_i32 s20, s16, 1376256
  s_add_u32 s4, s14, s20
  s_addc_u32 s5, s15, 0
  s_and_b32 s5, s5, 0xffff
  s_mov_b32 s6, 1376256
  s_mov_b32 s7, 0x20000
  s_mov_b32 s8, s12
  s_and_b32 s9, s13, 0xffff
  s_mov_b32 s10, 5505024
  s_mov_b32 s11, 0x20000
  buffer_load_dwordx4 v[16:19], v5, s[4:7], 0 offen offset:0
  buffer_load_dwordx4 v[20:23], v5, s[4:7], s33 offen offset:0
  buffer_load_dwordx4 v[24:27], v5, s[4:7], s34 offen offset:0
  buffer_load_dwordx4 v[28:31], v5, s[4:7], s35 offen offset:0
  buffer_load_dwordx4 v[32:35], v5, s[4:7], s36 offen offset:0
  buffer_load_dwordx4 v[36:39], v5, s[4:7], s37 offen offset:0
  buffer_load_dwordx4 v[40:43], v5, s[4:7], s38 offen offset:0
  buffer_load_dwordx4 v[44:47], v5, s[4:7], s39 offen offset:0
  buffer_load_dwordx4 v[48:51], v5, s[4:7], 0 offen offset:1024
  buffer_load_dwordx4 v[52:55], v5, s[4:7], s33 offen offset:1024
  buffer_load_dwordx4 v[56:59], v5, s[4:7], s34 offen offset:1024
  buffer_load_dwordx4 v[60:63], v5, s[4:7], s35 offen offset:1024
  buffer_load_dwordx4 v[64:67], v5, s[4:7], s36 offen offset:1024
  buffer_load_dwordx4 v[68:71], v5, s[4:7], s37 offen offset:1024
  buffer_load_dwordx4 v[72:75], v5, s[4:7], s38 offen offset:1024
  buffer_load_dwordx4 v[76:79], v5, s[4:7], s39 offen offset:1024
  s_and_b32 s21, s16, 15
  s_lshr_b32 s22, s16, 4
  s_mul_i32 s21, s21, 192
  s_mul_i32 s23, s24, 48
  s_add_u32 s21, s21, s23
  v_add_u32 v8, s21, v3
  s_movk_i32 s25, 1792
  v_mul_lo_u32 v8, v8, s25
  s_mul_i32 s22, s22, 896
  s_lshl_b32 s23, s17, 7
  s_add_u32 s22, s22, s23
  v_add_u32 v8, s22, v8
  v_lshl_add_u32 v7, v4, 4, v8
  s_mov_b32 s26, 0xffff0000
  buffer_load_dwordx4 v[80:83], v5, s[4:7], 0 offen offset:2048
  buffer_load_dwordx4 v[84:87], v5, s[4:7], s33 offen offset:2048
  buffer_load_dwordx4 v[88:91], v5, s[4:7], s34 offen offset:2048
  buffer_load_dwordx4 v[92:95], v5, s[4:7], s35 offen offset:2048
  buffer_load_dwordx4 v[96:99], v5, s[4:7], s36 offen offset:2048
  buffer_load_dwordx4 v[100:103], v5, s[4:7], s37 offen offset:2048
  buffer_load_dwordx4 v[104:107], v5, s[4:7], s38 offen offset:2048
  buffer_load_dwordx4 v[108:111], v5, s[4:7], s39 offen offset:2048
  s_waitcnt vmcnt(23)
  v_lshlrev_b32 v208, 16, v16
  v_and_b32 v209, s26, v16
  v_lshlrev_b32 v210, 16, v17
  v_and_b32 v211, s26, v17
  v_lshlrev_b32 v212, 16, v18
  v_and_b32 v213, s26, v18
  v_lshlrev_b32 v214, 16, v19
  v_and_b32 v215, s26, v19
  s_waitcnt vmcnt(22)
  v_lshlrev_b32 v216, 16, v20
  v_and_b32 v217, s26, v20
  v_lshlrev_b32 v218, 16, v21
  v_and_b32 v219, s26, v21
  v_lshlrev_b32 v220, 16, v22
  v_and_b32 v221, s26, v22
  v_lshlrev_b32 v222, 16, v23
  v_and_b32 v223, s26, v23
  v_add_f32 v208, v208, v216
  v_add_f32 v209, v209, v217
  v_add_f32 v210, v210, v218
  v_add_f32 v211, v211, v219
  v_add_f32 v212, v212, v220
  v_add_f32 v213, v213, v221
  v_add_f32 v214, v214, v222
  v_add_f32 v215, v215, v223
  s_waitcnt vmcnt(21)
  v_lshlrev_b32 v216, 16, v24
  v_and_b32 v217, s26, v24
  v_lshlrev_b32 v218, 16, v25
  v_and_b32 v219, s26, v25
  v_lshlrev_b32 v220, 16, v26
  v_and_b32 v221, s26, v26
  v_lshlrev_b32 v222, 16, v27
  v_and_b32 v223, s26, v27
  v_add_f32 v208, v208, v216
  v_add_f32 v209, v209, v217
  v_add_f32 v210, v210, v218
  v_add_f32 v211, v211, v219
  v_add_f32 v212, v212, v220
  v_add_f32 v213, v213, v221
  v_add_f32 v214, v214, v222
  v_add_f32 v215, v215, v223
  s_waitcnt vmcnt(20)
  v_lshlrev_b32 v216, 16, v28
  v_and_b32 v217, s26, v28
  v_lshlrev_b32 v218, 16, v29
  v_and_b32 v219, s26, v29
  v_lshlrev_b32 v220, 16, v30
  v_and_b32 v221, s26, v30
  v_lshlrev_b32 v222, 16, v31
  v_and_b32 v223, s26, v31
  v_add_f32 v208, v208, v216
  v_add_f32 v209, v209, v217
  v_add_f32 v210, v210, v218
  v_add_f32 v211, v211, v219
  v_add_f32 v212, v212, v220
  v_add_f32 v213, v213, v221
  v_add_f32 v214, v214, v222
  v_add_f32 v215, v215, v223
  s_waitcnt vmcnt(19)
  v_lshlrev_b32 v216, 16, v32
  v_and_b32 v217, s26, v32
  v_lshlrev_b32 v218, 16, v33
  v_and_b32 v219, s26, v33
  v_lshlrev_b32 v220, 16, v34
  v_and_b32 v221, s26, v34
  v_lshlrev_b32 v222, 16, v35
  v_and_b32 v223, s26, v35
  v_add_f32 v208, v208, v216
  v_add_f32 v209, v209, v217
  v_add_f32 v210, v210, v218
  v_add_f32 v211, v211, v219
  v_add_f32 v212, v212, v220
  v_add_f32 v213, v213, v221
  v_add_f32 v214, v214, v222
  v_add_f32 v215, v215, v223
  s_waitcnt vmcnt(18)
  v_lshlrev_b32 v216, 16, v36
  v_and_b32 v217, s26, v36
  v_lshlrev_b32 v218, 16, v37
  v_and_b32 v219, s26, v37
  v_lshlrev_b32 v220, 16, v38
  v_and_b32 v221, s26, v38
  v_lshlrev_b32 v222, 16, v39
  v_and_b32 v223, s26, v39
  v_add_f32 v208, v208, v216
  v_add_f32 v209, v209, v217
  v_add_f32 v210, v210, v218
  v_add_f32 v211, v211, v219
  v_add_f32 v212, v212, v220
  v_add_f32 v213, v213, v221
  v_add_f32 v214, v214, v222
  v_add_f32 v215, v215, v223
  s_waitcnt vmcnt(17)
  v_lshlrev_b32 v216, 16, v40
  v_and_b32 v217, s26, v40
  v_lshlrev_b32 v218, 16, v41
  v_and_b32 v219, s26, v41
  v_lshlrev_b32 v220, 16, v42
  v_and_b32 v221, s26, v42
  v_lshlrev_b32 v222, 16, v43
  v_and_b32 v223, s26, v43
  v_add_f32 v208, v208, v216
  v_add_f32 v209, v209, v217
  v_add_f32 v210, v210, v218
  v_add_f32 v211, v211, v219
  v_add_f32 v212, v212, v220
  v_add_f32 v213, v213, v221
  v_add_f32 v214, v214, v222
  v_add_f32 v215, v215, v223
  s_waitcnt vmcnt(16)
  v_lshlrev_b32 v216, 16, v44
  v_and_b32 v217, s26, v44
  v_lshlrev_b32 v218, 16, v45
  v_and_b32 v219, s26, v45
  v_lshlrev_b32 v220, 16, v46
  v_and_b32 v221, s26, v46
  v_lshlrev_b32 v222, 16, v47
  v_and_b32 v223, s26, v47
  v_add_f32 v208, v208, v216
  v_add_f32 v209, v209, v217
  v_add_f32 v210, v210, v218
  v_add_f32 v211, v211, v219
  v_add_f32 v212, v212, v220
  v_add_f32 v213, v213, v221
  v_add_f32 v214, v214, v222
  v_add_f32 v215, v215, v223
  v_cvt_pk_bf16_f32 v224, v208, v209
  v_cvt_pk_bf16_f32 v225, v210, v211
  v_cvt_pk_bf16_f32 v226, v212, v213
  v_cvt_pk_bf16_f32 v227, v214, v215
  s_nop 0
  v_permlane32_swap_b32 v224, v226
  v_permlane32_swap_b32 v225, v227
  s_nop 0
  v_permlane16_swap_b32 v224, v226
  v_permlane16_swap_b32 v225, v227
  s_mov_b32 s27, 0
  buffer_store_dwordx4 v[224:227], v7, s[8:11], s27 offen offset:0
  buffer_load_dwordx4 v[112:115], v5, s[4:7], 0 offen offset:3072
  buffer_load_dwordx4 v[116:119], v5, s[4:7], s33 offen offset:3072
  buffer_load_dwordx4 v[120:123], v5, s[4:7], s34 offen offset:3072
  buffer_load_dwordx4 v[124:127], v5, s[4:7], s35 offen offset:3072
  buffer_load_dwordx4 v[128:131], v5, s[4:7], s36 offen offset:3072
  buffer_load_dwordx4 v[132:135], v5, s[4:7], s37 offen offset:3072
  buffer_load_dwordx4 v[136:139], v5, s[4:7], s38 offen offset:3072
  buffer_load_dwordx4 v[140:143], v5, s[4:7], s39 offen offset:3072
  s_waitcnt vmcnt(24)
  v_lshlrev_b32 v208, 16, v48
  v_and_b32 v209, s26, v48
  v_lshlrev_b32 v210, 16, v49
  v_and_b32 v211, s26, v49
  v_lshlrev_b32 v212, 16, v50
  v_and_b32 v213, s26, v50
  v_lshlrev_b32 v214, 16, v51
  v_and_b32 v215, s26, v51
  s_waitcnt vmcnt(23)
  v_lshlrev_b32 v216, 16, v52
  v_and_b32 v217, s26, v52
  v_lshlrev_b32 v218, 16, v53
  v_and_b32 v219, s26, v53
  v_lshlrev_b32 v220, 16, v54
  v_and_b32 v221, s26, v54
  v_lshlrev_b32 v222, 16, v55
  v_and_b32 v223, s26, v55
  v_add_f32 v208, v208, v216
  v_add_f32 v209, v209, v217
  v_add_f32 v210, v210, v218
  v_add_f32 v211, v211, v219
  v_add_f32 v212, v212, v220
  v_add_f32 v213, v213, v221
  v_add_f32 v214, v214, v222
  v_add_f32 v215, v215, v223
  s_waitcnt vmcnt(22)
  v_lshlrev_b32 v216, 16, v56
  v_and_b32 v217, s26, v56
  v_lshlrev_b32 v218, 16, v57
  v_and_b32 v219, s26, v57
  v_lshlrev_b32 v220, 16, v58
  v_and_b32 v221, s26, v58
  v_lshlrev_b32 v222, 16, v59
  v_and_b32 v223, s26, v59
  v_add_f32 v208, v208, v216
  v_add_f32 v209, v209, v217
  v_add_f32 v210, v210, v218
  v_add_f32 v211, v211, v219
  v_add_f32 v212, v212, v220
  v_add_f32 v213, v213, v221
  v_add_f32 v214, v214, v222
  v_add_f32 v215, v215, v223
  s_waitcnt vmcnt(21)
  v_lshlrev_b32 v216, 16, v60
  v_and_b32 v217, s26, v60
  v_lshlrev_b32 v218, 16, v61
  v_and_b32 v219, s26, v61
  v_lshlrev_b32 v220, 16, v62
  v_and_b32 v221, s26, v62
  v_lshlrev_b32 v222, 16, v63
  v_and_b32 v223, s26, v63
  v_add_f32 v208, v208, v216
  v_add_f32 v209, v209, v217
  v_add_f32 v210, v210, v218
  v_add_f32 v211, v211, v219
  v_add_f32 v212, v212, v220
  v_add_f32 v213, v213, v221
  v_add_f32 v214, v214, v222
  v_add_f32 v215, v215, v223
  s_waitcnt vmcnt(20)
  v_lshlrev_b32 v216, 16, v64
  v_and_b32 v217, s26, v64
  v_lshlrev_b32 v218, 16, v65
  v_and_b32 v219, s26, v65
  v_lshlrev_b32 v220, 16, v66
  v_and_b32 v221, s26, v66
  v_lshlrev_b32 v222, 16, v67
  v_and_b32 v223, s26, v67
  v_add_f32 v208, v208, v216
  v_add_f32 v209, v209, v217
  v_add_f32 v210, v210, v218
  v_add_f32 v211, v211, v219
  v_add_f32 v212, v212, v220
  v_add_f32 v213, v213, v221
  v_add_f32 v214, v214, v222
  v_add_f32 v215, v215, v223
  s_waitcnt vmcnt(19)
  v_lshlrev_b32 v216, 16, v68
  v_and_b32 v217, s26, v68
  v_lshlrev_b32 v218, 16, v69
  v_and_b32 v219, s26, v69
  v_lshlrev_b32 v220, 16, v70
  v_and_b32 v221, s26, v70
  v_lshlrev_b32 v222, 16, v71
  v_and_b32 v223, s26, v71
  v_add_f32 v208, v208, v216
  v_add_f32 v209, v209, v217
  v_add_f32 v210, v210, v218
  v_add_f32 v211, v211, v219
  v_add_f32 v212, v212, v220
  v_add_f32 v213, v213, v221
  v_add_f32 v214, v214, v222
  v_add_f32 v215, v215, v223
  s_waitcnt vmcnt(18)
  v_lshlrev_b32 v216, 16, v72
  v_and_b32 v217, s26, v72
  v_lshlrev_b32 v218, 16, v73
  v_and_b32 v219, s26, v73
  v_lshlrev_b32 v220, 16, v74
  v_and_b32 v221, s26, v74
  v_lshlrev_b32 v222, 16, v75
  v_and_b32 v223, s26, v75
  v_add_f32 v208, v208, v216
  v_add_f32 v209, v209, v217
  v_add_f32 v210, v210, v218
  v_add_f32 v211, v211, v219
  v_add_f32 v212, v212, v220
  v_add_f32 v213, v213, v221
  v_add_f32 v214, v214, v222
  v_add_f32 v215, v215, v223
  s_waitcnt vmcnt(17)
  v_lshlrev_b32 v216, 16, v76
  v_and_b32 v217, s26, v76
  v_lshlrev_b32 v218, 16, v77
  v_and_b32 v219, s26, v77
  v_lshlrev_b32 v220, 16, v78
  v_and_b32 v221, s26, v78
  v_lshlrev_b32 v222, 16, v79
  v_and_b32 v223, s26, v79
  v_add_f32 v208, v208, v216
  v_add_f32 v209, v209, v217
  v_add_f32 v210, v210, v218
  v_add_f32 v211, v211, v219
  v_add_f32 v212, v212, v220
  v_add_f32 v213, v213, v221
  v_add_f32 v214, v214, v222
  v_add_f32 v215, v215, v223
  v_cvt_pk_bf16_f32 v228, v208, v209
  v_cvt_pk_bf16_f32 v229, v210, v211
  v_cvt_pk_bf16_f32 v230, v212, v213
  v_cvt_pk_bf16_f32 v231, v214, v215
  s_nop 0
  v_permlane32_swap_b32 v228, v230
  v_permlane32_swap_b32 v229, v231
  s_nop 0
  v_permlane16_swap_b32 v228, v230
  v_permlane16_swap_b32 v229, v231
  s_mov_b32 s27, 0
  buffer_store_dwordx4 v[228:231], v7, s[8:11], s27 offen offset:64
  buffer_load_dwordx4 v[144:147], v6, s[4:7], 0 offen offset:0
  buffer_load_dwordx4 v[148:151], v6, s[4:7], s33 offen offset:0
  buffer_load_dwordx4 v[152:155], v6, s[4:7], s34 offen offset:0
  buffer_load_dwordx4 v[156:159], v6, s[4:7], s35 offen offset:0
  buffer_load_dwordx4 v[160:163], v6, s[4:7], s36 offen offset:0
  buffer_load_dwordx4 v[164:167], v6, s[4:7], s37 offen offset:0
  buffer_load_dwordx4 v[168:171], v6, s[4:7], s38 offen offset:0
  buffer_load_dwordx4 v[172:175], v6, s[4:7], s39 offen offset:0
  s_waitcnt vmcnt(25)
  v_lshlrev_b32 v208, 16, v80
  v_and_b32 v209, s26, v80
  v_lshlrev_b32 v210, 16, v81
  v_and_b32 v211, s26, v81
  v_lshlrev_b32 v212, 16, v82
  v_and_b32 v213, s26, v82
  v_lshlrev_b32 v214, 16, v83
  v_and_b32 v215, s26, v83
  s_waitcnt vmcnt(24)
  v_lshlrev_b32 v216, 16, v84
  v_and_b32 v217, s26, v84
  v_lshlrev_b32 v218, 16, v85
  v_and_b32 v219, s26, v85
  v_lshlrev_b32 v220, 16, v86
  v_and_b32 v221, s26, v86
  v_lshlrev_b32 v222, 16, v87
  v_and_b32 v223, s26, v87
  v_add_f32 v208, v208, v216
  v_add_f32 v209, v209, v217
  v_add_f32 v210, v210, v218
  v_add_f32 v211, v211, v219
  v_add_f32 v212, v212, v220
  v_add_f32 v213, v213, v221
  v_add_f32 v214, v214, v222
  v_add_f32 v215, v215, v223
  s_waitcnt vmcnt(23)
  v_lshlrev_b32 v216, 16, v88
  v_and_b32 v217, s26, v88
  v_lshlrev_b32 v218, 16, v89
  v_and_b32 v219, s26, v89
  v_lshlrev_b32 v220, 16, v90
  v_and_b32 v221, s26, v90
  v_lshlrev_b32 v222, 16, v91
  v_and_b32 v223, s26, v91
  v_add_f32 v208, v208, v216
  v_add_f32 v209, v209, v217
  v_add_f32 v210, v210, v218
  v_add_f32 v211, v211, v219
  v_add_f32 v212, v212, v220
  v_add_f32 v213, v213, v221
  v_add_f32 v214, v214, v222
  v_add_f32 v215, v215, v223
  s_waitcnt vmcnt(22)
  v_lshlrev_b32 v216, 16, v92
  v_and_b32 v217, s26, v92
  v_lshlrev_b32 v218, 16, v93
  v_and_b32 v219, s26, v93
  v_lshlrev_b32 v220, 16, v94
  v_and_b32 v221, s26, v94
  v_lshlrev_b32 v222, 16, v95
  v_and_b32 v223, s26, v95
  v_add_f32 v208, v208, v216
  v_add_f32 v209, v209, v217
  v_add_f32 v210, v210, v218
  v_add_f32 v211, v211, v219
  v_add_f32 v212, v212, v220
  v_add_f32 v213, v213, v221
  v_add_f32 v214, v214, v222
  v_add_f32 v215, v215, v223
  s_waitcnt vmcnt(21)
  v_lshlrev_b32 v216, 16, v96
  v_and_b32 v217, s26, v96
  v_lshlrev_b32 v218, 16, v97
  v_and_b32 v219, s26, v97
  v_lshlrev_b32 v220, 16, v98
  v_and_b32 v221, s26, v98
  v_lshlrev_b32 v222, 16, v99
  v_and_b32 v223, s26, v99
  v_add_f32 v208, v208, v216
  v_add_f32 v209, v209, v217
  v_add_f32 v210, v210, v218
  v_add_f32 v211, v211, v219
  v_add_f32 v212, v212, v220
  v_add_f32 v213, v213, v221
  v_add_f32 v214, v214, v222
  v_add_f32 v215, v215, v223
  s_waitcnt vmcnt(20)
  v_lshlrev_b32 v216, 16, v100
  v_and_b32 v217, s26, v100
  v_lshlrev_b32 v218, 16, v101
  v_and_b32 v219, s26, v101
  v_lshlrev_b32 v220, 16, v102
  v_and_b32 v221, s26, v102
  v_lshlrev_b32 v222, 16, v103
  v_and_b32 v223, s26, v103
  v_add_f32 v208, v208, v216
  v_add_f32 v209, v209, v217
  v_add_f32 v210, v210, v218
  v_add_f32 v211, v211, v219
  v_add_f32 v212, v212, v220
  v_add_f32 v213, v213, v221
  v_add_f32 v214, v214, v222
  v_add_f32 v215, v215, v223
  s_waitcnt vmcnt(19)
  v_lshlrev_b32 v216, 16, v104
  v_and_b32 v217, s26, v104
  v_lshlrev_b32 v218, 16, v105
  v_and_b32 v219, s26, v105
  v_lshlrev_b32 v220, 16, v106
  v_and_b32 v221, s26, v106
  v_lshlrev_b32 v222, 16, v107
  v_and_b32 v223, s26, v107
  v_add_f32 v208, v208, v216
  v_add_f32 v209, v209, v217
  v_add_f32 v210, v210, v218
  v_add_f32 v211, v211, v219
  v_add_f32 v212, v212, v220
  v_add_f32 v213, v213, v221
  v_add_f32 v214, v214, v222
  v_add_f32 v215, v215, v223
  s_waitcnt vmcnt(18)
  v_lshlrev_b32 v216, 16, v108
  v_and_b32 v217, s26, v108
  v_lshlrev_b32 v218, 16, v109
  v_and_b32 v219, s26, v109
  v_lshlrev_b32 v220, 16, v110
  v_and_b32 v221, s26, v110
  v_lshlrev_b32 v222, 16, v111
  v_and_b32 v223, s26, v111
  v_add_f32 v208, v208, v216
  v_add_f32 v209, v209, v217
  v_add_f32 v210, v210, v218
  v_add_f32 v211, v211, v219
  v_add_f32 v212, v212, v220
  v_add_f32 v213, v213, v221
  v_add_f32 v214, v214, v222
  v_add_f32 v215, v215, v223
  v_cvt_pk_bf16_f32 v224, v208, v209
  v_cvt_pk_bf16_f32 v225, v210, v211
  v_cvt_pk_bf16_f32 v226, v212, v213
  v_cvt_pk_bf16_f32 v227, v214, v215
  s_nop 0
  v_permlane32_swap_b32 v224, v226
  v_permlane32_swap_b32 v225, v227
  s_nop 0
  v_permlane16_swap_b32 v224, v226
  v_permlane16_swap_b32 v225, v227
  s_mov_b32 s27, 28672
  buffer_store_dwordx4 v[224:227], v7, s[8:11], s27 offen offset:0
  buffer_load_dwordx4 v[176:179], v6, s[4:7], 0 offen offset:1024
  buffer_load_dwordx4 v[180:183], v6, s[4:7], s33 offen offset:1024
  buffer_load_dwordx4 v[184:187], v6, s[4:7], s34 offen offset:1024
  buffer_load_dwordx4 v[188:191], v6, s[4:7], s35 offen offset:1024
  buffer_load_dwordx4 v[192:195], v6, s[4:7], s36 offen offset:1024
  buffer_load_dwordx4 v[196:199], v6, s[4:7], s37 offen offset:1024
  buffer_load_dwordx4 v[200:203], v6, s[4:7], s38 offen offset:1024
  buffer_load_dwordx4 v[204:207], v6, s[4:7], s39 offen offset:1024
  s_waitcnt vmcnt(25)
  v_lshlrev_b32 v208, 16, v112
  v_and_b32 v209, s26, v112
  v_lshlrev_b32 v210, 16, v113
  v_and_b32 v211, s26, v113
  v_lshlrev_b32 v212, 16, v114
  v_and_b32 v213, s26, v114
  v_lshlrev_b32 v214, 16, v115
  v_and_b32 v215, s26, v115
  s_waitcnt vmcnt(24)
  v_lshlrev_b32 v216, 16, v116
  v_and_b32 v217, s26, v116
  v_lshlrev_b32 v218, 16, v117
  v_and_b32 v219, s26, v117
  v_lshlrev_b32 v220, 16, v118
  v_and_b32 v221, s26, v118
  v_lshlrev_b32 v222, 16, v119
  v_and_b32 v223, s26, v119
  v_add_f32 v208, v208, v216
  v_add_f32 v209, v209, v217
  v_add_f32 v210, v210, v218
  v_add_f32 v211, v211, v219
  v_add_f32 v212, v212, v220
  v_add_f32 v213, v213, v221
  v_add_f32 v214, v214, v222
  v_add_f32 v215, v215, v223
  s_waitcnt vmcnt(23)
  v_lshlrev_b32 v216, 16, v120
  v_and_b32 v217, s26, v120
  v_lshlrev_b32 v218, 16, v121
  v_and_b32 v219, s26, v121
  v_lshlrev_b32 v220, 16, v122
  v_and_b32 v221, s26, v122
  v_lshlrev_b32 v222, 16, v123
  v_and_b32 v223, s26, v123
  v_add_f32 v208, v208, v216
  v_add_f32 v209, v209, v217
  v_add_f32 v210, v210, v218
  v_add_f32 v211, v211, v219
  v_add_f32 v212, v212, v220
  v_add_f32 v213, v213, v221
  v_add_f32 v214, v214, v222
  v_add_f32 v215, v215, v223
  s_waitcnt vmcnt(22)
  v_lshlrev_b32 v216, 16, v124
  v_and_b32 v217, s26, v124
  v_lshlrev_b32 v218, 16, v125
  v_and_b32 v219, s26, v125
  v_lshlrev_b32 v220, 16, v126
  v_and_b32 v221, s26, v126
  v_lshlrev_b32 v222, 16, v127
  v_and_b32 v223, s26, v127
  v_add_f32 v208, v208, v216
  v_add_f32 v209, v209, v217
  v_add_f32 v210, v210, v218
  v_add_f32 v211, v211, v219
  v_add_f32 v212, v212, v220
  v_add_f32 v213, v213, v221
  v_add_f32 v214, v214, v222
  v_add_f32 v215, v215, v223
  s_waitcnt vmcnt(21)
  v_lshlrev_b32 v216, 16, v128
  v_and_b32 v217, s26, v128
  v_lshlrev_b32 v218, 16, v129
  v_and_b32 v219, s26, v129
  v_lshlrev_b32 v220, 16, v130
  v_and_b32 v221, s26, v130
  v_lshlrev_b32 v222, 16, v131
  v_and_b32 v223, s26, v131
  v_add_f32 v208, v208, v216
  v_add_f32 v209, v209, v217
  v_add_f32 v210, v210, v218
  v_add_f32 v211, v211, v219
  v_add_f32 v212, v212, v220
  v_add_f32 v213, v213, v221
  v_add_f32 v214, v214, v222
  v_add_f32 v215, v215, v223
  s_waitcnt vmcnt(20)
  v_lshlrev_b32 v216, 16, v132
  v_and_b32 v217, s26, v132
  v_lshlrev_b32 v218, 16, v133
  v_and_b32 v219, s26, v133
  v_lshlrev_b32 v220, 16, v134
  v_and_b32 v221, s26, v134
  v_lshlrev_b32 v222, 16, v135
  v_and_b32 v223, s26, v135
  v_add_f32 v208, v208, v216
  v_add_f32 v209, v209, v217
  v_add_f32 v210, v210, v218
  v_add_f32 v211, v211, v219
  v_add_f32 v212, v212, v220
  v_add_f32 v213, v213, v221
  v_add_f32 v214, v214, v222
  v_add_f32 v215, v215, v223
  s_waitcnt vmcnt(19)
  v_lshlrev_b32 v216, 16, v136
  v_and_b32 v217, s26, v136
  v_lshlrev_b32 v218, 16, v137
  v_and_b32 v219, s26, v137
  v_lshlrev_b32 v220, 16, v138
  v_and_b32 v221, s26, v138
  v_lshlrev_b32 v222, 16, v139
  v_and_b32 v223, s26, v139
  v_add_f32 v208, v208, v216
  v_add_f32 v209, v209, v217
  v_add_f32 v210, v210, v218
  v_add_f32 v211, v211, v219
  v_add_f32 v212, v212, v220
  v_add_f32 v213, v213, v221
  v_add_f32 v214, v214, v222
  v_add_f32 v215, v215, v223
  s_waitcnt vmcnt(18)
  v_lshlrev_b32 v216, 16, v140
  v_and_b32 v217, s26, v140
  v_lshlrev_b32 v218, 16, v141
  v_and_b32 v219, s26, v141
  v_lshlrev_b32 v220, 16, v142
  v_and_b32 v221, s26, v142
  v_lshlrev_b32 v222, 16, v143
  v_and_b32 v223, s26, v143
  v_add_f32 v208, v208, v216
  v_add_f32 v209, v209, v217
  v_add_f32 v210, v210, v218
  v_add_f32 v211, v211, v219
  v_add_f32 v212, v212, v220
  v_add_f32 v213, v213, v221
  v_add_f32 v214, v214, v222
  v_add_f32 v215, v215, v223
  v_cvt_pk_bf16_f32 v228, v208, v209
  v_cvt_pk_bf16_f32 v229, v210, v211
  v_cvt_pk_bf16_f32 v230, v212, v213
  v_cvt_pk_bf16_f32 v231, v214, v215
  s_nop 0
  v_permlane32_swap_b32 v228, v230
  v_permlane32_swap_b32 v229, v231
  s_nop 0
  v_permlane16_swap_b32 v228, v230
  v_permlane16_swap_b32 v229, v231
  s_mov_b32 s27, 28672
  buffer_store_dwordx4 v[228:231], v7, s[8:11], s27 offen offset:64
  s_waitcnt vmcnt(17)
  v_lshlrev_b32 v208, 16, v144
  v_and_b32 v209, s26, v144
  v_lshlrev_b32 v210, 16, v145
  v_and_b32 v211, s26, v145
  v_lshlrev_b32 v212, 16, v146
  v_and_b32 v213, s26, v146
  v_lshlrev_b32 v214, 16, v147
  v_and_b32 v215, s26, v147
  s_waitcnt vmcnt(16)
  v_lshlrev_b32 v216, 16, v148
  v_and_b32 v217, s26, v148
  v_lshlrev_b32 v218, 16, v149
  v_and_b32 v219, s26, v149
  v_lshlrev_b32 v220, 16, v150
  v_and_b32 v221, s26, v150
  v_lshlrev_b32 v222, 16, v151
  v_and_b32 v223, s26, v151
  v_add_f32 v208, v208, v216
  v_add_f32 v209, v209, v217
  v_add_f32 v210, v210, v218
  v_add_f32 v211, v211, v219
  v_add_f32 v212, v212, v220
  v_add_f32 v213, v213, v221
  v_add_f32 v214, v214, v222
  v_add_f32 v215, v215, v223
  s_waitcnt vmcnt(15)
  v_lshlrev_b32 v216, 16, v152
  v_and_b32 v217, s26, v152
  v_lshlrev_b32 v218, 16, v153
  v_and_b32 v219, s26, v153
  v_lshlrev_b32 v220, 16, v154
  v_and_b32 v221, s26, v154
  v_lshlrev_b32 v222, 16, v155
  v_and_b32 v223, s26, v155
  v_add_f32 v208, v208, v216
  v_add_f32 v209, v209, v217
  v_add_f32 v210, v210, v218
  v_add_f32 v211, v211, v219
  v_add_f32 v212, v212, v220
  v_add_f32 v213, v213, v221
  v_add_f32 v214, v214, v222
  v_add_f32 v215, v215, v223
  s_waitcnt vmcnt(14)
  v_lshlrev_b32 v216, 16, v156
  v_and_b32 v217, s26, v156
  v_lshlrev_b32 v218, 16, v157
  v_and_b32 v219, s26, v157
  v_lshlrev_b32 v220, 16, v158
  v_and_b32 v221, s26, v158
  v_lshlrev_b32 v222, 16, v159
  v_and_b32 v223, s26, v159
  v_add_f32 v208, v208, v216
  v_add_f32 v209, v209, v217
  v_add_f32 v210, v210, v218
  v_add_f32 v211, v211, v219
  v_add_f32 v212, v212, v220
  v_add_f32 v213, v213, v221
  v_add_f32 v214, v214, v222
  v_add_f32 v215, v215, v223
  s_waitcnt vmcnt(13)
  v_lshlrev_b32 v216, 16, v160
  v_and_b32 v217, s26, v160
  v_lshlrev_b32 v218, 16, v161
  v_and_b32 v219, s26, v161
  v_lshlrev_b32 v220, 16, v162
  v_and_b32 v221, s26, v162
  v_lshlrev_b32 v222, 16, v163
  v_and_b32 v223, s26, v163
  v_add_f32 v208, v208, v216
  v_add_f32 v209, v209, v217
  v_add_f32 v210, v210, v218
  v_add_f32 v211, v211, v219
  v_add_f32 v212, v212, v220
  v_add_f32 v213, v213, v221
  v_add_f32 v214, v214, v222
  v_add_f32 v215, v215, v223
  s_waitcnt vmcnt(12)
  v_lshlrev_b32 v216, 16, v164
  v_and_b32 v217, s26, v164
  v_lshlrev_b32 v218, 16, v165
  v_and_b32 v219, s26, v165
  v_lshlrev_b32 v220, 16, v166
  v_and_b32 v221, s26, v166
  v_lshlrev_b32 v222, 16, v167
  v_and_b32 v223, s26, v167
  v_add_f32 v208, v208, v216
  v_add_f32 v209, v209, v217
  v_add_f32 v210, v210, v218
  v_add_f32 v211, v211, v219
  v_add_f32 v212, v212, v220
  v_add_f32 v213, v213, v221
  v_add_f32 v214, v214, v222
  v_add_f32 v215, v215, v223
  s_waitcnt vmcnt(11)
  v_lshlrev_b32 v216, 16, v168
  v_and_b32 v217, s26, v168
  v_lshlrev_b32 v218, 16, v169
  v_and_b32 v219, s26, v169
  v_lshlrev_b32 v220, 16, v170
  v_and_b32 v221, s26, v170
  v_lshlrev_b32 v222, 16, v171
  v_and_b32 v223, s26, v171
  v_add_f32 v208, v208, v216
  v_add_f32 v209, v209, v217
  v_add_f32 v210, v210, v218
  v_add_f32 v211, v211, v219
  v_add_f32 v212, v212, v220
  v_add_f32 v213, v213, v221
  v_add_f32 v214, v214, v222
  v_add_f32 v215, v215, v223
  s_waitcnt vmcnt(10)
  v_lshlrev_b32 v216, 16, v172
  v_and_b32 v217, s26, v172
  v_lshlrev_b32 v218, 16, v173
  v_and_b32 v219, s26, v173
  v_lshlrev_b32 v220, 16, v174
  v_and_b32 v221, s26, v174
  v_lshlrev_b32 v222, 16, v175
  v_and_b32 v223, s26, v175
  v_add_f32 v208, v208, v216
  v_add_f32 v209, v209, v217
  v_add_f32 v210, v210, v218
  v_add_f32 v211, v211, v219
  v_add_f32 v212, v212, v220
  v_add_f32 v213, v213, v221
  v_add_f32 v214, v214, v222
  v_add_f32 v215, v215, v223
  v_cvt_pk_bf16_f32 v224, v208, v209
  v_cvt_pk_bf16_f32 v225, v210, v211
  v_cvt_pk_bf16_f32 v226, v212, v213
  v_cvt_pk_bf16_f32 v227, v214, v215
  s_nop 0
  v_permlane32_swap_b32 v224, v226
  v_permlane32_swap_b32 v225, v227
  s_nop 0
  v_permlane16_swap_b32 v224, v226
  v_permlane16_swap_b32 v225, v227
  s_mov_b32 s27, 57344
  buffer_store_dwordx4 v[224:227], v7, s[8:11], s27 offen offset:0
  s_waitcnt vmcnt(9)
  v_lshlrev_b32 v208, 16, v176
  v_and_b32 v209, s26, v176
  v_lshlrev_b32 v210, 16, v177
  v_and_b32 v211, s26, v177
  v_lshlrev_b32 v212, 16, v178
  v_and_b32 v213, s26, v178
  v_lshlrev_b32 v214, 16, v179
  v_and_b32 v215, s26, v179
  s_waitcnt vmcnt(8)
  v_lshlrev_b32 v216, 16, v180
  v_and_b32 v217, s26, v180
  v_lshlrev_b32 v218, 16, v181
  v_and_b32 v219, s26, v181
  v_lshlrev_b32 v220, 16, v182
  v_and_b32 v221, s26, v182
  v_lshlrev_b32 v222, 16, v183
  v_and_b32 v223, s26, v183
  v_add_f32 v208, v208, v216
  v_add_f32 v209, v209, v217
  v_add_f32 v210, v210, v218
  v_add_f32 v211, v211, v219
  v_add_f32 v212, v212, v220
  v_add_f32 v213, v213, v221
  v_add_f32 v214, v214, v222
  v_add_f32 v215, v215, v223
  s_waitcnt vmcnt(7)
  v_lshlrev_b32 v216, 16, v184
  v_and_b32 v217, s26, v184
  v_lshlrev_b32 v218, 16, v185
  v_and_b32 v219, s26, v185
  v_lshlrev_b32 v220, 16, v186
  v_and_b32 v221, s26, v186
  v_lshlrev_b32 v222, 16, v187
  v_and_b32 v223, s26, v187
  v_add_f32 v208, v208, v216
  v_add_f32 v209, v209, v217
  v_add_f32 v210, v210, v218
  v_add_f32 v211, v211, v219
  v_add_f32 v212, v212, v220
  v_add_f32 v213, v213, v221
  v_add_f32 v214, v214, v222
  v_add_f32 v215, v215, v223
  s_waitcnt vmcnt(6)
  v_lshlrev_b32 v216, 16, v188
  v_and_b32 v217, s26, v188
  v_lshlrev_b32 v218, 16, v189
  v_and_b32 v219, s26, v189
  v_lshlrev_b32 v220, 16, v190
  v_and_b32 v221, s26, v190
  v_lshlrev_b32 v222, 16, v191
  v_and_b32 v223, s26, v191
  v_add_f32 v208, v208, v216
  v_add_f32 v209, v209, v217
  v_add_f32 v210, v210, v218
  v_add_f32 v211, v211, v219
  v_add_f32 v212, v212, v220
  v_add_f32 v213, v213, v221
  v_add_f32 v214, v214, v222
  v_add_f32 v215, v215, v223
  s_waitcnt vmcnt(5)
  v_lshlrev_b32 v216, 16, v192
  v_and_b32 v217, s26, v192
  v_lshlrev_b32 v218, 16, v193
  v_and_b32 v219, s26, v193
  v_lshlrev_b32 v220, 16, v194
  v_and_b32 v221, s26, v194
  v_lshlrev_b32 v222, 16, v195
  v_and_b32 v223, s26, v195
  v_add_f32 v208, v208, v216
  v_add_f32 v209, v209, v217
  v_add_f32 v210, v210, v218
  v_add_f32 v211, v211, v219
  v_add_f32 v212, v212, v220
  v_add_f32 v213, v213, v221
  v_add_f32 v214, v214, v222
  v_add_f32 v215, v215, v223
  s_waitcnt vmcnt(4)
  v_lshlrev_b32 v216, 16, v196
  v_and_b32 v217, s26, v196
  v_lshlrev_b32 v218, 16, v197
  v_and_b32 v219, s26, v197
  v_lshlrev_b32 v220, 16, v198
  v_and_b32 v221, s26, v198
  v_lshlrev_b32 v222, 16, v199
  v_and_b32 v223, s26, v199
  v_add_f32 v208, v208, v216
  v_add_f32 v209, v209, v217
  v_add_f32 v210, v210, v218
  v_add_f32 v211, v211, v219
  v_add_f32 v212, v212, v220
  v_add_f32 v213, v213, v221
  v_add_f32 v214, v214, v222
  v_add_f32 v215, v215, v223
  s_waitcnt vmcnt(3)
  v_lshlrev_b32 v216, 16, v200
  v_and_b32 v217, s26, v200
  v_lshlrev_b32 v218, 16, v201
  v_and_b32 v219, s26, v201
  v_lshlrev_b32 v220, 16, v202
  v_and_b32 v221, s26, v202
  v_lshlrev_b32 v222, 16, v203
  v_and_b32 v223, s26, v203
  v_add_f32 v208, v208, v216
  v_add_f32 v209, v209, v217
  v_add_f32 v210, v210, v218
  v_add_f32 v211, v211, v219
  v_add_f32 v212, v212, v220
  v_add_f32 v213, v213, v221
  v_add_f32 v214, v214, v222
  v_add_f32 v215, v215, v223
  s_waitcnt vmcnt(2)
  v_lshlrev_b32 v216, 16, v204
  v_and_b32 v217, s26, v204
  v_lshlrev_b32 v218, 16, v205
  v_and_b32 v219, s26, v205
  v_lshlrev_b32 v220, 16, v206
  v_and_b32 v221, s26, v206
  v_lshlrev_b32 v222, 16, v207
  v_and_b32 v223, s26, v207
  v_add_f32 v208, v208, v216
  v_add_f32 v209, v209, v217
  v_add_f32 v210, v210, v218
  v_add_f32 v211, v211, v219
  v_add_f32 v212, v212, v220
  v_add_f32 v213, v213, v221
  v_add_f32 v214, v214, v222
  v_add_f32 v215, v215, v223
  v_cvt_pk_bf16_f32 v228, v208, v209
  v_cvt_pk_bf16_f32 v229, v210, v211
  v_cvt_pk_bf16_f32 v230, v212, v213
  v_cvt_pk_bf16_f32 v231, v214, v215
  s_nop 0
  v_permlane32_swap_b32 v228, v230
  v_permlane32_swap_b32 v229, v231
  s_nop 0
  v_permlane16_swap_b32 v228, v230
  v_permlane16_swap_b32 v229, v231
  s_mov_b32 s27, 57344
  buffer_store_dwordx4 v[228:231], v7, s[8:11], s27 offen offset:64
L_k3_end:
  s_waitcnt vmcnt(0)
  s_endpgm
.section .rodata,"a"
.p2align 6
.amdhsa_kernel attn_kernel
  .amdhsa_next_free_vgpr 512
  .amdhsa_next_free_sgpr 102
  .amdhsa_accum_offset 256
  .amdhsa_group_segment_fixed_size 0
  .amdhsa_kernarg_size 104
  .amdhsa_user_sgpr_count 2
  .amdhsa_user_sgpr_kernarg_segment_ptr 1
  .amdhsa_system_sgpr_workgroup_id_x 1
.end_amdhsa_kernel
.p2align 6
.amdhsa_kernel reduce_kernel
  .amdhsa_next_free_vgpr 232
  .amdhsa_next_free_sgpr 48
  .amdhsa_accum_offset 232
  .amdhsa_group_segment_fixed_size 0
  .amdhsa_kernarg_size 104
  .amdhsa_user_sgpr_count 2
  .amdhsa_user_sgpr_kernarg_segment_ptr 1
  .amdhsa_system_sgpr_workgroup_id_x 1
.end_amdhsa_kernel
```
